```python
import torch

def _softmax(x, axis=-1):
    return torch.softmax(x, dim=axis)
def _gelu(x):
    return torch.nn.functional.gelu(x, approximate="tanh")
def _silu(x):
    return torch.nn.functional.silu(x)
def _sigmoid(x):
    return torch.sigmoid(x)
def _layernorm(x, axis=-1, eps=1e-5):
    m = x.mean(dim=axis, keepdim=True)
    v = x.var(dim=axis, keepdim=True, unbiased=False)
    return (x - m) / torch.sqrt(v + eps)
def _scatter_add(tgt, idx, src, axis=0):
    return tgt.clone().index_add_(axis, idx, src)
def _segment_sum(src, seg, n):
    out = torch.zeros((n,) + src.shape[1:], dtype=src.dtype)
    return out.index_add_(0, seg, src)
def _pad(x, pw):
    flat = tuple(v for pair in reversed(pw) for v in pair)
    return torch.nn.functional.pad(x, flat)

kernel_name = 'standalone__instancenorm__prompt'

def setup_inputs():

    _w = (lambda a: (lambda t: t.to(torch.bfloat16) if t.is_floating_point() else t)(torch.as_tensor(a)))
    B, C, H, W = 2, 640, 2048, 32
    return {
        "x": _w(abs((lambda *s: torch.randn(*s, dtype=torch.bfloat16) * 0.05)(B, C, H, W))),
        "g": _w((lambda *s: torch.randn(*s, dtype=torch.bfloat16) * 0.05)(C) + 1.0),
        "b": _w((lambda *s: torch.randn(*s, dtype=torch.bfloat16) * 0.4)(C)),
    }

def reference(x, g, b):
    mu = x.mean(axis=(-2, -1), keepdims=True)
    var = ((x - mu) ** 2).mean(axis=(-2, -1), keepdims=True)
    xhat = (x - mu) / torch.sqrt(var + 1e-5)
    return xhat * g.reshape(1, -1, 1, 1) + b.reshape(1, -1, 1, 1)
```

```asm
; @launch grid=(256,1,1) block=(512,1,1) lds=1024
.amdgcn_target "amdgcn-amd-amdhsa--gfx950"
.text
.globl standalone__instancenorm__prompt_kernel
.p2align 8
.type standalone__instancenorm__prompt_kernel,@function
standalone__instancenorm__prompt_kernel:
    s_cmp_ge_u32 s2, 256
    s_cbranch_scc1 L_end
    s_load_dwordx4 s[4:7], s[0:1], 0
    s_load_dwordx4 s[8:11], s[0:1], 16
    s_load_dwordx2 s[70:71], s[0:1], 40
    v_lshrrev_b32 v2, 6, v0
    v_lshlrev_b32 v1, 4, v0
    v_readfirstlane_b32 s3, v2
    s_lshr_b32 s27, s2, 1
    s_lshl_b32 s17, s27, 1
    s_add_u32 s40, s17, 0
    s_sub_u32 s50, s40, 640
    s_cmp_ge_u32 s40, 640
    s_cselect_b32 s50, s50, s40
    s_lshl_b32 s40, s40, 17
    s_add_u32 s41, s17, 256
    s_sub_u32 s51, s41, 640
    s_cmp_ge_u32 s41, 640
    s_cselect_b32 s51, s51, s41
    s_lshl_b32 s41, s41, 17
    s_add_u32 s42, s17, 512
    s_sub_u32 s52, s42, 640
    s_cmp_ge_u32 s42, 640
    s_cselect_b32 s52, s52, s42
    s_lshl_b32 s42, s42, 17
    s_add_u32 s43, s17, 768
    s_sub_u32 s53, s43, 640
    s_cmp_ge_u32 s43, 640
    s_cselect_b32 s53, s53, s43
    s_lshl_b32 s43, s43, 17
    s_add_u32 s44, s17, 1024
    s_sub_u32 s54, s44, 640
    s_cmp_ge_u32 s44, 640
    s_cselect_b32 s54, s54, s44
    s_lshl_b32 s44, s44, 17
    s_add_u32 s45, s17, 1
    s_sub_u32 s55, s45, 640
    s_cmp_ge_u32 s45, 640
    s_cselect_b32 s55, s55, s45
    s_lshl_b32 s45, s45, 17
    s_add_u32 s46, s17, 257
    s_sub_u32 s56, s46, 640
    s_cmp_ge_u32 s46, 640
    s_cselect_b32 s56, s56, s46
    s_lshl_b32 s46, s46, 17
    s_add_u32 s47, s17, 513
    s_sub_u32 s57, s47, 640
    s_cmp_ge_u32 s47, 640
    s_cselect_b32 s57, s57, s47
    s_lshl_b32 s47, s47, 17
    s_add_u32 s48, s17, 769
    s_sub_u32 s58, s48, 640
    s_cmp_ge_u32 s48, 640
    s_cselect_b32 s58, s58, s48
    s_lshl_b32 s48, s48, 17
    s_add_u32 s49, s17, 1025
    s_sub_u32 s59, s49, 640
    s_cmp_ge_u32 s49, 640
    s_cselect_b32 s59, s59, s49
    s_lshl_b32 s49, s49, 17
    s_and_b32 s16, s2, 1
    s_cmp_eq_u32 s16, 0
    s_cbranch_scc0 L_side1
    s_waitcnt lgkmcnt(0)
    s_add_u32 s12, s4, s49
    s_addc_u32 s13, s5, 0
    global_load_dwordx4 v[36:39], v1, s[12:13] nt
    s_add_u32 s12, s12, 8192
    s_addc_u32 s13, s13, 0
    global_load_dwordx4 v[40:43], v1, s[12:13] nt
    s_add_u32 s12, s12, 8192
    s_addc_u32 s13, s13, 0
    global_load_dwordx4 v[44:47], v1, s[12:13] nt
    s_add_u32 s12, s12, 8192
    s_addc_u32 s13, s13, 0
    global_load_dwordx4 v[48:51], v1, s[12:13] nt
    s_add_u32 s12, s12, 8192
    s_addc_u32 s13, s13, 0
    s_getpc_b64 s[38:39]
L_pc0:
    s_sub_u32 s38, s38, L_pc0-standalone__instancenorm__prompt_kernel
    s_subb_u32 s39, s39, 0
    global_load_dwordx4 v[24:27], v1, s[38:39]
    s_add_u32 s38, s38, 8192
    s_addc_u32 s39, s39, 0
    global_load_dwordx4 v[24:27], v1, s[38:39]
    s_add_u32 s38, s38, 8192
    s_addc_u32 s39, s39, 0
    global_load_dwordx4 v[24:27], v1, s[38:39]
    s_add_u32 s38, s38, 8192
    s_addc_u32 s39, s39, 0
    global_load_dwordx4 v[24:27], v1, s[38:39]
    s_barrier
    s_add_u32 s12, s4, s40
    s_addc_u32 s13, s5, 0
    global_load_dwordx4 v[52:55], v1, s[12:13] nt
    s_add_u32 s12, s12, 8192
    s_addc_u32 s13, s13, 0
    global_load_dwordx4 v[56:59], v1, s[12:13] nt
    s_add_u32 s12, s12, 8192
    s_addc_u32 s13, s13, 0
    global_load_dwordx4 v[60:63], v1, s[12:13] nt
    s_add_u32 s12, s12, 8192
    s_addc_u32 s13, s13, 0
    global_load_dwordx4 v[64:67], v1, s[12:13] nt
    s_add_u32 s12, s12, 8192
    s_addc_u32 s13, s13, 0
    global_load_dwordx4 v[68:71], v1, s[12:13] nt
    s_add_u32 s12, s12, 8192
    s_addc_u32 s13, s13, 0
    global_load_dwordx4 v[72:75], v1, s[12:13] nt
    s_add_u32 s12, s12, 8192
    s_addc_u32 s13, s13, 0
    global_load_dwordx4 v[76:79], v1, s[12:13] nt
    s_add_u32 s12, s12, 8192
    s_addc_u32 s13, s13, 0
    global_load_dwordx4 v[80:83], v1, s[12:13] nt
    s_add_u32 s12, s12, 8192
    s_addc_u32 s13, s13, 0
    global_load_dwordx4 v[84:87], v1, s[12:13] nt
    s_add_u32 s12, s12, 8192
    s_addc_u32 s13, s13, 0
    global_load_dwordx4 v[88:91], v1, s[12:13] nt
    s_add_u32 s12, s12, 8192
    s_addc_u32 s13, s13, 0
    global_load_dwordx4 v[92:95], v1, s[12:13] nt
    s_add_u32 s12, s12, 8192
    s_addc_u32 s13, s13, 0
    global_load_dwordx4 v[96:99], v1, s[12:13] nt
    s_add_u32 s12, s12, 8192
    s_addc_u32 s13, s13, 0
    global_load_dwordx4 v[100:103], v1, s[12:13] nt
    s_add_u32 s12, s12, 8192
    s_addc_u32 s13, s13, 0
    global_load_dwordx4 v[104:107], v1, s[12:13] nt
    s_add_u32 s12, s12, 8192
    s_addc_u32 s13, s13, 0
    global_load_dwordx4 v[108:111], v1, s[12:13] nt
    s_add_u32 s12, s12, 8192
    s_addc_u32 s13, s13, 0
    global_load_dwordx4 v[112:115], v1, s[12:13] nt
    s_add_u32 s12, s12, 8192
    s_addc_u32 s13, s13, 0
    s_barrier
    s_add_u32 s12, s4, s41
    s_addc_u32 s13, s5, 0
    global_load_dwordx4 v[116:119], v1, s[12:13] nt
    s_add_u32 s12, s12, 8192
    s_addc_u32 s13, s13, 0
    global_load_dwordx4 v[120:123], v1, s[12:13] nt
    s_add_u32 s12, s12, 8192
    s_addc_u32 s13, s13, 0
    global_load_dwordx4 v[124:127], v1, s[12:13] nt
    s_add_u32 s12, s12, 8192
    s_addc_u32 s13, s13, 0
    global_load_dwordx4 v[128:131], v1, s[12:13] nt
    s_add_u32 s12, s12, 8192
    s_addc_u32 s13, s13, 0
    global_load_dwordx4 v[132:135], v1, s[12:13] nt
    s_add_u32 s12, s12, 8192
    s_addc_u32 s13, s13, 0
    global_load_dwordx4 v[136:139], v1, s[12:13] nt
    s_add_u32 s12, s12, 8192
    s_addc_u32 s13, s13, 0
    global_load_dwordx4 v[140:143], v1, s[12:13] nt
    s_add_u32 s12, s12, 8192
    s_addc_u32 s13, s13, 0
    global_load_dwordx4 v[144:147], v1, s[12:13] nt
    s_add_u32 s12, s12, 8192
    s_addc_u32 s13, s13, 0
    global_load_dwordx4 v[148:151], v1, s[12:13] nt
    s_add_u32 s12, s12, 8192
    s_addc_u32 s13, s13, 0
    global_load_dwordx4 v[152:155], v1, s[12:13] nt
    s_add_u32 s12, s12, 8192
    s_addc_u32 s13, s13, 0
    global_load_dwordx4 v[156:159], v1, s[12:13] nt
    s_add_u32 s12, s12, 8192
    s_addc_u32 s13, s13, 0
    global_load_dwordx4 v[160:163], v1, s[12:13] nt
    s_add_u32 s12, s12, 8192
    s_addc_u32 s13, s13, 0
    global_load_dwordx4 v[164:167], v1, s[12:13] nt
    s_add_u32 s12, s12, 8192
    s_addc_u32 s13, s13, 0
    global_load_dwordx4 v[168:171], v1, s[12:13] nt
    s_add_u32 s12, s12, 8192
    s_addc_u32 s13, s13, 0
    global_load_dwordx4 v[172:175], v1, s[12:13] nt
    s_add_u32 s12, s12, 8192
    s_addc_u32 s13, s13, 0
    global_load_dwordx4 v[176:179], v1, s[12:13] nt
    s_add_u32 s12, s12, 8192
    s_addc_u32 s13, s13, 0
    s_barrier
    s_add_u32 s12, s4, s42
    s_addc_u32 s13, s5, 0
    global_load_dwordx4 v[180:183], v1, s[12:13] nt
    s_add_u32 s12, s12, 8192
    s_addc_u32 s13, s13, 0
    global_load_dwordx4 v[184:187], v1, s[12:13] nt
    s_add_u32 s12, s12, 8192
    s_addc_u32 s13, s13, 0
    global_load_dwordx4 v[188:191], v1, s[12:13] nt
    s_add_u32 s12, s12, 8192
    s_addc_u32 s13, s13, 0
    global_load_dwordx4 v[192:195], v1, s[12:13] nt
    s_add_u32 s12, s12, 8192
    s_addc_u32 s13, s13, 0
    global_load_dwordx4 v[196:199], v1, s[12:13] nt
    s_add_u32 s12, s12, 8192
    s_addc_u32 s13, s13, 0
    global_load_dwordx4 v[200:203], v1, s[12:13] nt
    s_add_u32 s12, s12, 8192
    s_addc_u32 s13, s13, 0
    global_load_dwordx4 v[204:207], v1, s[12:13] nt
    s_add_u32 s12, s12, 8192
    s_addc_u32 s13, s13, 0
    global_load_dwordx4 v[208:211], v1, s[12:13] nt
    s_add_u32 s12, s12, 8192
    s_addc_u32 s13, s13, 0
    global_load_dwordx4 v[212:215], v1, s[12:13] nt
    s_add_u32 s12, s12, 8192
    s_addc_u32 s13, s13, 0
    global_load_dwordx4 v[216:219], v1, s[12:13] nt
    s_add_u32 s12, s12, 8192
    s_addc_u32 s13, s13, 0
    global_load_dwordx4 v[220:223], v1, s[12:13] nt
    s_add_u32 s12, s12, 8192
    s_addc_u32 s13, s13, 0
    global_load_dwordx4 v[224:227], v1, s[12:13] nt
    s_add_u32 s12, s12, 8192
    s_addc_u32 s13, s13, 0
    global_load_dwordx4 v[228:231], v1, s[12:13] nt
    s_add_u32 s12, s12, 8192
    s_addc_u32 s13, s13, 0
    global_load_dwordx4 v[232:235], v1, s[12:13] nt
    s_add_u32 s12, s12, 8192
    s_addc_u32 s13, s13, 0
    global_load_dwordx4 v[236:239], v1, s[12:13] nt
    s_add_u32 s12, s12, 8192
    s_addc_u32 s13, s13, 0
    global_load_dwordx4 v[240:243], v1, s[12:13] nt
    s_add_u32 s12, s12, 8192
    s_addc_u32 s13, s13, 0
    s_barrier
    s_add_u32 s12, s4, s43
    s_addc_u32 s13, s5, 0
    global_load_dwordx4 v[244:247], v1, s[12:13] nt
    s_add_u32 s12, s12, 8192
    s_addc_u32 s13, s13, 0
    global_load_dwordx4 v[248:251], v1, s[12:13] nt
    s_add_u32 s12, s12, 8192
    s_addc_u32 s13, s13, 0
    global_load_dwordx4 v[252:255], v1, s[12:13] nt
    s_add_u32 s12, s12, 8192
    s_addc_u32 s13, s13, 0
    s_lshl_b32 s27, s27, 6
    s_add_u32 s26, s27, 32
    s_load_dwordx4 s[76:79], s[70:71], s26 glc
    s_add_u32 s26, s27, 32
    s_add_u32 s28, s27, 16
    v_mov_b32 v30, s28
    v_lshrrev_b32 v2, 4, v0
    v_lshlrev_b32 v2, 2, v2
    v_and_b32 v3, 15, v0
    v_lshlrev_b32 v3, 3, v3
    s_mov_b32 s21, 0x3f803f80
    s_mov_b32 s22, 0xffff0000
    s_lshl_b32 s17, s50, 1
    s_and_b32 s17, s17, 0xfffffffc
    s_load_dword s60, s[6:7], s17
    s_load_dword s61, s[8:9], s17
    s_lshl_b32 s17, s51, 1
    s_and_b32 s17, s17, 0xfffffffc
    s_load_dword s62, s[6:7], s17
    s_load_dword s63, s[8:9], s17
    s_lshl_b32 s17, s52, 1
    s_and_b32 s17, s17, 0xfffffffc
    s_load_dword s64, s[6:7], s17
    s_load_dword s65, s[8:9], s17
    s_lshl_b32 s17, s53, 1
    s_and_b32 s17, s17, 0xfffffffc
    s_load_dword s66, s[6:7], s17
    s_load_dword s67, s[8:9], s17
    s_lshl_b32 s17, s54, 1
    s_and_b32 s17, s17, 0xfffffffc
    s_load_dword s68, s[6:7], s17
    s_load_dword s69, s[8:9], s17
    s_lshl_b32 s17, s59, 1
    s_and_b32 s17, s17, 0xfffffffc
    s_load_dword s36, s[6:7], s17
    s_load_dword s37, s[8:9], s17
    v_mov_b32 v4, 0
    v_mov_b32 v5, 0
    v_mov_b32 v6, 0
    v_mov_b32 v7, 0
    s_waitcnt vmcnt(58)
    v_dot2c_f32_bf16 v4, s21, v36
    v_dot2c_f32_bf16 v5, s21, v37
    v_dot2c_f32_bf16 v6, s21, v38
    v_dot2c_f32_bf16 v7, s21, v39
    s_waitcnt vmcnt(57)
    v_dot2c_f32_bf16 v4, s21, v40
    v_dot2c_f32_bf16 v5, s21, v41
    v_dot2c_f32_bf16 v6, s21, v42
    v_dot2c_f32_bf16 v7, s21, v43
    s_waitcnt vmcnt(56)
    v_dot2c_f32_bf16 v4, s21, v44
    v_dot2c_f32_bf16 v5, s21, v45
    v_dot2c_f32_bf16 v6, s21, v46
    v_dot2c_f32_bf16 v7, s21, v47
    s_waitcnt vmcnt(55)
    v_dot2c_f32_bf16 v4, s21, v48
    v_dot2c_f32_bf16 v5, s21, v49
    v_dot2c_f32_bf16 v6, s21, v50
    v_dot2c_f32_bf16 v7, s21, v51
    s_nop 2
    v_add_f32 v4, v4, v5
    v_add_f32 v6, v6, v7
    v_add_f32 v4, v4, v6
    s_nop 1
    v_add_f32_dpp v5, v4, v4 row_ror:8 row_mask:0xf bank_mask:0xf
    s_nop 1
    v_add_f32_dpp v4, v5, v5 row_ror:4 row_mask:0xf bank_mask:0xf
    s_nop 1
    v_add_f32_dpp v5, v4, v4 row_ror:2 row_mask:0xf bank_mask:0xf
    s_nop 1
    v_add_f32_dpp v4, v5, v5 row_ror:1 row_mask:0xf bank_mask:0xf
    ds_write_b32 v2, v4 offset:0
    s_waitcnt lgkmcnt(0)
    s_barrier
    ds_read_b64 v[4:5], v3 offset:0
    s_waitcnt lgkmcnt(0)
    v_add_f32 v4, v4, v5
    s_nop 1
    v_add_f32_dpp v5, v4, v4 row_ror:8 row_mask:0xf bank_mask:0xf
    s_nop 1
    v_add_f32_dpp v4, v5, v5 row_ror:4 row_mask:0xf bank_mask:0xf
    s_nop 1
    v_add_f32_dpp v5, v4, v4 row_ror:2 row_mask:0xf bank_mask:0xf
    s_nop 1
    v_add_f32_dpp v4, v5, v5 row_ror:1 row_mask:0xf bank_mask:0xf
    v_mov_b32 v28, v4
    v_mul_f32 v20, 0x38800000, v4
    v_mov_b32 v4, 0
    v_mov_b32 v5, 0
    v_mov_b32 v6, 0
    v_mov_b32 v7, 0
    v_lshlrev_b32 v12, 16, v36
    v_and_b32 v13, s22, v36
    v_lshlrev_b32 v14, 16, v37
    v_and_b32 v15, s22, v37
    v_lshlrev_b32 v16, 16, v38
    v_and_b32 v17, s22, v38
    v_lshlrev_b32 v18, 16, v39
    v_and_b32 v19, s22, v39
    v_pk_add_f32 v[12:13], v[12:13], v[20:21] op_sel_hi:[1,0] neg_lo:[0,1] neg_hi:[0,1]
    v_pk_add_f32 v[14:15], v[14:15], v[20:21] op_sel_hi:[1,0] neg_lo:[0,1] neg_hi:[0,1]
    v_pk_add_f32 v[16:17], v[16:17], v[20:21] op_sel_hi:[1,0] neg_lo:[0,1] neg_hi:[0,1]
    v_pk_add_f32 v[18:19], v[18:19], v[20:21] op_sel_hi:[1,0] neg_lo:[0,1] neg_hi:[0,1]
    v_pk_fma_f32 v[4:5], v[12:13], v[12:13], v[4:5]
    v_pk_fma_f32 v[6:7], v[14:15], v[14:15], v[6:7]
    v_pk_fma_f32 v[4:5], v[16:17], v[16:17], v[4:5]
    v_pk_fma_f32 v[6:7], v[18:19], v[18:19], v[6:7]
    v_lshlrev_b32 v12, 16, v40
    v_and_b32 v13, s22, v40
    v_lshlrev_b32 v14, 16, v41
    v_and_b32 v15, s22, v41
    v_lshlrev_b32 v16, 16, v42
    v_and_b32 v17, s22, v42
    v_lshlrev_b32 v18, 16, v43
    v_and_b32 v19, s22, v43
    v_pk_add_f32 v[12:13], v[12:13], v[20:21] op_sel_hi:[1,0] neg_lo:[0,1] neg_hi:[0,1]
    v_pk_add_f32 v[14:15], v[14:15], v[20:21] op_sel_hi:[1,0] neg_lo:[0,1] neg_hi:[0,1]
    v_pk_add_f32 v[16:17], v[16:17], v[20:21] op_sel_hi:[1,0] neg_lo:[0,1] neg_hi:[0,1]
    v_pk_add_f32 v[18:19], v[18:19], v[20:21] op_sel_hi:[1,0] neg_lo:[0,1] neg_hi:[0,1]
    v_pk_fma_f32 v[4:5], v[12:13], v[12:13], v[4:5]
    v_pk_fma_f32 v[6:7], v[14:15], v[14:15], v[6:7]
    v_pk_fma_f32 v[4:5], v[16:17], v[16:17], v[4:5]
    v_pk_fma_f32 v[6:7], v[18:19], v[18:19], v[6:7]
    v_lshlrev_b32 v12, 16, v44
    v_and_b32 v13, s22, v44
    v_lshlrev_b32 v14, 16, v45
    v_and_b32 v15, s22, v45
    v_lshlrev_b32 v16, 16, v46
    v_and_b32 v17, s22, v46
    v_lshlrev_b32 v18, 16, v47
    v_and_b32 v19, s22, v47
    v_pk_add_f32 v[12:13], v[12:13], v[20:21] op_sel_hi:[1,0] neg_lo:[0,1] neg_hi:[0,1]
    v_pk_add_f32 v[14:15], v[14:15], v[20:21] op_sel_hi:[1,0] neg_lo:[0,1] neg_hi:[0,1]
    v_pk_add_f32 v[16:17], v[16:17], v[20:21] op_sel_hi:[1,0] neg_lo:[0,1] neg_hi:[0,1]
    v_pk_add_f32 v[18:19], v[18:19], v[20:21] op_sel_hi:[1,0] neg_lo:[0,1] neg_hi:[0,1]
    v_pk_fma_f32 v[4:5], v[12:13], v[12:13], v[4:5]
    v_pk_fma_f32 v[6:7], v[14:15], v[14:15], v[6:7]
    v_pk_fma_f32 v[4:5], v[16:17], v[16:17], v[4:5]
    v_pk_fma_f32 v[6:7], v[18:19], v[18:19], v[6:7]
    v_lshlrev_b32 v12, 16, v48
    v_and_b32 v13, s22, v48
    v_lshlrev_b32 v14, 16, v49
    v_and_b32 v15, s22, v49
    v_lshlrev_b32 v16, 16, v50
    v_and_b32 v17, s22, v50
    v_lshlrev_b32 v18, 16, v51
    v_and_b32 v19, s22, v51
    v_pk_add_f32 v[12:13], v[12:13], v[20:21] op_sel_hi:[1,0] neg_lo:[0,1] neg_hi:[0,1]
    v_pk_add_f32 v[14:15], v[14:15], v[20:21] op_sel_hi:[1,0] neg_lo:[0,1] neg_hi:[0,1]
    v_pk_add_f32 v[16:17], v[16:17], v[20:21] op_sel_hi:[1,0] neg_lo:[0,1] neg_hi:[0,1]
    v_pk_add_f32 v[18:19], v[18:19], v[20:21] op_sel_hi:[1,0] neg_lo:[0,1] neg_hi:[0,1]
    v_pk_fma_f32 v[4:5], v[12:13], v[12:13], v[4:5]
    v_pk_fma_f32 v[6:7], v[14:15], v[14:15], v[6:7]
    v_pk_fma_f32 v[4:5], v[16:17], v[16:17], v[4:5]
    v_pk_fma_f32 v[6:7], v[18:19], v[18:19], v[6:7]
    s_nop 2
    v_add_f32 v4, v4, v5
    v_add_f32 v6, v6, v7
    v_add_f32 v4, v4, v6
    s_nop 1
    v_add_f32_dpp v5, v4, v4 row_ror:8 row_mask:0xf bank_mask:0xf
    s_nop 1
    v_add_f32_dpp v4, v5, v5 row_ror:4 row_mask:0xf bank_mask:0xf
    s_nop 1
    v_add_f32_dpp v5, v4, v4 row_ror:2 row_mask:0xf bank_mask:0xf
    s_nop 1
    v_add_f32_dpp v4, v5, v5 row_ror:1 row_mask:0xf bank_mask:0xf
    ds_write_b32 v2, v4 offset:512
    s_waitcnt lgkmcnt(0)
    s_barrier
    ds_read_b64 v[4:5], v3 offset:512
    s_waitcnt lgkmcnt(0)
    v_add_f32 v4, v4, v5
    s_nop 1
    v_add_f32_dpp v5, v4, v4 row_ror:8 row_mask:0xf bank_mask:0xf
    s_nop 1
    v_add_f32_dpp v4, v5, v5 row_ror:4 row_mask:0xf bank_mask:0xf
    s_nop 1
    v_add_f32_dpp v5, v4, v4 row_ror:2 row_mask:0xf bank_mask:0xf
    s_nop 1
    v_add_f32_dpp v4, v5, v5 row_ror:1 row_mask:0xf bank_mask:0xf
    v_mov_b32 v29, v4
    s_mul_i32 s24, s76, 0x9e3779b1
    s_add_u32 s24, s24, 0x7f4a7c15
    s_mul_i32 s25, s77, 0x85ebca6d
    s_add_u32 s25, s25, 0x165667b1
    s_mul_i32 s18, s78, 0x9e3779b1
    s_add_u32 s18, s18, 0x7f4a7c15
    s_mul_i32 s19, s79, 0x85ebca6d
    s_add_u32 s19, s19, 0x165667b1
    v_mov_b32 v12, v28
    v_mov_b32 v13, s24
    v_mov_b32 v14, v29
    v_mov_b32 v15, s25
    s_add_u32 s28, s27, 0
    v_mov_b32 v16, s28
    s_cmp_lg_u32 s3, 0
    s_cbranch_scc1 L_nopub0
    s_mov_b64 exec, 1
    global_store_dwordx4 v16, v[12:15], s[70:71] sc0 sc1
    s_mov_b64 exec, -1
L_nopub0:
    s_nop 1
    v_mov_b32 v4, 0
    v_mov_b32 v5, 0
    v_mov_b32 v6, 0
    v_mov_b32 v7, 0
    s_waitcnt vmcnt(50)
    v_dot2c_f32_bf16 v4, s21, v52
    v_dot2c_f32_bf16 v5, s21, v53
    v_dot2c_f32_bf16 v6, s21, v54
    v_dot2c_f32_bf16 v7, s21, v55
    s_waitcnt vmcnt(49)
    v_dot2c_f32_bf16 v4, s21, v56
    v_dot2c_f32_bf16 v5, s21, v57
    v_dot2c_f32_bf16 v6, s21, v58
    v_dot2c_f32_bf16 v7, s21, v59
    s_waitcnt vmcnt(48)
    v_dot2c_f32_bf16 v4, s21, v60
    v_dot2c_f32_bf16 v5, s21, v61
    v_dot2c_f32_bf16 v6, s21, v62
    v_dot2c_f32_bf16 v7, s21, v63
    s_waitcnt vmcnt(47)
    v_dot2c_f32_bf16 v4, s21, v64
    v_dot2c_f32_bf16 v5, s21, v65
    v_dot2c_f32_bf16 v6, s21, v66
    v_dot2c_f32_bf16 v7, s21, v67
    s_waitcnt vmcnt(46)
    v_dot2c_f32_bf16 v4, s21, v68
    v_dot2c_f32_bf16 v5, s21, v69
    v_dot2c_f32_bf16 v6, s21, v70
    v_dot2c_f32_bf16 v7, s21, v71
    s_waitcnt vmcnt(45)
    v_dot2c_f32_bf16 v4, s21, v72
    v_dot2c_f32_bf16 v5, s21, v73
    v_dot2c_f32_bf16 v6, s21, v74
    v_dot2c_f32_bf16 v7, s21, v75
    s_waitcnt vmcnt(44)
    v_dot2c_f32_bf16 v4, s21, v76
    v_dot2c_f32_bf16 v5, s21, v77
    v_dot2c_f32_bf16 v6, s21, v78
    v_dot2c_f32_bf16 v7, s21, v79
    s_waitcnt vmcnt(43)
    v_dot2c_f32_bf16 v4, s21, v80
    v_dot2c_f32_bf16 v5, s21, v81
    v_dot2c_f32_bf16 v6, s21, v82
    v_dot2c_f32_bf16 v7, s21, v83
    s_waitcnt vmcnt(42)
    v_dot2c_f32_bf16 v4, s21, v84
    v_dot2c_f32_bf16 v5, s21, v85
    v_dot2c_f32_bf16 v6, s21, v86
    v_dot2c_f32_bf16 v7, s21, v87
    s_waitcnt vmcnt(41)
    v_dot2c_f32_bf16 v4, s21, v88
    v_dot2c_f32_bf16 v5, s21, v89
    v_dot2c_f32_bf16 v6, s21, v90
    v_dot2c_f32_bf16 v7, s21, v91
    s_waitcnt vmcnt(40)
    v_dot2c_f32_bf16 v4, s21, v92
    v_dot2c_f32_bf16 v5, s21, v93
    v_dot2c_f32_bf16 v6, s21, v94
    v_dot2c_f32_bf16 v7, s21, v95
    s_waitcnt vmcnt(39)
    v_dot2c_f32_bf16 v4, s21, v96
    v_dot2c_f32_bf16 v5, s21, v97
    v_dot2c_f32_bf16 v6, s21, v98
    v_dot2c_f32_bf16 v7, s21, v99
    s_waitcnt vmcnt(38)
    v_dot2c_f32_bf16 v4, s21, v100
    v_dot2c_f32_bf16 v5, s21, v101
    v_dot2c_f32_bf16 v6, s21, v102
    v_dot2c_f32_bf16 v7, s21, v103
    s_waitcnt vmcnt(37)
    v_dot2c_f32_bf16 v4, s21, v104
    v_dot2c_f32_bf16 v5, s21, v105
    v_dot2c_f32_bf16 v6, s21, v106
    v_dot2c_f32_bf16 v7, s21, v107
    s_waitcnt vmcnt(36)
    v_dot2c_f32_bf16 v4, s21, v108
    v_dot2c_f32_bf16 v5, s21, v109
    v_dot2c_f32_bf16 v6, s21, v110
    v_dot2c_f32_bf16 v7, s21, v111
    s_waitcnt vmcnt(35)
    v_dot2c_f32_bf16 v4, s21, v112
    v_dot2c_f32_bf16 v5, s21, v113
    v_dot2c_f32_bf16 v6, s21, v114
    v_dot2c_f32_bf16 v7, s21, v115
    s_nop 2
    v_add_f32 v4, v4, v5
    v_add_f32 v6, v6, v7
    v_add_f32 v4, v4, v6
    s_nop 1
    v_add_f32_dpp v5, v4, v4 row_ror:8 row_mask:0xf bank_mask:0xf
    s_nop 1
    v_add_f32_dpp v4, v5, v5 row_ror:4 row_mask:0xf bank_mask:0xf
    s_nop 1
    v_add_f32_dpp v5, v4, v4 row_ror:2 row_mask:0xf bank_mask:0xf
    s_nop 1
    v_add_f32_dpp v4, v5, v5 row_ror:1 row_mask:0xf bank_mask:0xf
    ds_write_b32 v2, v4 offset:0
    s_waitcnt lgkmcnt(0)
    s_barrier
    ds_read_b64 v[4:5], v3 offset:0
    s_waitcnt lgkmcnt(0)
    v_add_f32 v4, v4, v5
    s_nop 1
    v_add_f32_dpp v5, v4, v4 row_ror:8 row_mask:0xf bank_mask:0xf
    s_nop 1
    v_add_f32_dpp v4, v5, v5 row_ror:4 row_mask:0xf bank_mask:0xf
    s_nop 1
    v_add_f32_dpp v5, v4, v4 row_ror:2 row_mask:0xf bank_mask:0xf
    s_nop 1
    v_add_f32_dpp v4, v5, v5 row_ror:1 row_mask:0xf bank_mask:0xf
    v_mul_f32 v4, 0x37800000, v4
    v_cvt_pk_bf16_f32 v4, v4, v4
    v_lshlrev_b32 v20, 16, v4
    v_mov_b32 v4, 0
    v_mov_b32 v5, 0
    v_mov_b32 v6, 0
    v_mov_b32 v7, 0
    v_lshlrev_b32 v12, 16, v52
    v_and_b32 v13, s22, v52
    v_lshlrev_b32 v14, 16, v53
    v_and_b32 v15, s22, v53
    v_lshlrev_b32 v16, 16, v54
    v_and_b32 v17, s22, v54
    v_lshlrev_b32 v18, 16, v55
    v_and_b32 v19, s22, v55
    v_pk_add_f32 v[12:13], v[12:13], v[20:21] op_sel_hi:[1,0] neg_lo:[0,1] neg_hi:[0,1]
    v_pk_add_f32 v[14:15], v[14:15], v[20:21] op_sel_hi:[1,0] neg_lo:[0,1] neg_hi:[0,1]
    v_pk_add_f32 v[16:17], v[16:17], v[20:21] op_sel_hi:[1,0] neg_lo:[0,1] neg_hi:[0,1]
    v_pk_add_f32 v[18:19], v[18:19], v[20:21] op_sel_hi:[1,0] neg_lo:[0,1] neg_hi:[0,1]
    v_cvt_pk_bf16_f32 v52, v12, v13
    v_cvt_pk_bf16_f32 v53, v14, v15
    v_cvt_pk_bf16_f32 v54, v16, v17
    v_cvt_pk_bf16_f32 v55, v18, v19
    v_dot2c_f32_bf16 v4, v52, v52
    v_dot2c_f32_bf16 v5, v53, v53
    v_dot2c_f32_bf16 v6, v54, v54
    v_dot2c_f32_bf16 v7, v55, v55
    v_lshlrev_b32 v12, 16, v56
    v_and_b32 v13, s22, v56
    v_lshlrev_b32 v14, 16, v57
    v_and_b32 v15, s22, v57
    v_lshlrev_b32 v16, 16, v58
    v_and_b32 v17, s22, v58
    v_lshlrev_b32 v18, 16, v59
    v_and_b32 v19, s22, v59
    v_pk_add_f32 v[12:13], v[12:13], v[20:21] op_sel_hi:[1,0] neg_lo:[0,1] neg_hi:[0,1]
    v_pk_add_f32 v[14:15], v[14:15], v[20:21] op_sel_hi:[1,0] neg_lo:[0,1] neg_hi:[0,1]
    v_pk_add_f32 v[16:17], v[16:17], v[20:21] op_sel_hi:[1,0] neg_lo:[0,1] neg_hi:[0,1]
    v_pk_add_f32 v[18:19], v[18:19], v[20:21] op_sel_hi:[1,0] neg_lo:[0,1] neg_hi:[0,1]
    v_cvt_pk_bf16_f32 v56, v12, v13
    v_cvt_pk_bf16_f32 v57, v14, v15
    v_cvt_pk_bf16_f32 v58, v16, v17
    v_cvt_pk_bf16_f32 v59, v18, v19
    v_dot2c_f32_bf16 v4, v56, v56
    v_dot2c_f32_bf16 v5, v57, v57
    v_dot2c_f32_bf16 v6, v58, v58
    v_dot2c_f32_bf16 v7, v59, v59
    v_lshlrev_b32 v12, 16, v60
    v_and_b32 v13, s22, v60
    v_lshlrev_b32 v14, 16, v61
    v_and_b32 v15, s22, v61
    v_lshlrev_b32 v16, 16, v62
    v_and_b32 v17, s22, v62
    v_lshlrev_b32 v18, 16, v63
    v_and_b32 v19, s22, v63
    v_pk_add_f32 v[12:13], v[12:13], v[20:21] op_sel_hi:[1,0] neg_lo:[0,1] neg_hi:[0,1]
    v_pk_add_f32 v[14:15], v[14:15], v[20:21] op_sel_hi:[1,0] neg_lo:[0,1] neg_hi:[0,1]
    v_pk_add_f32 v[16:17], v[16:17], v[20:21] op_sel_hi:[1,0] neg_lo:[0,1] neg_hi:[0,1]
    v_pk_add_f32 v[18:19], v[18:19], v[20:21] op_sel_hi:[1,0] neg_lo:[0,1] neg_hi:[0,1]
    v_cvt_pk_bf16_f32 v60, v12, v13
    v_cvt_pk_bf16_f32 v61, v14, v15
    v_cvt_pk_bf16_f32 v62, v16, v17
    v_cvt_pk_bf16_f32 v63, v18, v19
    v_dot2c_f32_bf16 v4, v60, v60
    v_dot2c_f32_bf16 v5, v61, v61
    v_dot2c_f32_bf16 v6, v62, v62
    v_dot2c_f32_bf16 v7, v63, v63
    v_lshlrev_b32 v12, 16, v64
    v_and_b32 v13, s22, v64
    v_lshlrev_b32 v14, 16, v65
    v_and_b32 v15, s22, v65
    v_lshlrev_b32 v16, 16, v66
    v_and_b32 v17, s22, v66
    v_lshlrev_b32 v18, 16, v67
    v_and_b32 v19, s22, v67
    v_pk_add_f32 v[12:13], v[12:13], v[20:21] op_sel_hi:[1,0] neg_lo:[0,1] neg_hi:[0,1]
    v_pk_add_f32 v[14:15], v[14:15], v[20:21] op_sel_hi:[1,0] neg_lo:[0,1] neg_hi:[0,1]
    v_pk_add_f32 v[16:17], v[16:17], v[20:21] op_sel_hi:[1,0] neg_lo:[0,1] neg_hi:[0,1]
    v_pk_add_f32 v[18:19], v[18:19], v[20:21] op_sel_hi:[1,0] neg_lo:[0,1] neg_hi:[0,1]
    v_cvt_pk_bf16_f32 v64, v12, v13
    v_cvt_pk_bf16_f32 v65, v14, v15
    v_cvt_pk_bf16_f32 v66, v16, v17
    v_cvt_pk_bf16_f32 v67, v18, v19
    v_dot2c_f32_bf16 v4, v64, v64
    v_dot2c_f32_bf16 v5, v65, v65
    v_dot2c_f32_bf16 v6, v66, v66
    v_dot2c_f32_bf16 v7, v67, v67
    v_lshlrev_b32 v12, 16, v68
    v_and_b32 v13, s22, v68
    v_lshlrev_b32 v14, 16, v69
    v_and_b32 v15, s22, v69
    v_lshlrev_b32 v16, 16, v70
    v_and_b32 v17, s22, v70
    v_lshlrev_b32 v18, 16, v71
    v_and_b32 v19, s22, v71
    v_pk_add_f32 v[12:13], v[12:13], v[20:21] op_sel_hi:[1,0] neg_lo:[0,1] neg_hi:[0,1]
    v_pk_add_f32 v[14:15], v[14:15], v[20:21] op_sel_hi:[1,0] neg_lo:[0,1] neg_hi:[0,1]
    v_pk_add_f32 v[16:17], v[16:17], v[20:21] op_sel_hi:[1,0] neg_lo:[0,1] neg_hi:[0,1]
    v_pk_add_f32 v[18:19], v[18:19], v[20:21] op_sel_hi:[1,0] neg_lo:[0,1] neg_hi:[0,1]
    v_cvt_pk_bf16_f32 v68, v12, v13
    v_cvt_pk_bf16_f32 v69, v14, v15
    v_cvt_pk_bf16_f32 v70, v16, v17
    v_cvt_pk_bf16_f32 v71, v18, v19
    v_dot2c_f32_bf16 v4, v68, v68
    v_dot2c_f32_bf16 v5, v69, v69
    v_dot2c_f32_bf16 v6, v70, v70
    v_dot2c_f32_bf16 v7, v71, v71
    v_lshlrev_b32 v12, 16, v72
    v_and_b32 v13, s22, v72
    v_lshlrev_b32 v14, 16, v73
    v_and_b32 v15, s22, v73
    v_lshlrev_b32 v16, 16, v74
    v_and_b32 v17, s22, v74
    v_lshlrev_b32 v18, 16, v75
    v_and_b32 v19, s22, v75
    v_pk_add_f32 v[12:13], v[12:13], v[20:21] op_sel_hi:[1,0] neg_lo:[0,1] neg_hi:[0,1]
    v_pk_add_f32 v[14:15], v[14:15], v[20:21] op_sel_hi:[1,0] neg_lo:[0,1] neg_hi:[0,1]
    v_pk_add_f32 v[16:17], v[16:17], v[20:21] op_sel_hi:[1,0] neg_lo:[0,1] neg_hi:[0,1]
    v_pk_add_f32 v[18:19], v[18:19], v[20:21] op_sel_hi:[1,0] neg_lo:[0,1] neg_hi:[0,1]
    v_cvt_pk_bf16_f32 v72, v12, v13
    v_cvt_pk_bf16_f32 v73, v14, v15
    v_cvt_pk_bf16_f32 v74, v16, v17
    v_cvt_pk_bf16_f32 v75, v18, v19
    v_dot2c_f32_bf16 v4, v72, v72
    v_dot2c_f32_bf16 v5, v73, v73
    v_dot2c_f32_bf16 v6, v74, v74
    v_dot2c_f32_bf16 v7, v75, v75
    v_lshlrev_b32 v12, 16, v76
    v_and_b32 v13, s22, v76
    v_lshlrev_b32 v14, 16, v77
    v_and_b32 v15, s22, v77
    v_lshlrev_b32 v16, 16, v78
    v_and_b32 v17, s22, v78
    v_lshlrev_b32 v18, 16, v79
    v_and_b32 v19, s22, v79
    v_pk_add_f32 v[12:13], v[12:13], v[20:21] op_sel_hi:[1,0] neg_lo:[0,1] neg_hi:[0,1]
    v_pk_add_f32 v[14:15], v[14:15], v[20:21] op_sel_hi:[1,0] neg_lo:[0,1] neg_hi:[0,1]
    v_pk_add_f32 v[16:17], v[16:17], v[20:21] op_sel_hi:[1,0] neg_lo:[0,1] neg_hi:[0,1]
    v_pk_add_f32 v[18:19], v[18:19], v[20:21] op_sel_hi:[1,0] neg_lo:[0,1] neg_hi:[0,1]
    v_cvt_pk_bf16_f32 v76, v12, v13
    v_cvt_pk_bf16_f32 v77, v14, v15
    v_cvt_pk_bf16_f32 v78, v16, v17
    v_cvt_pk_bf16_f32 v79, v18, v19
    v_dot2c_f32_bf16 v4, v76, v76
    v_dot2c_f32_bf16 v5, v77, v77
    v_dot2c_f32_bf16 v6, v78, v78
    v_dot2c_f32_bf16 v7, v79, v79
    v_lshlrev_b32 v12, 16, v80
    v_and_b32 v13, s22, v80
    v_lshlrev_b32 v14, 16, v81
    v_and_b32 v15, s22, v81
    v_lshlrev_b32 v16, 16, v82
    v_and_b32 v17, s22, v82
    v_lshlrev_b32 v18, 16, v83
    v_and_b32 v19, s22, v83
    v_pk_add_f32 v[12:13], v[12:13], v[20:21] op_sel_hi:[1,0] neg_lo:[0,1] neg_hi:[0,1]
    v_pk_add_f32 v[14:15], v[14:15], v[20:21] op_sel_hi:[1,0] neg_lo:[0,1] neg_hi:[0,1]
    v_pk_add_f32 v[16:17], v[16:17], v[20:21] op_sel_hi:[1,0] neg_lo:[0,1] neg_hi:[0,1]
    v_pk_add_f32 v[18:19], v[18:19], v[20:21] op_sel_hi:[1,0] neg_lo:[0,1] neg_hi:[0,1]
    v_cvt_pk_bf16_f32 v80, v12, v13
    v_cvt_pk_bf16_f32 v81, v14, v15
    v_cvt_pk_bf16_f32 v82, v16, v17
    v_cvt_pk_bf16_f32 v83, v18, v19
    v_dot2c_f32_bf16 v4, v80, v80
    v_dot2c_f32_bf16 v5, v81, v81
    v_dot2c_f32_bf16 v6, v82, v82
    v_dot2c_f32_bf16 v7, v83, v83
    v_lshlrev_b32 v12, 16, v84
    v_and_b32 v13, s22, v84
    v_lshlrev_b32 v14, 16, v85
    v_and_b32 v15, s22, v85
    v_lshlrev_b32 v16, 16, v86
    v_and_b32 v17, s22, v86
    v_lshlrev_b32 v18, 16, v87
    v_and_b32 v19, s22, v87
    v_pk_add_f32 v[12:13], v[12:13], v[20:21] op_sel_hi:[1,0] neg_lo:[0,1] neg_hi:[0,1]
    v_pk_add_f32 v[14:15], v[14:15], v[20:21] op_sel_hi:[1,0] neg_lo:[0,1] neg_hi:[0,1]
    v_pk_add_f32 v[16:17], v[16:17], v[20:21] op_sel_hi:[1,0] neg_lo:[0,1] neg_hi:[0,1]
    v_pk_add_f32 v[18:19], v[18:19], v[20:21] op_sel_hi:[1,0] neg_lo:[0,1] neg_hi:[0,1]
    v_cvt_pk_bf16_f32 v84, v12, v13
    v_cvt_pk_bf16_f32 v85, v14, v15
    v_cvt_pk_bf16_f32 v86, v16, v17
    v_cvt_pk_bf16_f32 v87, v18, v19
    v_dot2c_f32_bf16 v4, v84, v84
    v_dot2c_f32_bf16 v5, v85, v85
    v_dot2c_f32_bf16 v6, v86, v86
    v_dot2c_f32_bf16 v7, v87, v87
    v_lshlrev_b32 v12, 16, v88
    v_and_b32 v13, s22, v88
    v_lshlrev_b32 v14, 16, v89
    v_and_b32 v15, s22, v89
    v_lshlrev_b32 v16, 16, v90
    v_and_b32 v17, s22, v90
    v_lshlrev_b32 v18, 16, v91
    v_and_b32 v19, s22, v91
    v_pk_add_f32 v[12:13], v[12:13], v[20:21] op_sel_hi:[1,0] neg_lo:[0,1] neg_hi:[0,1]
    v_pk_add_f32 v[14:15], v[14:15], v[20:21] op_sel_hi:[1,0] neg_lo:[0,1] neg_hi:[0,1]
    v_pk_add_f32 v[16:17], v[16:17], v[20:21] op_sel_hi:[1,0] neg_lo:[0,1] neg_hi:[0,1]
    v_pk_add_f32 v[18:19], v[18:19], v[20:21] op_sel_hi:[1,0] neg_lo:[0,1] neg_hi:[0,1]
    v_cvt_pk_bf16_f32 v88, v12, v13
    v_cvt_pk_bf16_f32 v89, v14, v15
    v_cvt_pk_bf16_f32 v90, v16, v17
    v_cvt_pk_bf16_f32 v91, v18, v19
    v_dot2c_f32_bf16 v4, v88, v88
    v_dot2c_f32_bf16 v5, v89, v89
    v_dot2c_f32_bf16 v6, v90, v90
    v_dot2c_f32_bf16 v7, v91, v91
    v_lshlrev_b32 v12, 16, v92
    v_and_b32 v13, s22, v92
    v_lshlrev_b32 v14, 16, v93
    v_and_b32 v15, s22, v93
    v_lshlrev_b32 v16, 16, v94
    v_and_b32 v17, s22, v94
    v_lshlrev_b32 v18, 16, v95
    v_and_b32 v19, s22, v95
    v_pk_add_f32 v[12:13], v[12:13], v[20:21] op_sel_hi:[1,0] neg_lo:[0,1] neg_hi:[0,1]
    v_pk_add_f32 v[14:15], v[14:15], v[20:21] op_sel_hi:[1,0] neg_lo:[0,1] neg_hi:[0,1]
    v_pk_add_f32 v[16:17], v[16:17], v[20:21] op_sel_hi:[1,0] neg_lo:[0,1] neg_hi:[0,1]
    v_pk_add_f32 v[18:19], v[18:19], v[20:21] op_sel_hi:[1,0] neg_lo:[0,1] neg_hi:[0,1]
    v_cvt_pk_bf16_f32 v92, v12, v13
    v_cvt_pk_bf16_f32 v93, v14, v15
    v_cvt_pk_bf16_f32 v94, v16, v17
    v_cvt_pk_bf16_f32 v95, v18, v19
    v_dot2c_f32_bf16 v4, v92, v92
    v_dot2c_f32_bf16 v5, v93, v93
    v_dot2c_f32_bf16 v6, v94, v94
    v_dot2c_f32_bf16 v7, v95, v95
    v_lshlrev_b32 v12, 16, v96
    v_and_b32 v13, s22, v96
    v_lshlrev_b32 v14, 16, v97
    v_and_b32 v15, s22, v97
    v_lshlrev_b32 v16, 16, v98
    v_and_b32 v17, s22, v98
    v_lshlrev_b32 v18, 16, v99
    v_and_b32 v19, s22, v99
    v_pk_add_f32 v[12:13], v[12:13], v[20:21] op_sel_hi:[1,0] neg_lo:[0,1] neg_hi:[0,1]
    v_pk_add_f32 v[14:15], v[14:15], v[20:21] op_sel_hi:[1,0] neg_lo:[0,1] neg_hi:[0,1]
    v_pk_add_f32 v[16:17], v[16:17], v[20:21] op_sel_hi:[1,0] neg_lo:[0,1] neg_hi:[0,1]
    v_pk_add_f32 v[18:19], v[18:19], v[20:21] op_sel_hi:[1,0] neg_lo:[0,1] neg_hi:[0,1]
    v_cvt_pk_bf16_f32 v96, v12, v13
    v_cvt_pk_bf16_f32 v97, v14, v15
    v_cvt_pk_bf16_f32 v98, v16, v17
    v_cvt_pk_bf16_f32 v99, v18, v19
    v_dot2c_f32_bf16 v4, v96, v96
    v_dot2c_f32_bf16 v5, v97, v97
    v_dot2c_f32_bf16 v6, v98, v98
    v_dot2c_f32_bf16 v7, v99, v99
    v_lshlrev_b32 v12, 16, v100
    v_and_b32 v13, s22, v100
    v_lshlrev_b32 v14, 16, v101
    v_and_b32 v15, s22, v101
    v_lshlrev_b32 v16, 16, v102
    v_and_b32 v17, s22, v102
    v_lshlrev_b32 v18, 16, v103
    v_and_b32 v19, s22, v103
    v_pk_add_f32 v[12:13], v[12:13], v[20:21] op_sel_hi:[1,0] neg_lo:[0,1] neg_hi:[0,1]
    v_pk_add_f32 v[14:15], v[14:15], v[20:21] op_sel_hi:[1,0] neg_lo:[0,1] neg_hi:[0,1]
    v_pk_add_f32 v[16:17], v[16:17], v[20:21] op_sel_hi:[1,0] neg_lo:[0,1] neg_hi:[0,1]
    v_pk_add_f32 v[18:19], v[18:19], v[20:21] op_sel_hi:[1,0] neg_lo:[0,1] neg_hi:[0,1]
    v_cvt_pk_bf16_f32 v100, v12, v13
    v_cvt_pk_bf16_f32 v101, v14, v15
    v_cvt_pk_bf16_f32 v102, v16, v17
    v_cvt_pk_bf16_f32 v103, v18, v19
    v_dot2c_f32_bf16 v4, v100, v100
    v_dot2c_f32_bf16 v5, v101, v101
    v_dot2c_f32_bf16 v6, v102, v102
    v_dot2c_f32_bf16 v7, v103, v103
    v_lshlrev_b32 v12, 16, v104
    v_and_b32 v13, s22, v104
    v_lshlrev_b32 v14, 16, v105
    v_and_b32 v15, s22, v105
    v_lshlrev_b32 v16, 16, v106
    v_and_b32 v17, s22, v106
    v_lshlrev_b32 v18, 16, v107
    v_and_b32 v19, s22, v107
    v_pk_add_f32 v[12:13], v[12:13], v[20:21] op_sel_hi:[1,0] neg_lo:[0,1] neg_hi:[0,1]
    v_pk_add_f32 v[14:15], v[14:15], v[20:21] op_sel_hi:[1,0] neg_lo:[0,1] neg_hi:[0,1]
    v_pk_add_f32 v[16:17], v[16:17], v[20:21] op_sel_hi:[1,0] neg_lo:[0,1] neg_hi:[0,1]
    v_pk_add_f32 v[18:19], v[18:19], v[20:21] op_sel_hi:[1,0] neg_lo:[0,1] neg_hi:[0,1]
    v_cvt_pk_bf16_f32 v104, v12, v13
    v_cvt_pk_bf16_f32 v105, v14, v15
    v_cvt_pk_bf16_f32 v106, v16, v17
    v_cvt_pk_bf16_f32 v107, v18, v19
    v_dot2c_f32_bf16 v4, v104, v104
    v_dot2c_f32_bf16 v5, v105, v105
    v_dot2c_f32_bf16 v6, v106, v106
    v_dot2c_f32_bf16 v7, v107, v107
    v_lshlrev_b32 v12, 16, v108
    v_and_b32 v13, s22, v108
    v_lshlrev_b32 v14, 16, v109
    v_and_b32 v15, s22, v109
    v_lshlrev_b32 v16, 16, v110
    v_and_b32 v17, s22, v110
    v_lshlrev_b32 v18, 16, v111
    v_and_b32 v19, s22, v111
    v_pk_add_f32 v[12:13], v[12:13], v[20:21] op_sel_hi:[1,0] neg_lo:[0,1] neg_hi:[0,1]
    v_pk_add_f32 v[14:15], v[14:15], v[20:21] op_sel_hi:[1,0] neg_lo:[0,1] neg_hi:[0,1]
    v_pk_add_f32 v[16:17], v[16:17], v[20:21] op_sel_hi:[1,0] neg_lo:[0,1] neg_hi:[0,1]
    v_pk_add_f32 v[18:19], v[18:19], v[20:21] op_sel_hi:[1,0] neg_lo:[0,1] neg_hi:[0,1]
    v_cvt_pk_bf16_f32 v108, v12, v13
    v_cvt_pk_bf16_f32 v109, v14, v15
    v_cvt_pk_bf16_f32 v110, v16, v17
    v_cvt_pk_bf16_f32 v111, v18, v19
    v_dot2c_f32_bf16 v4, v108, v108
    v_dot2c_f32_bf16 v5, v109, v109
    v_dot2c_f32_bf16 v6, v110, v110
    v_dot2c_f32_bf16 v7, v111, v111
    v_lshlrev_b32 v12, 16, v112
    v_and_b32 v13, s22, v112
    v_lshlrev_b32 v14, 16, v113
    v_and_b32 v15, s22, v113
    v_lshlrev_b32 v16, 16, v114
    v_and_b32 v17, s22, v114
    v_lshlrev_b32 v18, 16, v115
    v_and_b32 v19, s22, v115
    v_pk_add_f32 v[12:13], v[12:13], v[20:21] op_sel_hi:[1,0] neg_lo:[0,1] neg_hi:[0,1]
    v_pk_add_f32 v[14:15], v[14:15], v[20:21] op_sel_hi:[1,0] neg_lo:[0,1] neg_hi:[0,1]
    v_pk_add_f32 v[16:17], v[16:17], v[20:21] op_sel_hi:[1,0] neg_lo:[0,1] neg_hi:[0,1]
    v_pk_add_f32 v[18:19], v[18:19], v[20:21] op_sel_hi:[1,0] neg_lo:[0,1] neg_hi:[0,1]
    v_cvt_pk_bf16_f32 v112, v12, v13
    v_cvt_pk_bf16_f32 v113, v14, v15
    v_cvt_pk_bf16_f32 v114, v16, v17
    v_cvt_pk_bf16_f32 v115, v18, v19
    v_dot2c_f32_bf16 v4, v112, v112
    v_dot2c_f32_bf16 v5, v113, v113
    v_dot2c_f32_bf16 v6, v114, v114
    v_dot2c_f32_bf16 v7, v115, v115
    s_nop 2
    v_add_f32 v4, v4, v5
    v_add_f32 v6, v6, v7
    v_add_f32 v4, v4, v6
    s_nop 1
    v_add_f32_dpp v5, v4, v4 row_ror:8 row_mask:0xf bank_mask:0xf
    s_nop 1
    v_add_f32_dpp v4, v5, v5 row_ror:4 row_mask:0xf bank_mask:0xf
    s_nop 1
    v_add_f32_dpp v5, v4, v4 row_ror:2 row_mask:0xf bank_mask:0xf
    s_nop 1
    v_add_f32_dpp v4, v5, v5 row_ror:1 row_mask:0xf bank_mask:0xf
    ds_write_b32 v2, v4 offset:512
    s_waitcnt lgkmcnt(0)
    s_barrier
    ds_read_b64 v[4:5], v3 offset:512
    s_waitcnt lgkmcnt(0)
    v_add_f32 v4, v4, v5
    s_nop 1
    v_add_f32_dpp v5, v4, v4 row_ror:8 row_mask:0xf bank_mask:0xf
    s_nop 1
    v_add_f32_dpp v4, v5, v5 row_ror:4 row_mask:0xf bank_mask:0xf
    s_nop 1
    v_add_f32_dpp v5, v4, v4 row_ror:2 row_mask:0xf bank_mask:0xf
    s_nop 1
    v_add_f32_dpp v4, v5, v5 row_ror:1 row_mask:0xf bank_mask:0xf
    v_mul_f32 v4, 0x37800000, v4
    v_cvt_pk_bf16_f32 v4, v4, v4
    v_lshlrev_b32 v4, 16, v4
    v_add_f32 v4, 0x3727c5ac, v4
    v_cvt_pk_bf16_f32 v4, v4, v4
    v_lshlrev_b32 v4, 16, v4
    v_sqrt_f32 v4, v4
    s_nop 0
    v_cvt_pk_bf16_f32 v4, v4, v4
    v_lshlrev_b32 v4, 16, v4
    v_rcp_f32 v8, v4
    s_lshl_b32 s32, s60, 16
    s_and_b32 s33, s60, 0xffff0000
    s_lshl_b32 s34, s61, 16
    s_and_b32 s35, s61, 0xffff0000
    s_bitcmp1_b32 s50, 0
    s_cselect_b32 s32, s33, s32
    s_cselect_b32 s34, s35, s34
    v_mul_f32 v8, s32, v8
    v_mov_b32 v9, s34
    s_add_u32 s14, s10, s40
    s_addc_u32 s15, s11, 0
    v_lshlrev_b32 v12, 16, v52
    v_and_b32 v13, s22, v52
    v_lshlrev_b32 v14, 16, v53
    v_and_b32 v15, s22, v53
    v_lshlrev_b32 v16, 16, v54
    v_and_b32 v17, s22, v54
    v_lshlrev_b32 v18, 16, v55
    v_and_b32 v19, s22, v55
    v_pk_fma_f32 v[12:13], v[12:13], v[8:9], v[8:9] op_sel:[0,0,1] op_sel_hi:[1,0,1]
    v_pk_fma_f32 v[14:15], v[14:15], v[8:9], v[8:9] op_sel:[0,0,1] op_sel_hi:[1,0,1]
    v_pk_fma_f32 v[16:17], v[16:17], v[8:9], v[8:9] op_sel:[0,0,1] op_sel_hi:[1,0,1]
    v_pk_fma_f32 v[18:19], v[18:19], v[8:9], v[8:9] op_sel:[0,0,1] op_sel_hi:[1,0,1]
    v_cvt_pk_bf16_f32 v52, v12, v13
    v_cvt_pk_bf16_f32 v53, v14, v15
    v_cvt_pk_bf16_f32 v54, v16, v17
    v_cvt_pk_bf16_f32 v55, v18, v19
    global_store_dwordx4 v1, v[52:55], s[14:15] sc1
    s_add_u32 s14, s14, 8192
    s_addc_u32 s15, s15, 0
    global_load_dwordx4 v[52:55], v1, s[12:13] nt
    s_add_u32 s12, s12, 8192
    s_addc_u32 s13, s13, 0
    v_lshlrev_b32 v12, 16, v56
    v_and_b32 v13, s22, v56
    v_lshlrev_b32 v14, 16, v57
    v_and_b32 v15, s22, v57
    v_lshlrev_b32 v16, 16, v58
    v_and_b32 v17, s22, v58
    v_lshlrev_b32 v18, 16, v59
    v_and_b32 v19, s22, v59
    v_pk_fma_f32 v[12:13], v[12:13], v[8:9], v[8:9] op_sel:[0,0,1] op_sel_hi:[1,0,1]
    v_pk_fma_f32 v[14:15], v[14:15], v[8:9], v[8:9] op_sel:[0,0,1] op_sel_hi:[1,0,1]
    v_pk_fma_f32 v[16:17], v[16:17], v[8:9], v[8:9] op_sel:[0,0,1] op_sel_hi:[1,0,1]
    v_pk_fma_f32 v[18:19], v[18:19], v[8:9], v[8:9] op_sel:[0,0,1] op_sel_hi:[1,0,1]
    v_cvt_pk_bf16_f32 v56, v12, v13
    v_cvt_pk_bf16_f32 v57, v14, v15
    v_cvt_pk_bf16_f32 v58, v16, v17
    v_cvt_pk_bf16_f32 v59, v18, v19
    global_store_dwordx4 v1, v[56:59], s[14:15] sc1
    s_add_u32 s14, s14, 8192
    s_addc_u32 s15, s15, 0
    global_load_dwordx4 v[56:59], v1, s[12:13] nt
    s_add_u32 s12, s12, 8192
    s_addc_u32 s13, s13, 0
    v_lshlrev_b32 v12, 16, v60
    v_and_b32 v13, s22, v60
    v_lshlrev_b32 v14, 16, v61
    v_and_b32 v15, s22, v61
    v_lshlrev_b32 v16, 16, v62
    v_and_b32 v17, s22, v62
    v_lshlrev_b32 v18, 16, v63
    v_and_b32 v19, s22, v63
    v_pk_fma_f32 v[12:13], v[12:13], v[8:9], v[8:9] op_sel:[0,0,1] op_sel_hi:[1,0,1]
    v_pk_fma_f32 v[14:15], v[14:15], v[8:9], v[8:9] op_sel:[0,0,1] op_sel_hi:[1,0,1]
    v_pk_fma_f32 v[16:17], v[16:17], v[8:9], v[8:9] op_sel:[0,0,1] op_sel_hi:[1,0,1]
    v_pk_fma_f32 v[18:19], v[18:19], v[8:9], v[8:9] op_sel:[0,0,1] op_sel_hi:[1,0,1]
    v_cvt_pk_bf16_f32 v60, v12, v13
    v_cvt_pk_bf16_f32 v61, v14, v15
    v_cvt_pk_bf16_f32 v62, v16, v17
    v_cvt_pk_bf16_f32 v63, v18, v19
    global_store_dwordx4 v1, v[60:63], s[14:15] sc1
    s_add_u32 s14, s14, 8192
    s_addc_u32 s15, s15, 0
    global_load_dwordx4 v[60:63], v1, s[12:13] nt
    s_add_u32 s12, s12, 8192
    s_addc_u32 s13, s13, 0
    v_lshlrev_b32 v12, 16, v64
    v_and_b32 v13, s22, v64
    v_lshlrev_b32 v14, 16, v65
    v_and_b32 v15, s22, v65
    v_lshlrev_b32 v16, 16, v66
    v_and_b32 v17, s22, v66
    v_lshlrev_b32 v18, 16, v67
    v_and_b32 v19, s22, v67
    v_pk_fma_f32 v[12:13], v[12:13], v[8:9], v[8:9] op_sel:[0,0,1] op_sel_hi:[1,0,1]
    v_pk_fma_f32 v[14:15], v[14:15], v[8:9], v[8:9] op_sel:[0,0,1] op_sel_hi:[1,0,1]
    v_pk_fma_f32 v[16:17], v[16:17], v[8:9], v[8:9] op_sel:[0,0,1] op_sel_hi:[1,0,1]
    v_pk_fma_f32 v[18:19], v[18:19], v[8:9], v[8:9] op_sel:[0,0,1] op_sel_hi:[1,0,1]
    v_cvt_pk_bf16_f32 v64, v12, v13
    v_cvt_pk_bf16_f32 v65, v14, v15
    v_cvt_pk_bf16_f32 v66, v16, v17
    v_cvt_pk_bf16_f32 v67, v18, v19
    global_store_dwordx4 v1, v[64:67], s[14:15] sc1
    s_add_u32 s14, s14, 8192
    s_addc_u32 s15, s15, 0
    global_load_dwordx4 v[64:67], v1, s[12:13] nt
    s_add_u32 s12, s12, 8192
    s_addc_u32 s13, s13, 0
    v_lshlrev_b32 v12, 16, v68
    v_and_b32 v13, s22, v68
    v_lshlrev_b32 v14, 16, v69
    v_and_b32 v15, s22, v69
    v_lshlrev_b32 v16, 16, v70
    v_and_b32 v17, s22, v70
    v_lshlrev_b32 v18, 16, v71
    v_and_b32 v19, s22, v71
    v_pk_fma_f32 v[12:13], v[12:13], v[8:9], v[8:9] op_sel:[0,0,1] op_sel_hi:[1,0,1]
    v_pk_fma_f32 v[14:15], v[14:15], v[8:9], v[8:9] op_sel:[0,0,1] op_sel_hi:[1,0,1]
    v_pk_fma_f32 v[16:17], v[16:17], v[8:9], v[8:9] op_sel:[0,0,1] op_sel_hi:[1,0,1]
    v_pk_fma_f32 v[18:19], v[18:19], v[8:9], v[8:9] op_sel:[0,0,1] op_sel_hi:[1,0,1]
    v_cvt_pk_bf16_f32 v68, v12, v13
    v_cvt_pk_bf16_f32 v69, v14, v15
    v_cvt_pk_bf16_f32 v70, v16, v17
    v_cvt_pk_bf16_f32 v71, v18, v19
    global_store_dwordx4 v1, v[68:71], s[14:15] sc1
    s_add_u32 s14, s14, 8192
    s_addc_u32 s15, s15, 0
    global_load_dwordx4 v[68:71], v1, s[12:13] nt
    s_add_u32 s12, s12, 8192
    s_addc_u32 s13, s13, 0
    v_lshlrev_b32 v12, 16, v72
    v_and_b32 v13, s22, v72
    v_lshlrev_b32 v14, 16, v73
    v_and_b32 v15, s22, v73
    v_lshlrev_b32 v16, 16, v74
    v_and_b32 v17, s22, v74
    v_lshlrev_b32 v18, 16, v75
    v_and_b32 v19, s22, v75
    v_pk_fma_f32 v[12:13], v[12:13], v[8:9], v[8:9] op_sel:[0,0,1] op_sel_hi:[1,0,1]
    v_pk_fma_f32 v[14:15], v[14:15], v[8:9], v[8:9] op_sel:[0,0,1] op_sel_hi:[1,0,1]
    v_pk_fma_f32 v[16:17], v[16:17], v[8:9], v[8:9] op_sel:[0,0,1] op_sel_hi:[1,0,1]
    v_pk_fma_f32 v[18:19], v[18:19], v[8:9], v[8:9] op_sel:[0,0,1] op_sel_hi:[1,0,1]
    v_cvt_pk_bf16_f32 v72, v12, v13
    v_cvt_pk_bf16_f32 v73, v14, v15
    v_cvt_pk_bf16_f32 v74, v16, v17
    v_cvt_pk_bf16_f32 v75, v18, v19
    global_store_dwordx4 v1, v[72:75], s[14:15] sc1
    s_add_u32 s14, s14, 8192
    s_addc_u32 s15, s15, 0
    global_load_dwordx4 v[72:75], v1, s[12:13] nt
    s_add_u32 s12, s12, 8192
    s_addc_u32 s13, s13, 0
    v_lshlrev_b32 v12, 16, v76
    v_and_b32 v13, s22, v76
    v_lshlrev_b32 v14, 16, v77
    v_and_b32 v15, s22, v77
    v_lshlrev_b32 v16, 16, v78
    v_and_b32 v17, s22, v78
    v_lshlrev_b32 v18, 16, v79
    v_and_b32 v19, s22, v79
    v_pk_fma_f32 v[12:13], v[12:13], v[8:9], v[8:9] op_sel:[0,0,1] op_sel_hi:[1,0,1]
    v_pk_fma_f32 v[14:15], v[14:15], v[8:9], v[8:9] op_sel:[0,0,1] op_sel_hi:[1,0,1]
    v_pk_fma_f32 v[16:17], v[16:17], v[8:9], v[8:9] op_sel:[0,0,1] op_sel_hi:[1,0,1]
    v_pk_fma_f32 v[18:19], v[18:19], v[8:9], v[8:9] op_sel:[0,0,1] op_sel_hi:[1,0,1]
    v_cvt_pk_bf16_f32 v76, v12, v13
    v_cvt_pk_bf16_f32 v77, v14, v15
    v_cvt_pk_bf16_f32 v78, v16, v17
    v_cvt_pk_bf16_f32 v79, v18, v19
    global_store_dwordx4 v1, v[76:79], s[14:15] sc1
    s_add_u32 s14, s14, 8192
    s_addc_u32 s15, s15, 0
    global_load_dwordx4 v[76:79], v1, s[12:13] nt
    s_add_u32 s12, s12, 8192
    s_addc_u32 s13, s13, 0
    v_lshlrev_b32 v12, 16, v80
    v_and_b32 v13, s22, v80
    v_lshlrev_b32 v14, 16, v81
    v_and_b32 v15, s22, v81
    v_lshlrev_b32 v16, 16, v82
    v_and_b32 v17, s22, v82
    v_lshlrev_b32 v18, 16, v83
    v_and_b32 v19, s22, v83
    v_pk_fma_f32 v[12:13], v[12:13], v[8:9], v[8:9] op_sel:[0,0,1] op_sel_hi:[1,0,1]
    v_pk_fma_f32 v[14:15], v[14:15], v[8:9], v[8:9] op_sel:[0,0,1] op_sel_hi:[1,0,1]
    v_pk_fma_f32 v[16:17], v[16:17], v[8:9], v[8:9] op_sel:[0,0,1] op_sel_hi:[1,0,1]
    v_pk_fma_f32 v[18:19], v[18:19], v[8:9], v[8:9] op_sel:[0,0,1] op_sel_hi:[1,0,1]
    v_cvt_pk_bf16_f32 v80, v12, v13
    v_cvt_pk_bf16_f32 v81, v14, v15
    v_cvt_pk_bf16_f32 v82, v16, v17
    v_cvt_pk_bf16_f32 v83, v18, v19
    global_store_dwordx4 v1, v[80:83], s[14:15] sc1
    s_add_u32 s14, s14, 8192
    s_addc_u32 s15, s15, 0
    global_load_dwordx4 v[80:83], v1, s[12:13] nt
    s_add_u32 s12, s12, 8192
    s_addc_u32 s13, s13, 0
    v_lshlrev_b32 v12, 16, v84
    v_and_b32 v13, s22, v84
    v_lshlrev_b32 v14, 16, v85
    v_and_b32 v15, s22, v85
    v_lshlrev_b32 v16, 16, v86
    v_and_b32 v17, s22, v86
    v_lshlrev_b32 v18, 16, v87
    v_and_b32 v19, s22, v87
    v_pk_fma_f32 v[12:13], v[12:13], v[8:9], v[8:9] op_sel:[0,0,1] op_sel_hi:[1,0,1]
    v_pk_fma_f32 v[14:15], v[14:15], v[8:9], v[8:9] op_sel:[0,0,1] op_sel_hi:[1,0,1]
    v_pk_fma_f32 v[16:17], v[16:17], v[8:9], v[8:9] op_sel:[0,0,1] op_sel_hi:[1,0,1]
    v_pk_fma_f32 v[18:19], v[18:19], v[8:9], v[8:9] op_sel:[0,0,1] op_sel_hi:[1,0,1]
    v_cvt_pk_bf16_f32 v84, v12, v13
    v_cvt_pk_bf16_f32 v85, v14, v15
    v_cvt_pk_bf16_f32 v86, v16, v17
    v_cvt_pk_bf16_f32 v87, v18, v19
    global_store_dwordx4 v1, v[84:87], s[14:15] sc1
    s_add_u32 s14, s14, 8192
    s_addc_u32 s15, s15, 0
    global_load_dwordx4 v[84:87], v1, s[12:13] nt
    s_add_u32 s12, s12, 8192
    s_addc_u32 s13, s13, 0
    v_lshlrev_b32 v12, 16, v88
    v_and_b32 v13, s22, v88
    v_lshlrev_b32 v14, 16, v89
    v_and_b32 v15, s22, v89
    v_lshlrev_b32 v16, 16, v90
    v_and_b32 v17, s22, v90
    v_lshlrev_b32 v18, 16, v91
    v_and_b32 v19, s22, v91
    v_pk_fma_f32 v[12:13], v[12:13], v[8:9], v[8:9] op_sel:[0,0,1] op_sel_hi:[1,0,1]
    v_pk_fma_f32 v[14:15], v[14:15], v[8:9], v[8:9] op_sel:[0,0,1] op_sel_hi:[1,0,1]
    v_pk_fma_f32 v[16:17], v[16:17], v[8:9], v[8:9] op_sel:[0,0,1] op_sel_hi:[1,0,1]
    v_pk_fma_f32 v[18:19], v[18:19], v[8:9], v[8:9] op_sel:[0,0,1] op_sel_hi:[1,0,1]
    v_cvt_pk_bf16_f32 v88, v12, v13
    v_cvt_pk_bf16_f32 v89, v14, v15
    v_cvt_pk_bf16_f32 v90, v16, v17
    v_cvt_pk_bf16_f32 v91, v18, v19
    global_store_dwordx4 v1, v[88:91], s[14:15] sc1
    s_add_u32 s14, s14, 8192
    s_addc_u32 s15, s15, 0
    global_load_dwordx4 v[88:91], v1, s[12:13] nt
    s_add_u32 s12, s12, 8192
    s_addc_u32 s13, s13, 0
    v_lshlrev_b32 v12, 16, v92
    v_and_b32 v13, s22, v92
    v_lshlrev_b32 v14, 16, v93
    v_and_b32 v15, s22, v93
    v_lshlrev_b32 v16, 16, v94
    v_and_b32 v17, s22, v94
    v_lshlrev_b32 v18, 16, v95
    v_and_b32 v19, s22, v95
    v_pk_fma_f32 v[12:13], v[12:13], v[8:9], v[8:9] op_sel:[0,0,1] op_sel_hi:[1,0,1]
    v_pk_fma_f32 v[14:15], v[14:15], v[8:9], v[8:9] op_sel:[0,0,1] op_sel_hi:[1,0,1]
    v_pk_fma_f32 v[16:17], v[16:17], v[8:9], v[8:9] op_sel:[0,0,1] op_sel_hi:[1,0,1]
    v_pk_fma_f32 v[18:19], v[18:19], v[8:9], v[8:9] op_sel:[0,0,1] op_sel_hi:[1,0,1]
    v_cvt_pk_bf16_f32 v92, v12, v13
    v_cvt_pk_bf16_f32 v93, v14, v15
    v_cvt_pk_bf16_f32 v94, v16, v17
    v_cvt_pk_bf16_f32 v95, v18, v19
    global_store_dwordx4 v1, v[92:95], s[14:15] sc1
    s_add_u32 s14, s14, 8192
    s_addc_u32 s15, s15, 0
    global_load_dwordx4 v[92:95], v1, s[12:13] nt
    s_add_u32 s12, s12, 8192
    s_addc_u32 s13, s13, 0
    v_lshlrev_b32 v12, 16, v96
    v_and_b32 v13, s22, v96
    v_lshlrev_b32 v14, 16, v97
    v_and_b32 v15, s22, v97
    v_lshlrev_b32 v16, 16, v98
    v_and_b32 v17, s22, v98
    v_lshlrev_b32 v18, 16, v99
    v_and_b32 v19, s22, v99
    v_pk_fma_f32 v[12:13], v[12:13], v[8:9], v[8:9] op_sel:[0,0,1] op_sel_hi:[1,0,1]
    v_pk_fma_f32 v[14:15], v[14:15], v[8:9], v[8:9] op_sel:[0,0,1] op_sel_hi:[1,0,1]
    v_pk_fma_f32 v[16:17], v[16:17], v[8:9], v[8:9] op_sel:[0,0,1] op_sel_hi:[1,0,1]
    v_pk_fma_f32 v[18:19], v[18:19], v[8:9], v[8:9] op_sel:[0,0,1] op_sel_hi:[1,0,1]
    v_cvt_pk_bf16_f32 v96, v12, v13
    v_cvt_pk_bf16_f32 v97, v14, v15
    v_cvt_pk_bf16_f32 v98, v16, v17
    v_cvt_pk_bf16_f32 v99, v18, v19
    global_store_dwordx4 v1, v[96:99], s[14:15] sc1
    s_add_u32 s14, s14, 8192
    s_addc_u32 s15, s15, 0
    global_load_dwordx4 v[96:99], v1, s[12:13] nt
    s_add_u32 s12, s12, 8192
    s_addc_u32 s13, s13, 0
    v_lshlrev_b32 v12, 16, v100
    v_and_b32 v13, s22, v100
    v_lshlrev_b32 v14, 16, v101
    v_and_b32 v15, s22, v101
    v_lshlrev_b32 v16, 16, v102
    v_and_b32 v17, s22, v102
    v_lshlrev_b32 v18, 16, v103
    v_and_b32 v19, s22, v103
    v_pk_fma_f32 v[12:13], v[12:13], v[8:9], v[8:9] op_sel:[0,0,1] op_sel_hi:[1,0,1]
    v_pk_fma_f32 v[14:15], v[14:15], v[8:9], v[8:9] op_sel:[0,0,1] op_sel_hi:[1,0,1]
    v_pk_fma_f32 v[16:17], v[16:17], v[8:9], v[8:9] op_sel:[0,0,1] op_sel_hi:[1,0,1]
    v_pk_fma_f32 v[18:19], v[18:19], v[8:9], v[8:9] op_sel:[0,0,1] op_sel_hi:[1,0,1]
    v_cvt_pk_bf16_f32 v100, v12, v13
    v_cvt_pk_bf16_f32 v101, v14, v15
    v_cvt_pk_bf16_f32 v102, v16, v17
    v_cvt_pk_bf16_f32 v103, v18, v19
    global_store_dwordx4 v1, v[100:103], s[14:15] sc1
    s_add_u32 s14, s14, 8192
    s_addc_u32 s15, s15, 0
    global_load_dwordx4 v[100:103], v1, s[12:13] nt
    s_add_u32 s12, s12, 8192
    s_addc_u32 s13, s13, 0
    v_lshlrev_b32 v12, 16, v104
    v_and_b32 v13, s22, v104
    v_lshlrev_b32 v14, 16, v105
    v_and_b32 v15, s22, v105
    v_lshlrev_b32 v16, 16, v106
    v_and_b32 v17, s22, v106
    v_lshlrev_b32 v18, 16, v107
    v_and_b32 v19, s22, v107
    v_pk_fma_f32 v[12:13], v[12:13], v[8:9], v[8:9] op_sel:[0,0,1] op_sel_hi:[1,0,1]
    v_pk_fma_f32 v[14:15], v[14:15], v[8:9], v[8:9] op_sel:[0,0,1] op_sel_hi:[1,0,1]
    v_pk_fma_f32 v[16:17], v[16:17], v[8:9], v[8:9] op_sel:[0,0,1] op_sel_hi:[1,0,1]
    v_pk_fma_f32 v[18:19], v[18:19], v[8:9], v[8:9] op_sel:[0,0,1] op_sel_hi:[1,0,1]
    v_cvt_pk_bf16_f32 v104, v12, v13
    v_cvt_pk_bf16_f32 v105, v14, v15
    v_cvt_pk_bf16_f32 v106, v16, v17
    v_cvt_pk_bf16_f32 v107, v18, v19
    global_store_dwordx4 v1, v[104:107], s[14:15] sc1
    s_add_u32 s14, s14, 8192
    s_addc_u32 s15, s15, 0
    s_add_u32 s12, s4, s44
    s_addc_u32 s13, s5, 0
    global_load_dwordx4 v[104:107], v1, s[12:13] nt
    s_add_u32 s12, s12, 8192
    s_addc_u32 s13, s13, 0
    v_lshlrev_b32 v12, 16, v108
    v_and_b32 v13, s22, v108
    v_lshlrev_b32 v14, 16, v109
    v_and_b32 v15, s22, v109
    v_lshlrev_b32 v16, 16, v110
    v_and_b32 v17, s22, v110
    v_lshlrev_b32 v18, 16, v111
    v_and_b32 v19, s22, v111
    v_pk_fma_f32 v[12:13], v[12:13], v[8:9], v[8:9] op_sel:[0,0,1] op_sel_hi:[1,0,1]
    v_pk_fma_f32 v[14:15], v[14:15], v[8:9], v[8:9] op_sel:[0,0,1] op_sel_hi:[1,0,1]
    v_pk_fma_f32 v[16:17], v[16:17], v[8:9], v[8:9] op_sel:[0,0,1] op_sel_hi:[1,0,1]
    v_pk_fma_f32 v[18:19], v[18:19], v[8:9], v[8:9] op_sel:[0,0,1] op_sel_hi:[1,0,1]
    v_cvt_pk_bf16_f32 v108, v12, v13
    v_cvt_pk_bf16_f32 v109, v14, v15
    v_cvt_pk_bf16_f32 v110, v16, v17
    v_cvt_pk_bf16_f32 v111, v18, v19
    global_store_dwordx4 v1, v[108:111], s[14:15] sc1
    s_add_u32 s14, s14, 8192
    s_addc_u32 s15, s15, 0
    global_load_dwordx4 v[108:111], v1, s[12:13] nt
    s_add_u32 s12, s12, 8192
    s_addc_u32 s13, s13, 0
    v_mov_b32 v4, 0
    v_mov_b32 v5, 0
    v_mov_b32 v6, 0
    v_mov_b32 v7, 0
    s_waitcnt vmcnt(63)
    v_dot2c_f32_bf16 v4, s21, v116
    v_dot2c_f32_bf16 v5, s21, v117
    v_dot2c_f32_bf16 v6, s21, v118
    v_dot2c_f32_bf16 v7, s21, v119
    s_waitcnt vmcnt(63)
    v_dot2c_f32_bf16 v4, s21, v120
    v_dot2c_f32_bf16 v5, s21, v121
    v_dot2c_f32_bf16 v6, s21, v122
    v_dot2c_f32_bf16 v7, s21, v123
    s_waitcnt vmcnt(62)
    v_dot2c_f32_bf16 v4, s21, v124
    v_dot2c_f32_bf16 v5, s21, v125
    v_dot2c_f32_bf16 v6, s21, v126
    v_dot2c_f32_bf16 v7, s21, v127
    s_waitcnt vmcnt(61)
    v_dot2c_f32_bf16 v4, s21, v128
    v_dot2c_f32_bf16 v5, s21, v129
    v_dot2c_f32_bf16 v6, s21, v130
    v_dot2c_f32_bf16 v7, s21, v131
    s_waitcnt vmcnt(60)
    v_dot2c_f32_bf16 v4, s21, v132
    v_dot2c_f32_bf16 v5, s21, v133
    v_dot2c_f32_bf16 v6, s21, v134
    v_dot2c_f32_bf16 v7, s21, v135
    s_waitcnt vmcnt(59)
    v_dot2c_f32_bf16 v4, s21, v136
    v_dot2c_f32_bf16 v5, s21, v137
    v_dot2c_f32_bf16 v6, s21, v138
    v_dot2c_f32_bf16 v7, s21, v139
    s_waitcnt vmcnt(58)
    v_dot2c_f32_bf16 v4, s21, v140
    v_dot2c_f32_bf16 v5, s21, v141
    v_dot2c_f32_bf16 v6, s21, v142
    v_dot2c_f32_bf16 v7, s21, v143
    s_waitcnt vmcnt(57)
    v_dot2c_f32_bf16 v4, s21, v144
    v_dot2c_f32_bf16 v5, s21, v145
    v_dot2c_f32_bf16 v6, s21, v146
    v_dot2c_f32_bf16 v7, s21, v147
    s_waitcnt vmcnt(56)
    v_dot2c_f32_bf16 v4, s21, v148
    v_dot2c_f32_bf16 v5, s21, v149
    v_dot2c_f32_bf16 v6, s21, v150
    v_dot2c_f32_bf16 v7, s21, v151
    s_waitcnt vmcnt(55)
    v_dot2c_f32_bf16 v4, s21, v152
    v_dot2c_f32_bf16 v5, s21, v153
    v_dot2c_f32_bf16 v6, s21, v154
    v_dot2c_f32_bf16 v7, s21, v155
    s_waitcnt vmcnt(54)
    v_dot2c_f32_bf16 v4, s21, v156
    v_dot2c_f32_bf16 v5, s21, v157
    v_dot2c_f32_bf16 v6, s21, v158
    v_dot2c_f32_bf16 v7, s21, v159
    s_waitcnt vmcnt(53)
    v_dot2c_f32_bf16 v4, s21, v160
    v_dot2c_f32_bf16 v5, s21, v161
    v_dot2c_f32_bf16 v6, s21, v162
    v_dot2c_f32_bf16 v7, s21, v163
    s_waitcnt vmcnt(52)
    v_dot2c_f32_bf16 v4, s21, v164
    v_dot2c_f32_bf16 v5, s21, v165
    v_dot2c_f32_bf16 v6, s21, v166
    v_dot2c_f32_bf16 v7, s21, v167
    s_waitcnt vmcnt(51)
    v_dot2c_f32_bf16 v4, s21, v168
    v_dot2c_f32_bf16 v5, s21, v169
    v_dot2c_f32_bf16 v6, s21, v170
    v_dot2c_f32_bf16 v7, s21, v171
    s_waitcnt vmcnt(50)
    v_dot2c_f32_bf16 v4, s21, v172
    v_dot2c_f32_bf16 v5, s21, v173
    v_dot2c_f32_bf16 v6, s21, v174
    v_dot2c_f32_bf16 v7, s21, v175
    s_waitcnt vmcnt(49)
    v_dot2c_f32_bf16 v4, s21, v176
    v_dot2c_f32_bf16 v5, s21, v177
    v_dot2c_f32_bf16 v6, s21, v178
    v_dot2c_f32_bf16 v7, s21, v179
    s_nop 2
    v_add_f32 v4, v4, v5
    v_add_f32 v6, v6, v7
    v_add_f32 v4, v4, v6
    s_nop 1
    v_add_f32_dpp v5, v4, v4 row_ror:8 row_mask:0xf bank_mask:0xf
    s_nop 1
    v_add_f32_dpp v4, v5, v5 row_ror:4 row_mask:0xf bank_mask:0xf
    s_nop 1
    v_add_f32_dpp v5, v4, v4 row_ror:2 row_mask:0xf bank_mask:0xf
    s_nop 1
    v_add_f32_dpp v4, v5, v5 row_ror:1 row_mask:0xf bank_mask:0xf
    ds_write_b32 v2, v4 offset:0
    s_waitcnt lgkmcnt(0)
    s_barrier
    ds_read_b64 v[4:5], v3 offset:0
    s_waitcnt lgkmcnt(0)
    v_add_f32 v4, v4, v5
    s_nop 1
    v_add_f32_dpp v5, v4, v4 row_ror:8 row_mask:0xf bank_mask:0xf
    s_nop 1
    v_add_f32_dpp v4, v5, v5 row_ror:4 row_mask:0xf bank_mask:0xf
    s_nop 1
    v_add_f32_dpp v5, v4, v4 row_ror:2 row_mask:0xf bank_mask:0xf
    s_nop 1
    v_add_f32_dpp v4, v5, v5 row_ror:1 row_mask:0xf bank_mask:0xf
    v_mul_f32 v4, 0x37800000, v4
    v_cvt_pk_bf16_f32 v4, v4, v4
    v_lshlrev_b32 v20, 16, v4
    v_mov_b32 v4, 0
    v_mov_b32 v5, 0
    v_mov_b32 v6, 0
    v_mov_b32 v7, 0
    v_lshlrev_b32 v12, 16, v116
    v_and_b32 v13, s22, v116
    v_lshlrev_b32 v14, 16, v117
    v_and_b32 v15, s22, v117
    v_lshlrev_b32 v16, 16, v118
    v_and_b32 v17, s22, v118
    v_lshlrev_b32 v18, 16, v119
    v_and_b32 v19, s22, v119
    v_pk_add_f32 v[12:13], v[12:13], v[20:21] op_sel_hi:[1,0] neg_lo:[0,1] neg_hi:[0,1]
    v_pk_add_f32 v[14:15], v[14:15], v[20:21] op_sel_hi:[1,0] neg_lo:[0,1] neg_hi:[0,1]
    v_pk_add_f32 v[16:17], v[16:17], v[20:21] op_sel_hi:[1,0] neg_lo:[0,1] neg_hi:[0,1]
    v_pk_add_f32 v[18:19], v[18:19], v[20:21] op_sel_hi:[1,0] neg_lo:[0,1] neg_hi:[0,1]
    v_cvt_pk_bf16_f32 v116, v12, v13
    v_cvt_pk_bf16_f32 v117, v14, v15
    v_cvt_pk_bf16_f32 v118, v16, v17
    v_cvt_pk_bf16_f32 v119, v18, v19
    v_dot2c_f32_bf16 v4, v116, v116
    v_dot2c_f32_bf16 v5, v117, v117
    v_dot2c_f32_bf16 v6, v118, v118
    v_dot2c_f32_bf16 v7, v119, v119
    v_lshlrev_b32 v12, 16, v120
    v_and_b32 v13, s22, v120
    v_lshlrev_b32 v14, 16, v121
    v_and_b32 v15, s22, v121
    v_lshlrev_b32 v16, 16, v122
    v_and_b32 v17, s22, v122
    v_lshlrev_b32 v18, 16, v123
    v_and_b32 v19, s22, v123
    v_pk_add_f32 v[12:13], v[12:13], v[20:21] op_sel_hi:[1,0] neg_lo:[0,1] neg_hi:[0,1]
    v_pk_add_f32 v[14:15], v[14:15], v[20:21] op_sel_hi:[1,0] neg_lo:[0,1] neg_hi:[0,1]
    v_pk_add_f32 v[16:17], v[16:17], v[20:21] op_sel_hi:[1,0] neg_lo:[0,1] neg_hi:[0,1]
    v_pk_add_f32 v[18:19], v[18:19], v[20:21] op_sel_hi:[1,0] neg_lo:[0,1] neg_hi:[0,1]
    v_cvt_pk_bf16_f32 v120, v12, v13
    v_cvt_pk_bf16_f32 v121, v14, v15
    v_cvt_pk_bf16_f32 v122, v16, v17
    v_cvt_pk_bf16_f32 v123, v18, v19
    v_dot2c_f32_bf16 v4, v120, v120
    v_dot2c_f32_bf16 v5, v121, v121
    v_dot2c_f32_bf16 v6, v122, v122
    v_dot2c_f32_bf16 v7, v123, v123
    v_lshlrev_b32 v12, 16, v124
    v_and_b32 v13, s22, v124
    v_lshlrev_b32 v14, 16, v125
    v_and_b32 v15, s22, v125
    v_lshlrev_b32 v16, 16, v126
    v_and_b32 v17, s22, v126
    v_lshlrev_b32 v18, 16, v127
    v_and_b32 v19, s22, v127
    v_pk_add_f32 v[12:13], v[12:13], v[20:21] op_sel_hi:[1,0] neg_lo:[0,1] neg_hi:[0,1]
    v_pk_add_f32 v[14:15], v[14:15], v[20:21] op_sel_hi:[1,0] neg_lo:[0,1] neg_hi:[0,1]
    v_pk_add_f32 v[16:17], v[16:17], v[20:21] op_sel_hi:[1,0] neg_lo:[0,1] neg_hi:[0,1]
    v_pk_add_f32 v[18:19], v[18:19], v[20:21] op_sel_hi:[1,0] neg_lo:[0,1] neg_hi:[0,1]
    v_cvt_pk_bf16_f32 v124, v12, v13
    v_cvt_pk_bf16_f32 v125, v14, v15
    v_cvt_pk_bf16_f32 v126, v16, v17
    v_cvt_pk_bf16_f32 v127, v18, v19
    v_dot2c_f32_bf16 v4, v124, v124
    v_dot2c_f32_bf16 v5, v125, v125
    v_dot2c_f32_bf16 v6, v126, v126
    v_dot2c_f32_bf16 v7, v127, v127
    v_lshlrev_b32 v12, 16, v128
    v_and_b32 v13, s22, v128
    v_lshlrev_b32 v14, 16, v129
    v_and_b32 v15, s22, v129
    v_lshlrev_b32 v16, 16, v130
    v_and_b32 v17, s22, v130
    v_lshlrev_b32 v18, 16, v131
    v_and_b32 v19, s22, v131
    v_pk_add_f32 v[12:13], v[12:13], v[20:21] op_sel_hi:[1,0] neg_lo:[0,1] neg_hi:[0,1]
    v_pk_add_f32 v[14:15], v[14:15], v[20:21] op_sel_hi:[1,0] neg_lo:[0,1] neg_hi:[0,1]
    v_pk_add_f32 v[16:17], v[16:17], v[20:21] op_sel_hi:[1,0] neg_lo:[0,1] neg_hi:[0,1]
    v_pk_add_f32 v[18:19], v[18:19], v[20:21] op_sel_hi:[1,0] neg_lo:[0,1] neg_hi:[0,1]
    v_cvt_pk_bf16_f32 v128, v12, v13
    v_cvt_pk_bf16_f32 v129, v14, v15
    v_cvt_pk_bf16_f32 v130, v16, v17
    v_cvt_pk_bf16_f32 v131, v18, v19
    v_dot2c_f32_bf16 v4, v128, v128
    v_dot2c_f32_bf16 v5, v129, v129
    v_dot2c_f32_bf16 v6, v130, v130
    v_dot2c_f32_bf16 v7, v131, v131
    v_lshlrev_b32 v12, 16, v132
    v_and_b32 v13, s22, v132
    v_lshlrev_b32 v14, 16, v133
    v_and_b32 v15, s22, v133
    v_lshlrev_b32 v16, 16, v134
    v_and_b32 v17, s22, v134
    v_lshlrev_b32 v18, 16, v135
    v_and_b32 v19, s22, v135
    v_pk_add_f32 v[12:13], v[12:13], v[20:21] op_sel_hi:[1,0] neg_lo:[0,1] neg_hi:[0,1]
    v_pk_add_f32 v[14:15], v[14:15], v[20:21] op_sel_hi:[1,0] neg_lo:[0,1] neg_hi:[0,1]
    v_pk_add_f32 v[16:17], v[16:17], v[20:21] op_sel_hi:[1,0] neg_lo:[0,1] neg_hi:[0,1]
    v_pk_add_f32 v[18:19], v[18:19], v[20:21] op_sel_hi:[1,0] neg_lo:[0,1] neg_hi:[0,1]
    v_cvt_pk_bf16_f32 v132, v12, v13
    v_cvt_pk_bf16_f32 v133, v14, v15
    v_cvt_pk_bf16_f32 v134, v16, v17
    v_cvt_pk_bf16_f32 v135, v18, v19
    v_dot2c_f32_bf16 v4, v132, v132
    v_dot2c_f32_bf16 v5, v133, v133
    v_dot2c_f32_bf16 v6, v134, v134
    v_dot2c_f32_bf16 v7, v135, v135
    v_lshlrev_b32 v12, 16, v136
    v_and_b32 v13, s22, v136
    v_lshlrev_b32 v14, 16, v137
    v_and_b32 v15, s22, v137
    v_lshlrev_b32 v16, 16, v138
    v_and_b32 v17, s22, v138
    v_lshlrev_b32 v18, 16, v139
    v_and_b32 v19, s22, v139
    v_pk_add_f32 v[12:13], v[12:13], v[20:21] op_sel_hi:[1,0] neg_lo:[0,1] neg_hi:[0,1]
    v_pk_add_f32 v[14:15], v[14:15], v[20:21] op_sel_hi:[1,0] neg_lo:[0,1] neg_hi:[0,1]
    v_pk_add_f32 v[16:17], v[16:17], v[20:21] op_sel_hi:[1,0] neg_lo:[0,1] neg_hi:[0,1]
    v_pk_add_f32 v[18:19], v[18:19], v[20:21] op_sel_hi:[1,0] neg_lo:[0,1] neg_hi:[0,1]
    v_cvt_pk_bf16_f32 v136, v12, v13
    v_cvt_pk_bf16_f32 v137, v14, v15
    v_cvt_pk_bf16_f32 v138, v16, v17
    v_cvt_pk_bf16_f32 v139, v18, v19
    v_dot2c_f32_bf16 v4, v136, v136
    v_dot2c_f32_bf16 v5, v137, v137
    v_dot2c_f32_bf16 v6, v138, v138
    v_dot2c_f32_bf16 v7, v139, v139
    v_lshlrev_b32 v12, 16, v140
    v_and_b32 v13, s22, v140
    v_lshlrev_b32 v14, 16, v141
    v_and_b32 v15, s22, v141
    v_lshlrev_b32 v16, 16, v142
    v_and_b32 v17, s22, v142
    v_lshlrev_b32 v18, 16, v143
    v_and_b32 v19, s22, v143
    v_pk_add_f32 v[12:13], v[12:13], v[20:21] op_sel_hi:[1,0] neg_lo:[0,1] neg_hi:[0,1]
    v_pk_add_f32 v[14:15], v[14:15], v[20:21] op_sel_hi:[1,0] neg_lo:[0,1] neg_hi:[0,1]
    v_pk_add_f32 v[16:17], v[16:17], v[20:21] op_sel_hi:[1,0] neg_lo:[0,1] neg_hi:[0,1]
    v_pk_add_f32 v[18:19], v[18:19], v[20:21] op_sel_hi:[1,0] neg_lo:[0,1] neg_hi:[0,1]
    v_cvt_pk_bf16_f32 v140, v12, v13
    v_cvt_pk_bf16_f32 v141, v14, v15
    v_cvt_pk_bf16_f32 v142, v16, v17
    v_cvt_pk_bf16_f32 v143, v18, v19
    v_dot2c_f32_bf16 v4, v140, v140
    v_dot2c_f32_bf16 v5, v141, v141
    v_dot2c_f32_bf16 v6, v142, v142
    v_dot2c_f32_bf16 v7, v143, v143
    v_lshlrev_b32 v12, 16, v144
    v_and_b32 v13, s22, v144
    v_lshlrev_b32 v14, 16, v145
    v_and_b32 v15, s22, v145
    v_lshlrev_b32 v16, 16, v146
    v_and_b32 v17, s22, v146
    v_lshlrev_b32 v18, 16, v147
    v_and_b32 v19, s22, v147
    v_pk_add_f32 v[12:13], v[12:13], v[20:21] op_sel_hi:[1,0] neg_lo:[0,1] neg_hi:[0,1]
    v_pk_add_f32 v[14:15], v[14:15], v[20:21] op_sel_hi:[1,0] neg_lo:[0,1] neg_hi:[0,1]
    v_pk_add_f32 v[16:17], v[16:17], v[20:21] op_sel_hi:[1,0] neg_lo:[0,1] neg_hi:[0,1]
    v_pk_add_f32 v[18:19], v[18:19], v[20:21] op_sel_hi:[1,0] neg_lo:[0,1] neg_hi:[0,1]
    v_cvt_pk_bf16_f32 v144, v12, v13
    v_cvt_pk_bf16_f32 v145, v14, v15
    v_cvt_pk_bf16_f32 v146, v16, v17
    v_cvt_pk_bf16_f32 v147, v18, v19
    v_dot2c_f32_bf16 v4, v144, v144
    v_dot2c_f32_bf16 v5, v145, v145
    v_dot2c_f32_bf16 v6, v146, v146
    v_dot2c_f32_bf16 v7, v147, v147
    v_lshlrev_b32 v12, 16, v112
    v_and_b32 v13, s22, v112
    v_lshlrev_b32 v14, 16, v113
    v_and_b32 v15, s22, v113
    v_lshlrev_b32 v16, 16, v114
    v_and_b32 v17, s22, v114
    v_lshlrev_b32 v18, 16, v115
    v_and_b32 v19, s22, v115
    v_pk_fma_f32 v[12:13], v[12:13], v[8:9], v[8:9] op_sel:[0,0,1] op_sel_hi:[1,0,1]
    v_pk_fma_f32 v[14:15], v[14:15], v[8:9], v[8:9] op_sel:[0,0,1] op_sel_hi:[1,0,1]
    v_pk_fma_f32 v[16:17], v[16:17], v[8:9], v[8:9] op_sel:[0,0,1] op_sel_hi:[1,0,1]
    v_pk_fma_f32 v[18:19], v[18:19], v[8:9], v[8:9] op_sel:[0,0,1] op_sel_hi:[1,0,1]
    v_cvt_pk_bf16_f32 v112, v12, v13
    v_cvt_pk_bf16_f32 v113, v14, v15
    v_cvt_pk_bf16_f32 v114, v16, v17
    v_cvt_pk_bf16_f32 v115, v18, v19
    global_store_dwordx4 v1, v[112:115], s[14:15] sc1
    s_add_u32 s14, s14, 8192
    s_addc_u32 s15, s15, 0
    global_load_dwordx4 v[112:115], v1, s[12:13] nt
    s_add_u32 s12, s12, 8192
    s_addc_u32 s13, s13, 0
    v_lshlrev_b32 v12, 16, v148
    v_and_b32 v13, s22, v148
    v_lshlrev_b32 v14, 16, v149
    v_and_b32 v15, s22, v149
    v_lshlrev_b32 v16, 16, v150
    v_and_b32 v17, s22, v150
    v_lshlrev_b32 v18, 16, v151
    v_and_b32 v19, s22, v151
    v_pk_add_f32 v[12:13], v[12:13], v[20:21] op_sel_hi:[1,0] neg_lo:[0,1] neg_hi:[0,1]
    v_pk_add_f32 v[14:15], v[14:15], v[20:21] op_sel_hi:[1,0] neg_lo:[0,1] neg_hi:[0,1]
    v_pk_add_f32 v[16:17], v[16:17], v[20:21] op_sel_hi:[1,0] neg_lo:[0,1] neg_hi:[0,1]
    v_pk_add_f32 v[18:19], v[18:19], v[20:21] op_sel_hi:[1,0] neg_lo:[0,1] neg_hi:[0,1]
    v_cvt_pk_bf16_f32 v148, v12, v13
    v_cvt_pk_bf16_f32 v149, v14, v15
    v_cvt_pk_bf16_f32 v150, v16, v17
    v_cvt_pk_bf16_f32 v151, v18, v19
    v_dot2c_f32_bf16 v4, v148, v148
    v_dot2c_f32_bf16 v5, v149, v149
    v_dot2c_f32_bf16 v6, v150, v150
    v_dot2c_f32_bf16 v7, v151, v151
    v_lshlrev_b32 v12, 16, v152
    v_and_b32 v13, s22, v152
    v_lshlrev_b32 v14, 16, v153
    v_and_b32 v15, s22, v153
    v_lshlrev_b32 v16, 16, v154
    v_and_b32 v17, s22, v154
    v_lshlrev_b32 v18, 16, v155
    v_and_b32 v19, s22, v155
    v_pk_add_f32 v[12:13], v[12:13], v[20:21] op_sel_hi:[1,0] neg_lo:[0,1] neg_hi:[0,1]
    v_pk_add_f32 v[14:15], v[14:15], v[20:21] op_sel_hi:[1,0] neg_lo:[0,1] neg_hi:[0,1]
    v_pk_add_f32 v[16:17], v[16:17], v[20:21] op_sel_hi:[1,0] neg_lo:[0,1] neg_hi:[0,1]
    v_pk_add_f32 v[18:19], v[18:19], v[20:21] op_sel_hi:[1,0] neg_lo:[0,1] neg_hi:[0,1]
    v_cvt_pk_bf16_f32 v152, v12, v13
    v_cvt_pk_bf16_f32 v153, v14, v15
    v_cvt_pk_bf16_f32 v154, v16, v17
    v_cvt_pk_bf16_f32 v155, v18, v19
    v_dot2c_f32_bf16 v4, v152, v152
    v_dot2c_f32_bf16 v5, v153, v153
    v_dot2c_f32_bf16 v6, v154, v154
    v_dot2c_f32_bf16 v7, v155, v155
    v_lshlrev_b32 v12, 16, v156
    v_and_b32 v13, s22, v156
    v_lshlrev_b32 v14, 16, v157
    v_and_b32 v15, s22, v157
    v_lshlrev_b32 v16, 16, v158
    v_and_b32 v17, s22, v158
    v_lshlrev_b32 v18, 16, v159
    v_and_b32 v19, s22, v159
    v_pk_add_f32 v[12:13], v[12:13], v[20:21] op_sel_hi:[1,0] neg_lo:[0,1] neg_hi:[0,1]
    v_pk_add_f32 v[14:15], v[14:15], v[20:21] op_sel_hi:[1,0] neg_lo:[0,1] neg_hi:[0,1]
    v_pk_add_f32 v[16:17], v[16:17], v[20:21] op_sel_hi:[1,0] neg_lo:[0,1] neg_hi:[0,1]
    v_pk_add_f32 v[18:19], v[18:19], v[20:21] op_sel_hi:[1,0] neg_lo:[0,1] neg_hi:[0,1]
    v_cvt_pk_bf16_f32 v156, v12, v13
    v_cvt_pk_bf16_f32 v157, v14, v15
    v_cvt_pk_bf16_f32 v158, v16, v17
    v_cvt_pk_bf16_f32 v159, v18, v19
    v_dot2c_f32_bf16 v4, v156, v156
    v_dot2c_f32_bf16 v5, v157, v157
    v_dot2c_f32_bf16 v6, v158, v158
    v_dot2c_f32_bf16 v7, v159, v159
    v_lshlrev_b32 v12, 16, v160
    v_and_b32 v13, s22, v160
    v_lshlrev_b32 v14, 16, v161
    v_and_b32 v15, s22, v161
    v_lshlrev_b32 v16, 16, v162
    v_and_b32 v17, s22, v162
    v_lshlrev_b32 v18, 16, v163
    v_and_b32 v19, s22, v163
    v_pk_add_f32 v[12:13], v[12:13], v[20:21] op_sel_hi:[1,0] neg_lo:[0,1] neg_hi:[0,1]
    v_pk_add_f32 v[14:15], v[14:15], v[20:21] op_sel_hi:[1,0] neg_lo:[0,1] neg_hi:[0,1]
    v_pk_add_f32 v[16:17], v[16:17], v[20:21] op_sel_hi:[1,0] neg_lo:[0,1] neg_hi:[0,1]
    v_pk_add_f32 v[18:19], v[18:19], v[20:21] op_sel_hi:[1,0] neg_lo:[0,1] neg_hi:[0,1]
    v_cvt_pk_bf16_f32 v160, v12, v13
    v_cvt_pk_bf16_f32 v161, v14, v15
    v_cvt_pk_bf16_f32 v162, v16, v17
    v_cvt_pk_bf16_f32 v163, v18, v19
    v_dot2c_f32_bf16 v4, v160, v160
    v_dot2c_f32_bf16 v5, v161, v161
    v_dot2c_f32_bf16 v6, v162, v162
    v_dot2c_f32_bf16 v7, v163, v163
    v_lshlrev_b32 v12, 16, v164
    v_and_b32 v13, s22, v164
    v_lshlrev_b32 v14, 16, v165
    v_and_b32 v15, s22, v165
    v_lshlrev_b32 v16, 16, v166
    v_and_b32 v17, s22, v166
    v_lshlrev_b32 v18, 16, v167
    v_and_b32 v19, s22, v167
    v_pk_add_f32 v[12:13], v[12:13], v[20:21] op_sel_hi:[1,0] neg_lo:[0,1] neg_hi:[0,1]
    v_pk_add_f32 v[14:15], v[14:15], v[20:21] op_sel_hi:[1,0] neg_lo:[0,1] neg_hi:[0,1]
    v_pk_add_f32 v[16:17], v[16:17], v[20:21] op_sel_hi:[1,0] neg_lo:[0,1] neg_hi:[0,1]
    v_pk_add_f32 v[18:19], v[18:19], v[20:21] op_sel_hi:[1,0] neg_lo:[0,1] neg_hi:[0,1]
    v_cvt_pk_bf16_f32 v164, v12, v13
    v_cvt_pk_bf16_f32 v165, v14, v15
    v_cvt_pk_bf16_f32 v166, v16, v17
    v_cvt_pk_bf16_f32 v167, v18, v19
    v_dot2c_f32_bf16 v4, v164, v164
    v_dot2c_f32_bf16 v5, v165, v165
    v_dot2c_f32_bf16 v6, v166, v166
    v_dot2c_f32_bf16 v7, v167, v167
    v_lshlrev_b32 v12, 16, v168
    v_and_b32 v13, s22, v168
    v_lshlrev_b32 v14, 16, v169
    v_and_b32 v15, s22, v169
    v_lshlrev_b32 v16, 16, v170
    v_and_b32 v17, s22, v170
    v_lshlrev_b32 v18, 16, v171
    v_and_b32 v19, s22, v171
    v_pk_add_f32 v[12:13], v[12:13], v[20:21] op_sel_hi:[1,0] neg_lo:[0,1] neg_hi:[0,1]
    v_pk_add_f32 v[14:15], v[14:15], v[20:21] op_sel_hi:[1,0] neg_lo:[0,1] neg_hi:[0,1]
    v_pk_add_f32 v[16:17], v[16:17], v[20:21] op_sel_hi:[1,0] neg_lo:[0,1] neg_hi:[0,1]
    v_pk_add_f32 v[18:19], v[18:19], v[20:21] op_sel_hi:[1,0] neg_lo:[0,1] neg_hi:[0,1]
    v_cvt_pk_bf16_f32 v168, v12, v13
    v_cvt_pk_bf16_f32 v169, v14, v15
    v_cvt_pk_bf16_f32 v170, v16, v17
    v_cvt_pk_bf16_f32 v171, v18, v19
    v_dot2c_f32_bf16 v4, v168, v168
    v_dot2c_f32_bf16 v5, v169, v169
    v_dot2c_f32_bf16 v6, v170, v170
    v_dot2c_f32_bf16 v7, v171, v171
    v_lshlrev_b32 v12, 16, v172
    v_and_b32 v13, s22, v172
    v_lshlrev_b32 v14, 16, v173
    v_and_b32 v15, s22, v173
    v_lshlrev_b32 v16, 16, v174
    v_and_b32 v17, s22, v174
    v_lshlrev_b32 v18, 16, v175
    v_and_b32 v19, s22, v175
    v_pk_add_f32 v[12:13], v[12:13], v[20:21] op_sel_hi:[1,0] neg_lo:[0,1] neg_hi:[0,1]
    v_pk_add_f32 v[14:15], v[14:15], v[20:21] op_sel_hi:[1,0] neg_lo:[0,1] neg_hi:[0,1]
    v_pk_add_f32 v[16:17], v[16:17], v[20:21] op_sel_hi:[1,0] neg_lo:[0,1] neg_hi:[0,1]
    v_pk_add_f32 v[18:19], v[18:19], v[20:21] op_sel_hi:[1,0] neg_lo:[0,1] neg_hi:[0,1]
    v_cvt_pk_bf16_f32 v172, v12, v13
    v_cvt_pk_bf16_f32 v173, v14, v15
    v_cvt_pk_bf16_f32 v174, v16, v17
    v_cvt_pk_bf16_f32 v175, v18, v19
    v_dot2c_f32_bf16 v4, v172, v172
    v_dot2c_f32_bf16 v5, v173, v173
    v_dot2c_f32_bf16 v6, v174, v174
    v_dot2c_f32_bf16 v7, v175, v175
    v_lshlrev_b32 v12, 16, v176
    v_and_b32 v13, s22, v176
    v_lshlrev_b32 v14, 16, v177
    v_and_b32 v15, s22, v177
    v_lshlrev_b32 v16, 16, v178
    v_and_b32 v17, s22, v178
    v_lshlrev_b32 v18, 16, v179
    v_and_b32 v19, s22, v179
    v_pk_add_f32 v[12:13], v[12:13], v[20:21] op_sel_hi:[1,0] neg_lo:[0,1] neg_hi:[0,1]
    v_pk_add_f32 v[14:15], v[14:15], v[20:21] op_sel_hi:[1,0] neg_lo:[0,1] neg_hi:[0,1]
    v_pk_add_f32 v[16:17], v[16:17], v[20:21] op_sel_hi:[1,0] neg_lo:[0,1] neg_hi:[0,1]
    v_pk_add_f32 v[18:19], v[18:19], v[20:21] op_sel_hi:[1,0] neg_lo:[0,1] neg_hi:[0,1]
    v_cvt_pk_bf16_f32 v176, v12, v13
    v_cvt_pk_bf16_f32 v177, v14, v15
    v_cvt_pk_bf16_f32 v178, v16, v17
    v_cvt_pk_bf16_f32 v179, v18, v19
    v_dot2c_f32_bf16 v4, v176, v176
    v_dot2c_f32_bf16 v5, v177, v177
    v_dot2c_f32_bf16 v6, v178, v178
    v_dot2c_f32_bf16 v7, v179, v179
    s_nop 2
    v_add_f32 v4, v4, v5
    v_add_f32 v6, v6, v7
    v_add_f32 v4, v4, v6
    s_nop 1
    v_add_f32_dpp v5, v4, v4 row_ror:8 row_mask:0xf bank_mask:0xf
    s_nop 1
    v_add_f32_dpp v4, v5, v5 row_ror:4 row_mask:0xf bank_mask:0xf
    s_nop 1
    v_add_f32_dpp v5, v4, v4 row_ror:2 row_mask:0xf bank_mask:0xf
    s_nop 1
    v_add_f32_dpp v4, v5, v5 row_ror:1 row_mask:0xf bank_mask:0xf
    ds_write_b32 v2, v4 offset:512
    s_waitcnt lgkmcnt(0)
    s_barrier
    ds_read_b64 v[4:5], v3 offset:512
    s_waitcnt lgkmcnt(0)
    v_add_f32 v4, v4, v5
    s_nop 1
    v_add_f32_dpp v5, v4, v4 row_ror:8 row_mask:0xf bank_mask:0xf
    s_nop 1
    v_add_f32_dpp v4, v5, v5 row_ror:4 row_mask:0xf bank_mask:0xf
    s_nop 1
    v_add_f32_dpp v5, v4, v4 row_ror:2 row_mask:0xf bank_mask:0xf
    s_nop 1
    v_add_f32_dpp v4, v5, v5 row_ror:1 row_mask:0xf bank_mask:0xf
    v_mul_f32 v4, 0x37800000, v4
    v_cvt_pk_bf16_f32 v4, v4, v4
    v_lshlrev_b32 v4, 16, v4
    v_add_f32 v4, 0x3727c5ac, v4
    v_cvt_pk_bf16_f32 v4, v4, v4
    v_lshlrev_b32 v4, 16, v4
    v_sqrt_f32 v4, v4
    s_nop 0
    v_cvt_pk_bf16_f32 v4, v4, v4
    v_lshlrev_b32 v4, 16, v4
    v_rcp_f32 v10, v4
    s_lshl_b32 s32, s62, 16
    s_and_b32 s33, s62, 0xffff0000
    s_lshl_b32 s34, s63, 16
    s_and_b32 s35, s63, 0xffff0000
    s_bitcmp1_b32 s51, 0
    s_cselect_b32 s32, s33, s32
    s_cselect_b32 s34, s35, s34
    v_mul_f32 v10, s32, v10
    v_mov_b32 v11, s34
    global_load_dwordx4 v[24:27], v30, s[70:71] sc0 sc1
    s_add_u32 s14, s10, s41
    s_addc_u32 s15, s11, 0
    v_lshlrev_b32 v12, 16, v116
    v_and_b32 v13, s22, v116
    v_lshlrev_b32 v14, 16, v117
    v_and_b32 v15, s22, v117
    v_lshlrev_b32 v16, 16, v118
    v_and_b32 v17, s22, v118
    v_lshlrev_b32 v18, 16, v119
    v_and_b32 v19, s22, v119
    v_pk_fma_f32 v[12:13], v[12:13], v[10:11], v[10:11] op_sel:[0,0,1] op_sel_hi:[1,0,1]
    v_pk_fma_f32 v[14:15], v[14:15], v[10:11], v[10:11] op_sel:[0,0,1] op_sel_hi:[1,0,1]
    v_pk_fma_f32 v[16:17], v[16:17], v[10:11], v[10:11] op_sel:[0,0,1] op_sel_hi:[1,0,1]
    v_pk_fma_f32 v[18:19], v[18:19], v[10:11], v[10:11] op_sel:[0,0,1] op_sel_hi:[1,0,1]
    v_cvt_pk_bf16_f32 v116, v12, v13
    v_cvt_pk_bf16_f32 v117, v14, v15
    v_cvt_pk_bf16_f32 v118, v16, v17
    v_cvt_pk_bf16_f32 v119, v18, v19
    global_store_dwordx4 v1, v[116:119], s[14:15] sc1
    s_add_u32 s14, s14, 8192
    s_addc_u32 s15, s15, 0
    global_load_dwordx4 v[116:119], v1, s[12:13] nt
    s_add_u32 s12, s12, 8192
    s_addc_u32 s13, s13, 0
    v_lshlrev_b32 v12, 16, v120
    v_and_b32 v13, s22, v120
    v_lshlrev_b32 v14, 16, v121
    v_and_b32 v15, s22, v121
    v_lshlrev_b32 v16, 16, v122
    v_and_b32 v17, s22, v122
    v_lshlrev_b32 v18, 16, v123
    v_and_b32 v19, s22, v123
    v_pk_fma_f32 v[12:13], v[12:13], v[10:11], v[10:11] op_sel:[0,0,1] op_sel_hi:[1,0,1]
    v_pk_fma_f32 v[14:15], v[14:15], v[10:11], v[10:11] op_sel:[0,0,1] op_sel_hi:[1,0,1]
    v_pk_fma_f32 v[16:17], v[16:17], v[10:11], v[10:11] op_sel:[0,0,1] op_sel_hi:[1,0,1]
    v_pk_fma_f32 v[18:19], v[18:19], v[10:11], v[10:11] op_sel:[0,0,1] op_sel_hi:[1,0,1]
    v_cvt_pk_bf16_f32 v120, v12, v13
    v_cvt_pk_bf16_f32 v121, v14, v15
    v_cvt_pk_bf16_f32 v122, v16, v17
    v_cvt_pk_bf16_f32 v123, v18, v19
    global_store_dwordx4 v1, v[120:123], s[14:15] sc1
    s_add_u32 s14, s14, 8192
    s_addc_u32 s15, s15, 0
    global_load_dwordx4 v[120:123], v1, s[12:13] nt
    s_add_u32 s12, s12, 8192
    s_addc_u32 s13, s13, 0
    v_lshlrev_b32 v12, 16, v124
    v_and_b32 v13, s22, v124
    v_lshlrev_b32 v14, 16, v125
    v_and_b32 v15, s22, v125
    v_lshlrev_b32 v16, 16, v126
    v_and_b32 v17, s22, v126
    v_lshlrev_b32 v18, 16, v127
    v_and_b32 v19, s22, v127
    v_pk_fma_f32 v[12:13], v[12:13], v[10:11], v[10:11] op_sel:[0,0,1] op_sel_hi:[1,0,1]
    v_pk_fma_f32 v[14:15], v[14:15], v[10:11], v[10:11] op_sel:[0,0,1] op_sel_hi:[1,0,1]
    v_pk_fma_f32 v[16:17], v[16:17], v[10:11], v[10:11] op_sel:[0,0,1] op_sel_hi:[1,0,1]
    v_pk_fma_f32 v[18:19], v[18:19], v[10:11], v[10:11] op_sel:[0,0,1] op_sel_hi:[1,0,1]
    v_cvt_pk_bf16_f32 v124, v12, v13
    v_cvt_pk_bf16_f32 v125, v14, v15
    v_cvt_pk_bf16_f32 v126, v16, v17
    v_cvt_pk_bf16_f32 v127, v18, v19
    global_store_dwordx4 v1, v[124:127], s[14:15] sc1
    s_add_u32 s14, s14, 8192
    s_addc_u32 s15, s15, 0
    global_load_dwordx4 v[124:127], v1, s[12:13] nt
    s_add_u32 s12, s12, 8192
    s_addc_u32 s13, s13, 0
    v_mov_b32 v4, 0
    v_mov_b32 v5, 0
    v_mov_b32 v6, 0
    v_mov_b32 v7, 0
    s_waitcnt vmcnt(57)
    v_dot2c_f32_bf16 v4, s21, v180
    v_dot2c_f32_bf16 v5, s21, v181
    v_dot2c_f32_bf16 v6, s21, v182
    v_dot2c_f32_bf16 v7, s21, v183
    s_waitcnt vmcnt(56)
    v_dot2c_f32_bf16 v4, s21, v184
    v_dot2c_f32_bf16 v5, s21, v185
    v_dot2c_f32_bf16 v6, s21, v186
    v_dot2c_f32_bf16 v7, s21, v187
    s_waitcnt vmcnt(55)
    v_dot2c_f32_bf16 v4, s21, v188
    v_dot2c_f32_bf16 v5, s21, v189
    v_dot2c_f32_bf16 v6, s21, v190
    v_dot2c_f32_bf16 v7, s21, v191
    s_waitcnt vmcnt(54)
    v_dot2c_f32_bf16 v4, s21, v192
    v_dot2c_f32_bf16 v5, s21, v193
    v_dot2c_f32_bf16 v6, s21, v194
    v_dot2c_f32_bf16 v7, s21, v195
    s_waitcnt vmcnt(53)
    v_dot2c_f32_bf16 v4, s21, v196
    v_dot2c_f32_bf16 v5, s21, v197
    v_dot2c_f32_bf16 v6, s21, v198
    v_dot2c_f32_bf16 v7, s21, v199
    s_waitcnt vmcnt(52)
    v_dot2c_f32_bf16 v4, s21, v200
    v_dot2c_f32_bf16 v5, s21, v201
    v_dot2c_f32_bf16 v6, s21, v202
    v_dot2c_f32_bf16 v7, s21, v203
    s_waitcnt vmcnt(51)
    v_dot2c_f32_bf16 v4, s21, v204
    v_dot2c_f32_bf16 v5, s21, v205
    v_dot2c_f32_bf16 v6, s21, v206
    v_dot2c_f32_bf16 v7, s21, v207
    s_waitcnt vmcnt(50)
    v_dot2c_f32_bf16 v4, s21, v208
    v_dot2c_f32_bf16 v5, s21, v209
    v_dot2c_f32_bf16 v6, s21, v210
    v_dot2c_f32_bf16 v7, s21, v211
    s_waitcnt vmcnt(49)
    v_dot2c_f32_bf16 v4, s21, v212
    v_dot2c_f32_bf16 v5, s21, v213
    v_dot2c_f32_bf16 v6, s21, v214
    v_dot2c_f32_bf16 v7, s21, v215
    s_waitcnt vmcnt(48)
    v_dot2c_f32_bf16 v4, s21, v216
    v_dot2c_f32_bf16 v5, s21, v217
    v_dot2c_f32_bf16 v6, s21, v218
    v_dot2c_f32_bf16 v7, s21, v219
    s_waitcnt vmcnt(47)
    v_dot2c_f32_bf16 v4, s21, v220
    v_dot2c_f32_bf16 v5, s21, v221
    v_dot2c_f32_bf16 v6, s21, v222
    v_dot2c_f32_bf16 v7, s21, v223
    s_waitcnt vmcnt(46)
    v_dot2c_f32_bf16 v4, s21, v224
    v_dot2c_f32_bf16 v5, s21, v225
    v_dot2c_f32_bf16 v6, s21, v226
    v_dot2c_f32_bf16 v7, s21, v227
    s_waitcnt vmcnt(45)
    v_dot2c_f32_bf16 v4, s21, v228
    v_dot2c_f32_bf16 v5, s21, v229
    v_dot2c_f32_bf16 v6, s21, v230
    v_dot2c_f32_bf16 v7, s21, v231
    s_waitcnt vmcnt(44)
    v_dot2c_f32_bf16 v4, s21, v232
    v_dot2c_f32_bf16 v5, s21, v233
    v_dot2c_f32_bf16 v6, s21, v234
    v_dot2c_f32_bf16 v7, s21, v235
    s_waitcnt vmcnt(43)
    v_dot2c_f32_bf16 v4, s21, v236
    v_dot2c_f32_bf16 v5, s21, v237
    v_dot2c_f32_bf16 v6, s21, v238
    v_dot2c_f32_bf16 v7, s21, v239
    s_waitcnt vmcnt(42)
    v_dot2c_f32_bf16 v4, s21, v240
    v_dot2c_f32_bf16 v5, s21, v241
    v_dot2c_f32_bf16 v6, s21, v242
    v_dot2c_f32_bf16 v7, s21, v243
    s_nop 2
    v_add_f32 v4, v4, v5
    v_add_f32 v6, v6, v7
    v_add_f32 v4, v4, v6
    s_nop 1
    v_add_f32_dpp v5, v4, v4 row_ror:8 row_mask:0xf bank_mask:0xf
    s_nop 1
    v_add_f32_dpp v4, v5, v5 row_ror:4 row_mask:0xf bank_mask:0xf
    s_nop 1
    v_add_f32_dpp v5, v4, v4 row_ror:2 row_mask:0xf bank_mask:0xf
    s_nop 1
    v_add_f32_dpp v4, v5, v5 row_ror:1 row_mask:0xf bank_mask:0xf
    ds_write_b32 v2, v4 offset:0
    v_lshlrev_b32 v12, 16, v128
    v_and_b32 v13, s22, v128
    v_lshlrev_b32 v14, 16, v129
    v_and_b32 v15, s22, v129
    v_lshlrev_b32 v16, 16, v130
    v_and_b32 v17, s22, v130
    v_lshlrev_b32 v18, 16, v131
    v_and_b32 v19, s22, v131
    v_pk_fma_f32 v[12:13], v[12:13], v[10:11], v[10:11] op_sel:[0,0,1] op_sel_hi:[1,0,1]
    v_pk_fma_f32 v[14:15], v[14:15], v[10:11], v[10:11] op_sel:[0,0,1] op_sel_hi:[1,0,1]
    v_pk_fma_f32 v[16:17], v[16:17], v[10:11], v[10:11] op_sel:[0,0,1] op_sel_hi:[1,0,1]
    v_pk_fma_f32 v[18:19], v[18:19], v[10:11], v[10:11] op_sel:[0,0,1] op_sel_hi:[1,0,1]
    v_cvt_pk_bf16_f32 v128, v12, v13
    v_cvt_pk_bf16_f32 v129, v14, v15
    v_cvt_pk_bf16_f32 v130, v16, v17
    v_cvt_pk_bf16_f32 v131, v18, v19
    global_store_dwordx4 v1, v[128:131], s[14:15] sc1
    s_add_u32 s14, s14, 8192
    s_addc_u32 s15, s15, 0
    global_load_dwordx4 v[128:131], v1, s[12:13] nt
    s_add_u32 s12, s12, 8192
    s_addc_u32 s13, s13, 0
    v_lshlrev_b32 v12, 16, v132
    v_and_b32 v13, s22, v132
    v_lshlrev_b32 v14, 16, v133
    v_and_b32 v15, s22, v133
    v_lshlrev_b32 v16, 16, v134
    v_and_b32 v17, s22, v134
    v_lshlrev_b32 v18, 16, v135
    v_and_b32 v19, s22, v135
    v_pk_fma_f32 v[12:13], v[12:13], v[10:11], v[10:11] op_sel:[0,0,1] op_sel_hi:[1,0,1]
    v_pk_fma_f32 v[14:15], v[14:15], v[10:11], v[10:11] op_sel:[0,0,1] op_sel_hi:[1,0,1]
    v_pk_fma_f32 v[16:17], v[16:17], v[10:11], v[10:11] op_sel:[0,0,1] op_sel_hi:[1,0,1]
    v_pk_fma_f32 v[18:19], v[18:19], v[10:11], v[10:11] op_sel:[0,0,1] op_sel_hi:[1,0,1]
    v_cvt_pk_bf16_f32 v132, v12, v13
    v_cvt_pk_bf16_f32 v133, v14, v15
    v_cvt_pk_bf16_f32 v134, v16, v17
    v_cvt_pk_bf16_f32 v135, v18, v19
    global_store_dwordx4 v1, v[132:135], s[14:15] sc1
    s_add_u32 s14, s14, 8192
    s_addc_u32 s15, s15, 0
    global_load_dwordx4 v[132:135], v1, s[12:13] nt
    s_add_u32 s12, s12, 8192
    s_addc_u32 s13, s13, 0
    s_waitcnt lgkmcnt(0)
    s_barrier
    ds_read_b64 v[4:5], v3 offset:0
    s_waitcnt lgkmcnt(0)
    v_add_f32 v4, v4, v5
    s_nop 1
    v_add_f32_dpp v5, v4, v4 row_ror:8 row_mask:0xf bank_mask:0xf
    s_nop 1
    v_add_f32_dpp v4, v5, v5 row_ror:4 row_mask:0xf bank_mask:0xf
    s_nop 1
    v_add_f32_dpp v5, v4, v4 row_ror:2 row_mask:0xf bank_mask:0xf
    s_nop 1
    v_add_f32_dpp v4, v5, v5 row_ror:1 row_mask:0xf bank_mask:0xf
    v_mul_f32 v4, 0x37800000, v4
    v_cvt_pk_bf16_f32 v4, v4, v4
    v_lshlrev_b32 v20, 16, v4
    v_mov_b32 v4, 0
    v_mov_b32 v5, 0
    v_mov_b32 v6, 0
    v_mov_b32 v7, 0
    v_lshlrev_b32 v12, 16, v136
    v_and_b32 v13, s22, v136
    v_lshlrev_b32 v14, 16, v137
    v_and_b32 v15, s22, v137
    v_lshlrev_b32 v16, 16, v138
    v_and_b32 v17, s22, v138
    v_lshlrev_b32 v18, 16, v139
    v_and_b32 v19, s22, v139
    v_pk_fma_f32 v[12:13], v[12:13], v[10:11], v[10:11] op_sel:[0,0,1] op_sel_hi:[1,0,1]
    v_pk_fma_f32 v[14:15], v[14:15], v[10:11], v[10:11] op_sel:[0,0,1] op_sel_hi:[1,0,1]
    v_pk_fma_f32 v[16:17], v[16:17], v[10:11], v[10:11] op_sel:[0,0,1] op_sel_hi:[1,0,1]
    v_pk_fma_f32 v[18:19], v[18:19], v[10:11], v[10:11] op_sel:[0,0,1] op_sel_hi:[1,0,1]
    v_cvt_pk_bf16_f32 v136, v12, v13
    v_cvt_pk_bf16_f32 v137, v14, v15
    v_cvt_pk_bf16_f32 v138, v16, v17
    v_cvt_pk_bf16_f32 v139, v18, v19
    global_store_dwordx4 v1, v[136:139], s[14:15] sc1
    s_add_u32 s14, s14, 8192
    s_addc_u32 s15, s15, 0
    global_load_dwordx4 v[136:139], v1, s[12:13] nt
    s_add_u32 s12, s12, 8192
    s_addc_u32 s13, s13, 0
    v_lshlrev_b32 v12, 16, v140
    v_and_b32 v13, s22, v140
    v_lshlrev_b32 v14, 16, v141
    v_and_b32 v15, s22, v141
    v_lshlrev_b32 v16, 16, v142
    v_and_b32 v17, s22, v142
    v_lshlrev_b32 v18, 16, v143
    v_and_b32 v19, s22, v143
    v_pk_fma_f32 v[12:13], v[12:13], v[10:11], v[10:11] op_sel:[0,0,1] op_sel_hi:[1,0,1]
    v_pk_fma_f32 v[14:15], v[14:15], v[10:11], v[10:11] op_sel:[0,0,1] op_sel_hi:[1,0,1]
    v_pk_fma_f32 v[16:17], v[16:17], v[10:11], v[10:11] op_sel:[0,0,1] op_sel_hi:[1,0,1]
    v_pk_fma_f32 v[18:19], v[18:19], v[10:11], v[10:11] op_sel:[0,0,1] op_sel_hi:[1,0,1]
    v_cvt_pk_bf16_f32 v140, v12, v13
    v_cvt_pk_bf16_f32 v141, v14, v15
    v_cvt_pk_bf16_f32 v142, v16, v17
    v_cvt_pk_bf16_f32 v143, v18, v19
    global_store_dwordx4 v1, v[140:143], s[14:15] sc1
    s_add_u32 s14, s14, 8192
    s_addc_u32 s15, s15, 0
    global_load_dwordx4 v[140:143], v1, s[12:13] nt
    s_add_u32 s12, s12, 8192
    s_addc_u32 s13, s13, 0
    v_lshlrev_b32 v12, 16, v180
    v_and_b32 v13, s22, v180
    v_lshlrev_b32 v14, 16, v181
    v_and_b32 v15, s22, v181
    v_lshlrev_b32 v16, 16, v182
    v_and_b32 v17, s22, v182
    v_lshlrev_b32 v18, 16, v183
    v_and_b32 v19, s22, v183
    v_pk_add_f32 v[12:13], v[12:13], v[20:21] op_sel_hi:[1,0] neg_lo:[0,1] neg_hi:[0,1]
    v_pk_add_f32 v[14:15], v[14:15], v[20:21] op_sel_hi:[1,0] neg_lo:[0,1] neg_hi:[0,1]
    v_pk_add_f32 v[16:17], v[16:17], v[20:21] op_sel_hi:[1,0] neg_lo:[0,1] neg_hi:[0,1]
    v_pk_add_f32 v[18:19], v[18:19], v[20:21] op_sel_hi:[1,0] neg_lo:[0,1] neg_hi:[0,1]
    v_cvt_pk_bf16_f32 v180, v12, v13
    v_cvt_pk_bf16_f32 v181, v14, v15
    v_cvt_pk_bf16_f32 v182, v16, v17
    v_cvt_pk_bf16_f32 v183, v18, v19
    v_dot2c_f32_bf16 v4, v180, v180
    v_dot2c_f32_bf16 v5, v181, v181
    v_dot2c_f32_bf16 v6, v182, v182
    v_dot2c_f32_bf16 v7, v183, v183
    v_lshlrev_b32 v12, 16, v184
    v_and_b32 v13, s22, v184
    v_lshlrev_b32 v14, 16, v185
    v_and_b32 v15, s22, v185
    v_lshlrev_b32 v16, 16, v186
    v_and_b32 v17, s22, v186
    v_lshlrev_b32 v18, 16, v187
    v_and_b32 v19, s22, v187
    v_pk_add_f32 v[12:13], v[12:13], v[20:21] op_sel_hi:[1,0] neg_lo:[0,1] neg_hi:[0,1]
    v_pk_add_f32 v[14:15], v[14:15], v[20:21] op_sel_hi:[1,0] neg_lo:[0,1] neg_hi:[0,1]
    v_pk_add_f32 v[16:17], v[16:17], v[20:21] op_sel_hi:[1,0] neg_lo:[0,1] neg_hi:[0,1]
    v_pk_add_f32 v[18:19], v[18:19], v[20:21] op_sel_hi:[1,0] neg_lo:[0,1] neg_hi:[0,1]
    v_cvt_pk_bf16_f32 v184, v12, v13
    v_cvt_pk_bf16_f32 v185, v14, v15
    v_cvt_pk_bf16_f32 v186, v16, v17
    v_cvt_pk_bf16_f32 v187, v18, v19
    v_dot2c_f32_bf16 v4, v184, v184
    v_dot2c_f32_bf16 v5, v185, v185
    v_dot2c_f32_bf16 v6, v186, v186
    v_dot2c_f32_bf16 v7, v187, v187
    v_lshlrev_b32 v12, 16, v188
    v_and_b32 v13, s22, v188
    v_lshlrev_b32 v14, 16, v189
    v_and_b32 v15, s22, v189
    v_lshlrev_b32 v16, 16, v190
    v_and_b32 v17, s22, v190
    v_lshlrev_b32 v18, 16, v191
    v_and_b32 v19, s22, v191
    v_pk_add_f32 v[12:13], v[12:13], v[20:21] op_sel_hi:[1,0] neg_lo:[0,1] neg_hi:[0,1]
    v_pk_add_f32 v[14:15], v[14:15], v[20:21] op_sel_hi:[1,0] neg_lo:[0,1] neg_hi:[0,1]
    v_pk_add_f32 v[16:17], v[16:17], v[20:21] op_sel_hi:[1,0] neg_lo:[0,1] neg_hi:[0,1]
    v_pk_add_f32 v[18:19], v[18:19], v[20:21] op_sel_hi:[1,0] neg_lo:[0,1] neg_hi:[0,1]
    v_cvt_pk_bf16_f32 v188, v12, v13
    v_cvt_pk_bf16_f32 v189, v14, v15
    v_cvt_pk_bf16_f32 v190, v16, v17
    v_cvt_pk_bf16_f32 v191, v18, v19
    v_dot2c_f32_bf16 v4, v188, v188
    v_dot2c_f32_bf16 v5, v189, v189
    v_dot2c_f32_bf16 v6, v190, v190
    v_dot2c_f32_bf16 v7, v191, v191
    v_lshlrev_b32 v12, 16, v192
    v_and_b32 v13, s22, v192
    v_lshlrev_b32 v14, 16, v193
    v_and_b32 v15, s22, v193
    v_lshlrev_b32 v16, 16, v194
    v_and_b32 v17, s22, v194
    v_lshlrev_b32 v18, 16, v195
    v_and_b32 v19, s22, v195
    v_pk_add_f32 v[12:13], v[12:13], v[20:21] op_sel_hi:[1,0] neg_lo:[0,1] neg_hi:[0,1]
    v_pk_add_f32 v[14:15], v[14:15], v[20:21] op_sel_hi:[1,0] neg_lo:[0,1] neg_hi:[0,1]
    v_pk_add_f32 v[16:17], v[16:17], v[20:21] op_sel_hi:[1,0] neg_lo:[0,1] neg_hi:[0,1]
    v_pk_add_f32 v[18:19], v[18:19], v[20:21] op_sel_hi:[1,0] neg_lo:[0,1] neg_hi:[0,1]
    v_cvt_pk_bf16_f32 v192, v12, v13
    v_cvt_pk_bf16_f32 v193, v14, v15
    v_cvt_pk_bf16_f32 v194, v16, v17
    v_cvt_pk_bf16_f32 v195, v18, v19
    v_dot2c_f32_bf16 v4, v192, v192
    v_dot2c_f32_bf16 v5, v193, v193
    v_dot2c_f32_bf16 v6, v194, v194
    v_dot2c_f32_bf16 v7, v195, v195
    v_lshlrev_b32 v12, 16, v144
    v_and_b32 v13, s22, v144
    v_lshlrev_b32 v14, 16, v145
    v_and_b32 v15, s22, v145
    v_lshlrev_b32 v16, 16, v146
    v_and_b32 v17, s22, v146
    v_lshlrev_b32 v18, 16, v147
    v_and_b32 v19, s22, v147
    v_pk_fma_f32 v[12:13], v[12:13], v[10:11], v[10:11] op_sel:[0,0,1] op_sel_hi:[1,0,1]
    v_pk_fma_f32 v[14:15], v[14:15], v[10:11], v[10:11] op_sel:[0,0,1] op_sel_hi:[1,0,1]
    v_pk_fma_f32 v[16:17], v[16:17], v[10:11], v[10:11] op_sel:[0,0,1] op_sel_hi:[1,0,1]
    v_pk_fma_f32 v[18:19], v[18:19], v[10:11], v[10:11] op_sel:[0,0,1] op_sel_hi:[1,0,1]
    v_cvt_pk_bf16_f32 v144, v12, v13
    v_cvt_pk_bf16_f32 v145, v14, v15
    v_cvt_pk_bf16_f32 v146, v16, v17
    v_cvt_pk_bf16_f32 v147, v18, v19
    global_store_dwordx4 v1, v[144:147], s[14:15] sc1
    s_add_u32 s14, s14, 8192
    s_addc_u32 s15, s15, 0
    global_load_dwordx4 v[144:147], v1, s[12:13] nt
    s_add_u32 s12, s12, 8192
    s_addc_u32 s13, s13, 0
    v_lshlrev_b32 v12, 16, v148
    v_and_b32 v13, s22, v148
    v_lshlrev_b32 v14, 16, v149
    v_and_b32 v15, s22, v149
    v_lshlrev_b32 v16, 16, v150
    v_and_b32 v17, s22, v150
    v_lshlrev_b32 v18, 16, v151
    v_and_b32 v19, s22, v151
    v_pk_fma_f32 v[12:13], v[12:13], v[10:11], v[10:11] op_sel:[0,0,1] op_sel_hi:[1,0,1]
    v_pk_fma_f32 v[14:15], v[14:15], v[10:11], v[10:11] op_sel:[0,0,1] op_sel_hi:[1,0,1]
    v_pk_fma_f32 v[16:17], v[16:17], v[10:11], v[10:11] op_sel:[0,0,1] op_sel_hi:[1,0,1]
    v_pk_fma_f32 v[18:19], v[18:19], v[10:11], v[10:11] op_sel:[0,0,1] op_sel_hi:[1,0,1]
    v_cvt_pk_bf16_f32 v148, v12, v13
    v_cvt_pk_bf16_f32 v149, v14, v15
    v_cvt_pk_bf16_f32 v150, v16, v17
    v_cvt_pk_bf16_f32 v151, v18, v19
    global_store_dwordx4 v1, v[148:151], s[14:15] sc1
    s_add_u32 s14, s14, 8192
    s_addc_u32 s15, s15, 0
    global_load_dwordx4 v[148:151], v1, s[12:13] nt
    s_add_u32 s12, s12, 8192
    s_addc_u32 s13, s13, 0
    v_lshlrev_b32 v12, 16, v196
    v_and_b32 v13, s22, v196
    v_lshlrev_b32 v14, 16, v197
    v_and_b32 v15, s22, v197
    v_lshlrev_b32 v16, 16, v198
    v_and_b32 v17, s22, v198
    v_lshlrev_b32 v18, 16, v199
    v_and_b32 v19, s22, v199
    v_pk_add_f32 v[12:13], v[12:13], v[20:21] op_sel_hi:[1,0] neg_lo:[0,1] neg_hi:[0,1]
    v_pk_add_f32 v[14:15], v[14:15], v[20:21] op_sel_hi:[1,0] neg_lo:[0,1] neg_hi:[0,1]
    v_pk_add_f32 v[16:17], v[16:17], v[20:21] op_sel_hi:[1,0] neg_lo:[0,1] neg_hi:[0,1]
    v_pk_add_f32 v[18:19], v[18:19], v[20:21] op_sel_hi:[1,0] neg_lo:[0,1] neg_hi:[0,1]
    v_cvt_pk_bf16_f32 v196, v12, v13
    v_cvt_pk_bf16_f32 v197, v14, v15
    v_cvt_pk_bf16_f32 v198, v16, v17
    v_cvt_pk_bf16_f32 v199, v18, v19
    v_dot2c_f32_bf16 v4, v196, v196
    v_dot2c_f32_bf16 v5, v197, v197
    v_dot2c_f32_bf16 v6, v198, v198
    v_dot2c_f32_bf16 v7, v199, v199
    v_lshlrev_b32 v12, 16, v200
    v_and_b32 v13, s22, v200
    v_lshlrev_b32 v14, 16, v201
    v_and_b32 v15, s22, v201
    v_lshlrev_b32 v16, 16, v202
    v_and_b32 v17, s22, v202
    v_lshlrev_b32 v18, 16, v203
    v_and_b32 v19, s22, v203
    v_pk_add_f32 v[12:13], v[12:13], v[20:21] op_sel_hi:[1,0] neg_lo:[0,1] neg_hi:[0,1]
    v_pk_add_f32 v[14:15], v[14:15], v[20:21] op_sel_hi:[1,0] neg_lo:[0,1] neg_hi:[0,1]
    v_pk_add_f32 v[16:17], v[16:17], v[20:21] op_sel_hi:[1,0] neg_lo:[0,1] neg_hi:[0,1]
    v_pk_add_f32 v[18:19], v[18:19], v[20:21] op_sel_hi:[1,0] neg_lo:[0,1] neg_hi:[0,1]
    v_cvt_pk_bf16_f32 v200, v12, v13
    v_cvt_pk_bf16_f32 v201, v14, v15
    v_cvt_pk_bf16_f32 v202, v16, v17
    v_cvt_pk_bf16_f32 v203, v18, v19
    v_dot2c_f32_bf16 v4, v200, v200
    v_dot2c_f32_bf16 v5, v201, v201
    v_dot2c_f32_bf16 v6, v202, v202
    v_dot2c_f32_bf16 v7, v203, v203
    v_lshlrev_b32 v12, 16, v204
    v_and_b32 v13, s22, v204
    v_lshlrev_b32 v14, 16, v205
    v_and_b32 v15, s22, v205
    v_lshlrev_b32 v16, 16, v206
    v_and_b32 v17, s22, v206
    v_lshlrev_b32 v18, 16, v207
    v_and_b32 v19, s22, v207
    v_pk_add_f32 v[12:13], v[12:13], v[20:21] op_sel_hi:[1,0] neg_lo:[0,1] neg_hi:[0,1]
    v_pk_add_f32 v[14:15], v[14:15], v[20:21] op_sel_hi:[1,0] neg_lo:[0,1] neg_hi:[0,1]
    v_pk_add_f32 v[16:17], v[16:17], v[20:21] op_sel_hi:[1,0] neg_lo:[0,1] neg_hi:[0,1]
    v_pk_add_f32 v[18:19], v[18:19], v[20:21] op_sel_hi:[1,0] neg_lo:[0,1] neg_hi:[0,1]
    v_cvt_pk_bf16_f32 v204, v12, v13
    v_cvt_pk_bf16_f32 v205, v14, v15
    v_cvt_pk_bf16_f32 v206, v16, v17
    v_cvt_pk_bf16_f32 v207, v18, v19
    v_dot2c_f32_bf16 v4, v204, v204
    v_dot2c_f32_bf16 v5, v205, v205
    v_dot2c_f32_bf16 v6, v206, v206
    v_dot2c_f32_bf16 v7, v207, v207
    v_lshlrev_b32 v12, 16, v208
    v_and_b32 v13, s22, v208
    v_lshlrev_b32 v14, 16, v209
    v_and_b32 v15, s22, v209
    v_lshlrev_b32 v16, 16, v210
    v_and_b32 v17, s22, v210
    v_lshlrev_b32 v18, 16, v211
    v_and_b32 v19, s22, v211
    v_pk_add_f32 v[12:13], v[12:13], v[20:21] op_sel_hi:[1,0] neg_lo:[0,1] neg_hi:[0,1]
    v_pk_add_f32 v[14:15], v[14:15], v[20:21] op_sel_hi:[1,0] neg_lo:[0,1] neg_hi:[0,1]
    v_pk_add_f32 v[16:17], v[16:17], v[20:21] op_sel_hi:[1,0] neg_lo:[0,1] neg_hi:[0,1]
    v_pk_add_f32 v[18:19], v[18:19], v[20:21] op_sel_hi:[1,0] neg_lo:[0,1] neg_hi:[0,1]
    v_cvt_pk_bf16_f32 v208, v12, v13
    v_cvt_pk_bf16_f32 v209, v14, v15
    v_cvt_pk_bf16_f32 v210, v16, v17
    v_cvt_pk_bf16_f32 v211, v18, v19
    v_dot2c_f32_bf16 v4, v208, v208
    v_dot2c_f32_bf16 v5, v209, v209
    v_dot2c_f32_bf16 v6, v210, v210
    v_dot2c_f32_bf16 v7, v211, v211
    v_lshlrev_b32 v12, 16, v152
    v_and_b32 v13, s22, v152
    v_lshlrev_b32 v14, 16, v153
    v_and_b32 v15, s22, v153
    v_lshlrev_b32 v16, 16, v154
    v_and_b32 v17, s22, v154
    v_lshlrev_b32 v18, 16, v155
    v_and_b32 v19, s22, v155
    v_pk_fma_f32 v[12:13], v[12:13], v[10:11], v[10:11] op_sel:[0,0,1] op_sel_hi:[1,0,1]
    v_pk_fma_f32 v[14:15], v[14:15], v[10:11], v[10:11] op_sel:[0,0,1] op_sel_hi:[1,0,1]
    v_pk_fma_f32 v[16:17], v[16:17], v[10:11], v[10:11] op_sel:[0,0,1] op_sel_hi:[1,0,1]
    v_pk_fma_f32 v[18:19], v[18:19], v[10:11], v[10:11] op_sel:[0,0,1] op_sel_hi:[1,0,1]
    v_cvt_pk_bf16_f32 v152, v12, v13
    v_cvt_pk_bf16_f32 v153, v14, v15
    v_cvt_pk_bf16_f32 v154, v16, v17
    v_cvt_pk_bf16_f32 v155, v18, v19
    global_store_dwordx4 v1, v[152:155], s[14:15] sc1
    s_add_u32 s14, s14, 8192
    s_addc_u32 s15, s15, 0
    global_load_dwordx4 v[152:155], v1, s[12:13] nt
    s_add_u32 s12, s12, 8192
    s_addc_u32 s13, s13, 0
    v_lshlrev_b32 v12, 16, v156
    v_and_b32 v13, s22, v156
    v_lshlrev_b32 v14, 16, v157
    v_and_b32 v15, s22, v157
    v_lshlrev_b32 v16, 16, v158
    v_and_b32 v17, s22, v158
    v_lshlrev_b32 v18, 16, v159
    v_and_b32 v19, s22, v159
    v_pk_fma_f32 v[12:13], v[12:13], v[10:11], v[10:11] op_sel:[0,0,1] op_sel_hi:[1,0,1]
    v_pk_fma_f32 v[14:15], v[14:15], v[10:11], v[10:11] op_sel:[0,0,1] op_sel_hi:[1,0,1]
    v_pk_fma_f32 v[16:17], v[16:17], v[10:11], v[10:11] op_sel:[0,0,1] op_sel_hi:[1,0,1]
    v_pk_fma_f32 v[18:19], v[18:19], v[10:11], v[10:11] op_sel:[0,0,1] op_sel_hi:[1,0,1]
    v_cvt_pk_bf16_f32 v156, v12, v13
    v_cvt_pk_bf16_f32 v157, v14, v15
    v_cvt_pk_bf16_f32 v158, v16, v17
    v_cvt_pk_bf16_f32 v159, v18, v19
    global_store_dwordx4 v1, v[156:159], s[14:15] sc1
    s_add_u32 s14, s14, 8192
    s_addc_u32 s15, s15, 0
    global_load_dwordx4 v[156:159], v1, s[12:13] nt
    s_add_u32 s12, s12, 8192
    s_addc_u32 s13, s13, 0
    v_lshlrev_b32 v12, 16, v212
    v_and_b32 v13, s22, v212
    v_lshlrev_b32 v14, 16, v213
    v_and_b32 v15, s22, v213
    v_lshlrev_b32 v16, 16, v214
    v_and_b32 v17, s22, v214
    v_lshlrev_b32 v18, 16, v215
    v_and_b32 v19, s22, v215
    v_pk_add_f32 v[12:13], v[12:13], v[20:21] op_sel_hi:[1,0] neg_lo:[0,1] neg_hi:[0,1]
    v_pk_add_f32 v[14:15], v[14:15], v[20:21] op_sel_hi:[1,0] neg_lo:[0,1] neg_hi:[0,1]
    v_pk_add_f32 v[16:17], v[16:17], v[20:21] op_sel_hi:[1,0] neg_lo:[0,1] neg_hi:[0,1]
    v_pk_add_f32 v[18:19], v[18:19], v[20:21] op_sel_hi:[1,0] neg_lo:[0,1] neg_hi:[0,1]
    v_cvt_pk_bf16_f32 v212, v12, v13
    v_cvt_pk_bf16_f32 v213, v14, v15
    v_cvt_pk_bf16_f32 v214, v16, v17
    v_cvt_pk_bf16_f32 v215, v18, v19
    v_dot2c_f32_bf16 v4, v212, v212
    v_dot2c_f32_bf16 v5, v213, v213
    v_dot2c_f32_bf16 v6, v214, v214
    v_dot2c_f32_bf16 v7, v215, v215
    v_lshlrev_b32 v12, 16, v216
    v_and_b32 v13, s22, v216
    v_lshlrev_b32 v14, 16, v217
    v_and_b32 v15, s22, v217
    v_lshlrev_b32 v16, 16, v218
    v_and_b32 v17, s22, v218
    v_lshlrev_b32 v18, 16, v219
    v_and_b32 v19, s22, v219
    v_pk_add_f32 v[12:13], v[12:13], v[20:21] op_sel_hi:[1,0] neg_lo:[0,1] neg_hi:[0,1]
    v_pk_add_f32 v[14:15], v[14:15], v[20:21] op_sel_hi:[1,0] neg_lo:[0,1] neg_hi:[0,1]
    v_pk_add_f32 v[16:17], v[16:17], v[20:21] op_sel_hi:[1,0] neg_lo:[0,1] neg_hi:[0,1]
    v_pk_add_f32 v[18:19], v[18:19], v[20:21] op_sel_hi:[1,0] neg_lo:[0,1] neg_hi:[0,1]
    v_cvt_pk_bf16_f32 v216, v12, v13
    v_cvt_pk_bf16_f32 v217, v14, v15
    v_cvt_pk_bf16_f32 v218, v16, v17
    v_cvt_pk_bf16_f32 v219, v18, v19
    v_dot2c_f32_bf16 v4, v216, v216
    v_dot2c_f32_bf16 v5, v217, v217
    v_dot2c_f32_bf16 v6, v218, v218
    v_dot2c_f32_bf16 v7, v219, v219
    v_lshlrev_b32 v12, 16, v220
    v_and_b32 v13, s22, v220
    v_lshlrev_b32 v14, 16, v221
    v_and_b32 v15, s22, v221
    v_lshlrev_b32 v16, 16, v222
    v_and_b32 v17, s22, v222
    v_lshlrev_b32 v18, 16, v223
    v_and_b32 v19, s22, v223
    v_pk_add_f32 v[12:13], v[12:13], v[20:21] op_sel_hi:[1,0] neg_lo:[0,1] neg_hi:[0,1]
    v_pk_add_f32 v[14:15], v[14:15], v[20:21] op_sel_hi:[1,0] neg_lo:[0,1] neg_hi:[0,1]
    v_pk_add_f32 v[16:17], v[16:17], v[20:21] op_sel_hi:[1,0] neg_lo:[0,1] neg_hi:[0,1]
    v_pk_add_f32 v[18:19], v[18:19], v[20:21] op_sel_hi:[1,0] neg_lo:[0,1] neg_hi:[0,1]
    v_cvt_pk_bf16_f32 v220, v12, v13
    v_cvt_pk_bf16_f32 v221, v14, v15
    v_cvt_pk_bf16_f32 v222, v16, v17
    v_cvt_pk_bf16_f32 v223, v18, v19
    v_dot2c_f32_bf16 v4, v220, v220
    v_dot2c_f32_bf16 v5, v221, v221
    v_dot2c_f32_bf16 v6, v222, v222
    v_dot2c_f32_bf16 v7, v223, v223
    v_lshlrev_b32 v12, 16, v224
    v_and_b32 v13, s22, v224
    v_lshlrev_b32 v14, 16, v225
    v_and_b32 v15, s22, v225
    v_lshlrev_b32 v16, 16, v226
    v_and_b32 v17, s22, v226
    v_lshlrev_b32 v18, 16, v227
    v_and_b32 v19, s22, v227
    v_pk_add_f32 v[12:13], v[12:13], v[20:21] op_sel_hi:[1,0] neg_lo:[0,1] neg_hi:[0,1]
    v_pk_add_f32 v[14:15], v[14:15], v[20:21] op_sel_hi:[1,0] neg_lo:[0,1] neg_hi:[0,1]
    v_pk_add_f32 v[16:17], v[16:17], v[20:21] op_sel_hi:[1,0] neg_lo:[0,1] neg_hi:[0,1]
    v_pk_add_f32 v[18:19], v[18:19], v[20:21] op_sel_hi:[1,0] neg_lo:[0,1] neg_hi:[0,1]
    v_cvt_pk_bf16_f32 v224, v12, v13
    v_cvt_pk_bf16_f32 v225, v14, v15
    v_cvt_pk_bf16_f32 v226, v16, v17
    v_cvt_pk_bf16_f32 v227, v18, v19
    v_dot2c_f32_bf16 v4, v224, v224
    v_dot2c_f32_bf16 v5, v225, v225
    v_dot2c_f32_bf16 v6, v226, v226
    v_dot2c_f32_bf16 v7, v227, v227
    v_lshlrev_b32 v12, 16, v160
    v_and_b32 v13, s22, v160
    v_lshlrev_b32 v14, 16, v161
    v_and_b32 v15, s22, v161
    v_lshlrev_b32 v16, 16, v162
    v_and_b32 v17, s22, v162
    v_lshlrev_b32 v18, 16, v163
    v_and_b32 v19, s22, v163
    v_pk_fma_f32 v[12:13], v[12:13], v[10:11], v[10:11] op_sel:[0,0,1] op_sel_hi:[1,0,1]
    v_pk_fma_f32 v[14:15], v[14:15], v[10:11], v[10:11] op_sel:[0,0,1] op_sel_hi:[1,0,1]
    v_pk_fma_f32 v[16:17], v[16:17], v[10:11], v[10:11] op_sel:[0,0,1] op_sel_hi:[1,0,1]
    v_pk_fma_f32 v[18:19], v[18:19], v[10:11], v[10:11] op_sel:[0,0,1] op_sel_hi:[1,0,1]
    v_cvt_pk_bf16_f32 v160, v12, v13
    v_cvt_pk_bf16_f32 v161, v14, v15
    v_cvt_pk_bf16_f32 v162, v16, v17
    v_cvt_pk_bf16_f32 v163, v18, v19
    global_store_dwordx4 v1, v[160:163], s[14:15] sc1
    s_add_u32 s14, s14, 8192
    s_addc_u32 s15, s15, 0
    global_load_dwordx4 v[160:163], v1, s[12:13] nt
    s_add_u32 s12, s12, 8192
    s_addc_u32 s13, s13, 0
    v_lshlrev_b32 v12, 16, v164
    v_and_b32 v13, s22, v164
    v_lshlrev_b32 v14, 16, v165
    v_and_b32 v15, s22, v165
    v_lshlrev_b32 v16, 16, v166
    v_and_b32 v17, s22, v166
    v_lshlrev_b32 v18, 16, v167
    v_and_b32 v19, s22, v167
    v_pk_fma_f32 v[12:13], v[12:13], v[10:11], v[10:11] op_sel:[0,0,1] op_sel_hi:[1,0,1]
    v_pk_fma_f32 v[14:15], v[14:15], v[10:11], v[10:11] op_sel:[0,0,1] op_sel_hi:[1,0,1]
    v_pk_fma_f32 v[16:17], v[16:17], v[10:11], v[10:11] op_sel:[0,0,1] op_sel_hi:[1,0,1]
    v_pk_fma_f32 v[18:19], v[18:19], v[10:11], v[10:11] op_sel:[0,0,1] op_sel_hi:[1,0,1]
    v_cvt_pk_bf16_f32 v164, v12, v13
    v_cvt_pk_bf16_f32 v165, v14, v15
    v_cvt_pk_bf16_f32 v166, v16, v17
    v_cvt_pk_bf16_f32 v167, v18, v19
    global_store_dwordx4 v1, v[164:167], s[14:15] sc1
    s_add_u32 s14, s14, 8192
    s_addc_u32 s15, s15, 0
    global_load_dwordx4 v[164:167], v1, s[12:13] nt
    s_add_u32 s12, s12, 8192
    s_addc_u32 s13, s13, 0
    v_lshlrev_b32 v12, 16, v228
    v_and_b32 v13, s22, v228
    v_lshlrev_b32 v14, 16, v229
    v_and_b32 v15, s22, v229
    v_lshlrev_b32 v16, 16, v230
    v_and_b32 v17, s22, v230
    v_lshlrev_b32 v18, 16, v231
    v_and_b32 v19, s22, v231
    v_pk_add_f32 v[12:13], v[12:13], v[20:21] op_sel_hi:[1,0] neg_lo:[0,1] neg_hi:[0,1]
    v_pk_add_f32 v[14:15], v[14:15], v[20:21] op_sel_hi:[1,0] neg_lo:[0,1] neg_hi:[0,1]
    v_pk_add_f32 v[16:17], v[16:17], v[20:21] op_sel_hi:[1,0] neg_lo:[0,1] neg_hi:[0,1]
    v_pk_add_f32 v[18:19], v[18:19], v[20:21] op_sel_hi:[1,0] neg_lo:[0,1] neg_hi:[0,1]
    v_cvt_pk_bf16_f32 v228, v12, v13
    v_cvt_pk_bf16_f32 v229, v14, v15
    v_cvt_pk_bf16_f32 v230, v16, v17
    v_cvt_pk_bf16_f32 v231, v18, v19
    v_dot2c_f32_bf16 v4, v228, v228
    v_dot2c_f32_bf16 v5, v229, v229
    v_dot2c_f32_bf16 v6, v230, v230
    v_dot2c_f32_bf16 v7, v231, v231
    v_lshlrev_b32 v12, 16, v232
    v_and_b32 v13, s22, v232
    v_lshlrev_b32 v14, 16, v233
    v_and_b32 v15, s22, v233
    v_lshlrev_b32 v16, 16, v234
    v_and_b32 v17, s22, v234
    v_lshlrev_b32 v18, 16, v235
    v_and_b32 v19, s22, v235
    v_pk_add_f32 v[12:13], v[12:13], v[20:21] op_sel_hi:[1,0] neg_lo:[0,1] neg_hi:[0,1]
    v_pk_add_f32 v[14:15], v[14:15], v[20:21] op_sel_hi:[1,0] neg_lo:[0,1] neg_hi:[0,1]
    v_pk_add_f32 v[16:17], v[16:17], v[20:21] op_sel_hi:[1,0] neg_lo:[0,1] neg_hi:[0,1]
    v_pk_add_f32 v[18:19], v[18:19], v[20:21] op_sel_hi:[1,0] neg_lo:[0,1] neg_hi:[0,1]
    v_cvt_pk_bf16_f32 v232, v12, v13
    v_cvt_pk_bf16_f32 v233, v14, v15
    v_cvt_pk_bf16_f32 v234, v16, v17
    v_cvt_pk_bf16_f32 v235, v18, v19
    v_dot2c_f32_bf16 v4, v232, v232
    v_dot2c_f32_bf16 v5, v233, v233
    v_dot2c_f32_bf16 v6, v234, v234
    v_dot2c_f32_bf16 v7, v235, v235
    v_lshlrev_b32 v12, 16, v236
    v_and_b32 v13, s22, v236
    v_lshlrev_b32 v14, 16, v237
    v_and_b32 v15, s22, v237
    v_lshlrev_b32 v16, 16, v238
    v_and_b32 v17, s22, v238
    v_lshlrev_b32 v18, 16, v239
    v_and_b32 v19, s22, v239
    v_pk_add_f32 v[12:13], v[12:13], v[20:21] op_sel_hi:[1,0] neg_lo:[0,1] neg_hi:[0,1]
    v_pk_add_f32 v[14:15], v[14:15], v[20:21] op_sel_hi:[1,0] neg_lo:[0,1] neg_hi:[0,1]
    v_pk_add_f32 v[16:17], v[16:17], v[20:21] op_sel_hi:[1,0] neg_lo:[0,1] neg_hi:[0,1]
    v_pk_add_f32 v[18:19], v[18:19], v[20:21] op_sel_hi:[1,0] neg_lo:[0,1] neg_hi:[0,1]
    v_cvt_pk_bf16_f32 v236, v12, v13
    v_cvt_pk_bf16_f32 v237, v14, v15
    v_cvt_pk_bf16_f32 v238, v16, v17
    v_cvt_pk_bf16_f32 v239, v18, v19
    v_dot2c_f32_bf16 v4, v236, v236
    v_dot2c_f32_bf16 v5, v237, v237
    v_dot2c_f32_bf16 v6, v238, v238
    v_dot2c_f32_bf16 v7, v239, v239
    v_lshlrev_b32 v12, 16, v240
    v_and_b32 v13, s22, v240
    v_lshlrev_b32 v14, 16, v241
    v_and_b32 v15, s22, v241
    v_lshlrev_b32 v16, 16, v242
    v_and_b32 v17, s22, v242
    v_lshlrev_b32 v18, 16, v243
    v_and_b32 v19, s22, v243
    v_pk_add_f32 v[12:13], v[12:13], v[20:21] op_sel_hi:[1,0] neg_lo:[0,1] neg_hi:[0,1]
    v_pk_add_f32 v[14:15], v[14:15], v[20:21] op_sel_hi:[1,0] neg_lo:[0,1] neg_hi:[0,1]
    v_pk_add_f32 v[16:17], v[16:17], v[20:21] op_sel_hi:[1,0] neg_lo:[0,1] neg_hi:[0,1]
    v_pk_add_f32 v[18:19], v[18:19], v[20:21] op_sel_hi:[1,0] neg_lo:[0,1] neg_hi:[0,1]
    v_cvt_pk_bf16_f32 v240, v12, v13
    v_cvt_pk_bf16_f32 v241, v14, v15
    v_cvt_pk_bf16_f32 v242, v16, v17
    v_cvt_pk_bf16_f32 v243, v18, v19
    v_dot2c_f32_bf16 v4, v240, v240
    v_dot2c_f32_bf16 v5, v241, v241
    v_dot2c_f32_bf16 v6, v242, v242
    v_dot2c_f32_bf16 v7, v243, v243
    s_nop 2
    v_add_f32 v4, v4, v5
    v_add_f32 v6, v6, v7
    v_add_f32 v4, v4, v6
    s_nop 1
    v_add_f32_dpp v5, v4, v4 row_ror:8 row_mask:0xf bank_mask:0xf
    s_nop 1
    v_add_f32_dpp v4, v5, v5 row_ror:4 row_mask:0xf bank_mask:0xf
    s_nop 1
    v_add_f32_dpp v5, v4, v4 row_ror:2 row_mask:0xf bank_mask:0xf
    s_nop 1
    v_add_f32_dpp v4, v5, v5 row_ror:1 row_mask:0xf bank_mask:0xf
    ds_write_b32 v2, v4 offset:512
    v_lshlrev_b32 v12, 16, v168
    v_and_b32 v13, s22, v168
    v_lshlrev_b32 v14, 16, v169
    v_and_b32 v15, s22, v169
    v_lshlrev_b32 v16, 16, v170
    v_and_b32 v17, s22, v170
    v_lshlrev_b32 v18, 16, v171
    v_and_b32 v19, s22, v171
    v_pk_fma_f32 v[12:13], v[12:13], v[10:11], v[10:11] op_sel:[0,0,1] op_sel_hi:[1,0,1]
    v_pk_fma_f32 v[14:15], v[14:15], v[10:11], v[10:11] op_sel:[0,0,1] op_sel_hi:[1,0,1]
    v_pk_fma_f32 v[16:17], v[16:17], v[10:11], v[10:11] op_sel:[0,0,1] op_sel_hi:[1,0,1]
    v_pk_fma_f32 v[18:19], v[18:19], v[10:11], v[10:11] op_sel:[0,0,1] op_sel_hi:[1,0,1]
    v_cvt_pk_bf16_f32 v168, v12, v13
    v_cvt_pk_bf16_f32 v169, v14, v15
    v_cvt_pk_bf16_f32 v170, v16, v17
    v_cvt_pk_bf16_f32 v171, v18, v19
    global_store_dwordx4 v1, v[168:171], s[14:15] sc1
    s_add_u32 s14, s14, 8192
    s_addc_u32 s15, s15, 0
    v_lshlrev_b32 v12, 16, v172
    v_and_b32 v13, s22, v172
    v_lshlrev_b32 v14, 16, v173
    v_and_b32 v15, s22, v173
    v_lshlrev_b32 v16, 16, v174
    v_and_b32 v17, s22, v174
    v_lshlrev_b32 v18, 16, v175
    v_and_b32 v19, s22, v175
    v_pk_fma_f32 v[12:13], v[12:13], v[10:11], v[10:11] op_sel:[0,0,1] op_sel_hi:[1,0,1]
    v_pk_fma_f32 v[14:15], v[14:15], v[10:11], v[10:11] op_sel:[0,0,1] op_sel_hi:[1,0,1]
    v_pk_fma_f32 v[16:17], v[16:17], v[10:11], v[10:11] op_sel:[0,0,1] op_sel_hi:[1,0,1]
    v_pk_fma_f32 v[18:19], v[18:19], v[10:11], v[10:11] op_sel:[0,0,1] op_sel_hi:[1,0,1]
    v_cvt_pk_bf16_f32 v172, v12, v13
    v_cvt_pk_bf16_f32 v173, v14, v15
    v_cvt_pk_bf16_f32 v174, v16, v17
    v_cvt_pk_bf16_f32 v175, v18, v19
    global_store_dwordx4 v1, v[172:175], s[14:15] sc1
    s_add_u32 s14, s14, 8192
    s_addc_u32 s15, s15, 0
    s_waitcnt lgkmcnt(0)
    s_barrier
    ds_read_b64 v[4:5], v3 offset:512
    s_waitcnt lgkmcnt(0)
    v_add_f32 v4, v4, v5
    s_nop 1
    v_add_f32_dpp v5, v4, v4 row_ror:8 row_mask:0xf bank_mask:0xf
    s_nop 1
    v_add_f32_dpp v4, v5, v5 row_ror:4 row_mask:0xf bank_mask:0xf
    s_nop 1
    v_add_f32_dpp v5, v4, v4 row_ror:2 row_mask:0xf bank_mask:0xf
    s_nop 1
    v_add_f32_dpp v4, v5, v5 row_ror:1 row_mask:0xf bank_mask:0xf
    v_mul_f32 v4, 0x37800000, v4
    v_cvt_pk_bf16_f32 v4, v4, v4
    v_lshlrev_b32 v4, 16, v4
    v_add_f32 v4, 0x3727c5ac, v4
    v_cvt_pk_bf16_f32 v4, v4, v4
    v_lshlrev_b32 v4, 16, v4
    v_sqrt_f32 v4, v4
    s_nop 0
    v_cvt_pk_bf16_f32 v4, v4, v4
    v_lshlrev_b32 v4, 16, v4
    v_rcp_f32 v8, v4
    s_lshl_b32 s32, s64, 16
    s_and_b32 s33, s64, 0xffff0000
    s_lshl_b32 s34, s65, 16
    s_and_b32 s35, s65, 0xffff0000
    s_bitcmp1_b32 s52, 0
    s_cselect_b32 s32, s33, s32
    s_cselect_b32 s34, s35, s34
    v_mul_f32 v8, s32, v8
    v_mov_b32 v9, s34
    v_lshlrev_b32 v12, 16, v176
    v_and_b32 v13, s22, v176
    v_lshlrev_b32 v14, 16, v177
    v_and_b32 v15, s22, v177
    v_lshlrev_b32 v16, 16, v178
    v_and_b32 v17, s22, v178
    v_lshlrev_b32 v18, 16, v179
    v_and_b32 v19, s22, v179
    v_pk_fma_f32 v[12:13], v[12:13], v[10:11], v[10:11] op_sel:[0,0,1] op_sel_hi:[1,0,1]
    v_pk_fma_f32 v[14:15], v[14:15], v[10:11], v[10:11] op_sel:[0,0,1] op_sel_hi:[1,0,1]
    v_pk_fma_f32 v[16:17], v[16:17], v[10:11], v[10:11] op_sel:[0,0,1] op_sel_hi:[1,0,1]
    v_pk_fma_f32 v[18:19], v[18:19], v[10:11], v[10:11] op_sel:[0,0,1] op_sel_hi:[1,0,1]
    v_cvt_pk_bf16_f32 v176, v12, v13
    v_cvt_pk_bf16_f32 v177, v14, v15
    v_cvt_pk_bf16_f32 v178, v16, v17
    v_cvt_pk_bf16_f32 v179, v18, v19
    global_store_dwordx4 v1, v[176:179], s[14:15] sc1
    s_add_u32 s14, s14, 8192
    s_addc_u32 s15, s15, 0
    s_waitcnt vmcnt(29)
    s_mov_b32 s28, 65536
L_chk0:
    v_cmp_ne_u32 vcc, s18, v25
    v_cmp_ne_u32 s[30:31], s19, v27
    s_or_b64 s[30:31], vcc, s[30:31]
    s_cmp_eq_u64 s[30:31], 0
    s_cbranch_scc1 L_ready0
    s_sleep 4
    global_load_dwordx4 v[24:27], v30, s[70:71] sc0 sc1
    s_waitcnt vmcnt(0)
    s_sub_u32 s28, s28, 1
    s_cmp_lg_u32 s28, 0
    s_cbranch_scc1 L_chk0
    v_and_b32 v33, 63, v0
    v_lshlrev_b32 v33, 4, v33
    v_mov_b32 v4, 0
    v_mov_b32 v5, 0
    v_mov_b32 v6, 0
    v_mov_b32 v7, 0
    s_add_u32 s38, s49, 32768
    s_add_u32 s38, s4, s38
    s_addc_u32 s39, s5, 0
    s_mov_b32 s28, 96
L_fb1_0:
    global_load_dwordx4 v[24:27], v33, s[38:39]
    s_add_u32 s38, s38, 1024
    s_addc_u32 s39, s39, 0
    s_waitcnt vmcnt(0)
    v_dot2c_f32_bf16 v4, s21, v24
    v_dot2c_f32_bf16 v5, s21, v25
    v_dot2c_f32_bf16 v6, s21, v26
    v_dot2c_f32_bf16 v7, s21, v27
    s_sub_u32 s28, s28, 1
    s_cmp_lg_u32 s28, 0
    s_cbranch_scc1 L_fb1_0
    s_nop 2
    v_add_f32 v4, v4, v5
    v_add_f32 v6, v6, v7
    v_add_f32 v34, v4, v6
    s_nop 1
    v_add_f32_dpp v5, v34, v34 row_ror:8 row_mask:0xf bank_mask:0xf
    s_nop 1
    v_add_f32_dpp v34, v5, v5 row_ror:4 row_mask:0xf bank_mask:0xf
    s_nop 1
    v_add_f32_dpp v5, v34, v34 row_ror:2 row_mask:0xf bank_mask:0xf
    s_nop 1
    v_add_f32_dpp v34, v5, v5 row_ror:1 row_mask:0xf bank_mask:0xf
    v_mov_b32 v5, v34
    s_nop 1
    v_permlane16_swap_b32 v34, v5
    v_add_f32 v34, v34, v5
    v_mov_b32 v5, v34
    s_nop 1
    v_permlane32_swap_b32 v34, v5
    v_add_f32 v34, v34, v5
    v_mul_f32 v32, 0x37aaaaab, v34
    v_mov_b32 v4, 0
    v_mov_b32 v5, 0
    v_mov_b32 v6, 0
    v_mov_b32 v7, 0
    s_add_u32 s38, s49, 32768
    s_add_u32 s38, s4, s38
    s_addc_u32 s39, s5, 0
    s_mov_b32 s28, 96
L_fb2_0:
    global_load_dwordx4 v[24:27], v33, s[38:39]
    s_add_u32 s38, s38, 1024
    s_addc_u32 s39, s39, 0
    s_waitcnt vmcnt(0)
    v_lshlrev_b32 v12, 16, v24
    v_and_b32 v13, s22, v24
    v_lshlrev_b32 v14, 16, v25
    v_and_b32 v15, s22, v25
    v_lshlrev_b32 v16, 16, v26
    v_and_b32 v17, s22, v26
    v_lshlrev_b32 v18, 16, v27
    v_and_b32 v19, s22, v27
    v_pk_add_f32 v[12:13], v[12:13], v[32:33] op_sel_hi:[1,0] neg_lo:[0,1] neg_hi:[0,1]
    v_pk_add_f32 v[14:15], v[14:15], v[32:33] op_sel_hi:[1,0] neg_lo:[0,1] neg_hi:[0,1]
    v_pk_add_f32 v[16:17], v[16:17], v[32:33] op_sel_hi:[1,0] neg_lo:[0,1] neg_hi:[0,1]
    v_pk_add_f32 v[18:19], v[18:19], v[32:33] op_sel_hi:[1,0] neg_lo:[0,1] neg_hi:[0,1]
    v_pk_fma_f32 v[4:5], v[12:13], v[12:13], v[4:5]
    v_pk_fma_f32 v[6:7], v[14:15], v[14:15], v[6:7]
    v_pk_fma_f32 v[4:5], v[16:17], v[16:17], v[4:5]
    v_pk_fma_f32 v[6:7], v[18:19], v[18:19], v[6:7]
    s_sub_u32 s28, s28, 1
    s_cmp_lg_u32 s28, 0
    s_cbranch_scc1 L_fb2_0
    v_add_f32 v4, v4, v5
    v_add_f32 v6, v6, v7
    v_add_f32 v26, v4, v6
    s_nop 1
    v_add_f32_dpp v5, v26, v26 row_ror:8 row_mask:0xf bank_mask:0xf
    s_nop 1
    v_add_f32_dpp v26, v5, v5 row_ror:4 row_mask:0xf bank_mask:0xf
    s_nop 1
    v_add_f32_dpp v5, v26, v26 row_ror:2 row_mask:0xf bank_mask:0xf
    s_nop 1
    v_add_f32_dpp v26, v5, v5 row_ror:1 row_mask:0xf bank_mask:0xf
    v_mov_b32 v5, v26
    s_nop 1
    v_permlane16_swap_b32 v26, v5
    v_add_f32 v26, v26, v5
    v_mov_b32 v5, v26
    s_nop 1
    v_permlane32_swap_b32 v26, v5
    v_add_f32 v26, v26, v5
    v_mov_b32 v24, v34
L_ready0:
    s_cmp_lg_u32 s3, 0
    s_cbranch_scc1 L_nobump0
    v_mov_b32 v16, s26
    v_mov_b32 v18, s24
    v_mov_b32 v19, s25
    s_mov_b64 exec, 1
    global_store_dwordx2 v16, v[18:19], s[70:71] sc0 sc1
    s_mov_b64 exec, -1
L_nobump0:
    v_add_f32 v12, v28, v24
    v_mul_f32 v12, 0x37800000, v12
    v_mul_f32 v13, 0x38800000, v28
    v_mul_f32 v14, 0x37aaaaab, v24
    v_sub_f32 v13, v13, v12
    v_sub_f32 v14, v14, v12
    v_mul_f32 v13, v13, v13
    v_mul_f32 v14, v14, v14
    v_mov_b32 v15, 0x46800000
    v_fma_f32 v13, v13, v15, v29
    v_mov_b32 v15, 0x47400000
    v_fma_f32 v14, v14, v15, v26
    v_add_f32 v13, v13, v14
    v_cvt_pk_bf16_f32 v32, v12, v12
    v_lshlrev_b32 v32, 16, v32
    v_sub_f32 v12, v12, v32
    v_mul_f32 v12, v12, v12
    v_mov_b32 v15, 0x37800000
    v_fma_f32 v4, v13, v15, v12
    v_cvt_pk_bf16_f32 v4, v4, v4
    v_lshlrev_b32 v4, 16, v4
    v_add_f32 v4, 0x3727c5ac, v4
    v_cvt_pk_bf16_f32 v4, v4, v4
    v_lshlrev_b32 v4, 16, v4
    v_sqrt_f32 v4, v4
    s_nop 0
    v_cvt_pk_bf16_f32 v4, v4, v4
    v_lshlrev_b32 v4, 16, v4
    v_rcp_f32 v34, v4
    s_lshl_b32 s32, s36, 16
    s_and_b32 s33, s36, 0xffff0000
    s_lshl_b32 s34, s37, 16
    s_and_b32 s35, s37, 0xffff0000
    s_bitcmp1_b32 s59, 0
    s_cselect_b32 s32, s33, s32
    s_cselect_b32 s34, s35, s34
    v_mul_f32 v34, s32, v34
    v_mov_b32 v35, s34
    s_add_u32 s14, s10, s49
    s_addc_u32 s15, s11, 0
    v_lshlrev_b32 v12, 16, v36
    v_and_b32 v13, s22, v36
    v_lshlrev_b32 v14, 16, v37
    v_and_b32 v15, s22, v37
    v_lshlrev_b32 v16, 16, v38
    v_and_b32 v17, s22, v38
    v_lshlrev_b32 v18, 16, v39
    v_and_b32 v19, s22, v39
    v_pk_add_f32 v[12:13], v[12:13], v[32:33] op_sel_hi:[1,0] neg_lo:[0,1] neg_hi:[0,1]
    v_pk_add_f32 v[14:15], v[14:15], v[32:33] op_sel_hi:[1,0] neg_lo:[0,1] neg_hi:[0,1]
    v_pk_add_f32 v[16:17], v[16:17], v[32:33] op_sel_hi:[1,0] neg_lo:[0,1] neg_hi:[0,1]
    v_pk_add_f32 v[18:19], v[18:19], v[32:33] op_sel_hi:[1,0] neg_lo:[0,1] neg_hi:[0,1]
    v_cvt_pk_bf16_f32 v36, v12, v13
    v_cvt_pk_bf16_f32 v37, v14, v15
    v_cvt_pk_bf16_f32 v38, v16, v17
    v_cvt_pk_bf16_f32 v39, v18, v19
    v_lshlrev_b32 v12, 16, v36
    v_and_b32 v13, s22, v36
    v_lshlrev_b32 v14, 16, v37
    v_and_b32 v15, s22, v37
    v_lshlrev_b32 v16, 16, v38
    v_and_b32 v17, s22, v38
    v_lshlrev_b32 v18, 16, v39
    v_and_b32 v19, s22, v39
    v_pk_fma_f32 v[12:13], v[12:13], v[34:35], v[34:35] op_sel:[0,0,1] op_sel_hi:[1,0,1]
    v_pk_fma_f32 v[14:15], v[14:15], v[34:35], v[34:35] op_sel:[0,0,1] op_sel_hi:[1,0,1]
    v_pk_fma_f32 v[16:17], v[16:17], v[34:35], v[34:35] op_sel:[0,0,1] op_sel_hi:[1,0,1]
    v_pk_fma_f32 v[18:19], v[18:19], v[34:35], v[34:35] op_sel:[0,0,1] op_sel_hi:[1,0,1]
    v_cvt_pk_bf16_f32 v36, v12, v13
    v_cvt_pk_bf16_f32 v37, v14, v15
    v_cvt_pk_bf16_f32 v38, v16, v17
    v_cvt_pk_bf16_f32 v39, v18, v19
    global_store_dwordx4 v1, v[36:39], s[14:15] sc1
    s_add_u32 s14, s14, 8192
    s_addc_u32 s15, s15, 0
    v_lshlrev_b32 v12, 16, v40
    v_and_b32 v13, s22, v40
    v_lshlrev_b32 v14, 16, v41
    v_and_b32 v15, s22, v41
    v_lshlrev_b32 v16, 16, v42
    v_and_b32 v17, s22, v42
    v_lshlrev_b32 v18, 16, v43
    v_and_b32 v19, s22, v43
    v_pk_add_f32 v[12:13], v[12:13], v[32:33] op_sel_hi:[1,0] neg_lo:[0,1] neg_hi:[0,1]
    v_pk_add_f32 v[14:15], v[14:15], v[32:33] op_sel_hi:[1,0] neg_lo:[0,1] neg_hi:[0,1]
    v_pk_add_f32 v[16:17], v[16:17], v[32:33] op_sel_hi:[1,0] neg_lo:[0,1] neg_hi:[0,1]
    v_pk_add_f32 v[18:19], v[18:19], v[32:33] op_sel_hi:[1,0] neg_lo:[0,1] neg_hi:[0,1]
    v_cvt_pk_bf16_f32 v40, v12, v13
    v_cvt_pk_bf16_f32 v41, v14, v15
    v_cvt_pk_bf16_f32 v42, v16, v17
    v_cvt_pk_bf16_f32 v43, v18, v19
    v_lshlrev_b32 v12, 16, v40
    v_and_b32 v13, s22, v40
    v_lshlrev_b32 v14, 16, v41
    v_and_b32 v15, s22, v41
    v_lshlrev_b32 v16, 16, v42
    v_and_b32 v17, s22, v42
    v_lshlrev_b32 v18, 16, v43
    v_and_b32 v19, s22, v43
    v_pk_fma_f32 v[12:13], v[12:13], v[34:35], v[34:35] op_sel:[0,0,1] op_sel_hi:[1,0,1]
    v_pk_fma_f32 v[14:15], v[14:15], v[34:35], v[34:35] op_sel:[0,0,1] op_sel_hi:[1,0,1]
    v_pk_fma_f32 v[16:17], v[16:17], v[34:35], v[34:35] op_sel:[0,0,1] op_sel_hi:[1,0,1]
    v_pk_fma_f32 v[18:19], v[18:19], v[34:35], v[34:35] op_sel:[0,0,1] op_sel_hi:[1,0,1]
    v_cvt_pk_bf16_f32 v40, v12, v13
    v_cvt_pk_bf16_f32 v41, v14, v15
    v_cvt_pk_bf16_f32 v42, v16, v17
    v_cvt_pk_bf16_f32 v43, v18, v19
    global_store_dwordx4 v1, v[40:43], s[14:15] sc1
    s_add_u32 s14, s14, 8192
    s_addc_u32 s15, s15, 0
    v_lshlrev_b32 v12, 16, v44
    v_and_b32 v13, s22, v44
    v_lshlrev_b32 v14, 16, v45
    v_and_b32 v15, s22, v45
    v_lshlrev_b32 v16, 16, v46
    v_and_b32 v17, s22, v46
    v_lshlrev_b32 v18, 16, v47
    v_and_b32 v19, s22, v47
    v_pk_add_f32 v[12:13], v[12:13], v[32:33] op_sel_hi:[1,0] neg_lo:[0,1] neg_hi:[0,1]
    v_pk_add_f32 v[14:15], v[14:15], v[32:33] op_sel_hi:[1,0] neg_lo:[0,1] neg_hi:[0,1]
    v_pk_add_f32 v[16:17], v[16:17], v[32:33] op_sel_hi:[1,0] neg_lo:[0,1] neg_hi:[0,1]
    v_pk_add_f32 v[18:19], v[18:19], v[32:33] op_sel_hi:[1,0] neg_lo:[0,1] neg_hi:[0,1]
    v_cvt_pk_bf16_f32 v44, v12, v13
    v_cvt_pk_bf16_f32 v45, v14, v15
    v_cvt_pk_bf16_f32 v46, v16, v17
    v_cvt_pk_bf16_f32 v47, v18, v19
    v_lshlrev_b32 v12, 16, v44
    v_and_b32 v13, s22, v44
    v_lshlrev_b32 v14, 16, v45
    v_and_b32 v15, s22, v45
    v_lshlrev_b32 v16, 16, v46
    v_and_b32 v17, s22, v46
    v_lshlrev_b32 v18, 16, v47
    v_and_b32 v19, s22, v47
    v_pk_fma_f32 v[12:13], v[12:13], v[34:35], v[34:35] op_sel:[0,0,1] op_sel_hi:[1,0,1]
    v_pk_fma_f32 v[14:15], v[14:15], v[34:35], v[34:35] op_sel:[0,0,1] op_sel_hi:[1,0,1]
    v_pk_fma_f32 v[16:17], v[16:17], v[34:35], v[34:35] op_sel:[0,0,1] op_sel_hi:[1,0,1]
    v_pk_fma_f32 v[18:19], v[18:19], v[34:35], v[34:35] op_sel:[0,0,1] op_sel_hi:[1,0,1]
    v_cvt_pk_bf16_f32 v44, v12, v13
    v_cvt_pk_bf16_f32 v45, v14, v15
    v_cvt_pk_bf16_f32 v46, v16, v17
    v_cvt_pk_bf16_f32 v47, v18, v19
    global_store_dwordx4 v1, v[44:47], s[14:15] sc1
    s_add_u32 s14, s14, 8192
    s_addc_u32 s15, s15, 0
    v_lshlrev_b32 v12, 16, v48
    v_and_b32 v13, s22, v48
    v_lshlrev_b32 v14, 16, v49
    v_and_b32 v15, s22, v49
    v_lshlrev_b32 v16, 16, v50
    v_and_b32 v17, s22, v50
    v_lshlrev_b32 v18, 16, v51
    v_and_b32 v19, s22, v51
    v_pk_add_f32 v[12:13], v[12:13], v[32:33] op_sel_hi:[1,0] neg_lo:[0,1] neg_hi:[0,1]
    v_pk_add_f32 v[14:15], v[14:15], v[32:33] op_sel_hi:[1,0] neg_lo:[0,1] neg_hi:[0,1]
    v_pk_add_f32 v[16:17], v[16:17], v[32:33] op_sel_hi:[1,0] neg_lo:[0,1] neg_hi:[0,1]
    v_pk_add_f32 v[18:19], v[18:19], v[32:33] op_sel_hi:[1,0] neg_lo:[0,1] neg_hi:[0,1]
    v_cvt_pk_bf16_f32 v48, v12, v13
    v_cvt_pk_bf16_f32 v49, v14, v15
    v_cvt_pk_bf16_f32 v50, v16, v17
    v_cvt_pk_bf16_f32 v51, v18, v19
    v_lshlrev_b32 v12, 16, v48
    v_and_b32 v13, s22, v48
    v_lshlrev_b32 v14, 16, v49
    v_and_b32 v15, s22, v49
    v_lshlrev_b32 v16, 16, v50
    v_and_b32 v17, s22, v50
    v_lshlrev_b32 v18, 16, v51
    v_and_b32 v19, s22, v51
    v_pk_fma_f32 v[12:13], v[12:13], v[34:35], v[34:35] op_sel:[0,0,1] op_sel_hi:[1,0,1]
    v_pk_fma_f32 v[14:15], v[14:15], v[34:35], v[34:35] op_sel:[0,0,1] op_sel_hi:[1,0,1]
    v_pk_fma_f32 v[16:17], v[16:17], v[34:35], v[34:35] op_sel:[0,0,1] op_sel_hi:[1,0,1]
    v_pk_fma_f32 v[18:19], v[18:19], v[34:35], v[34:35] op_sel:[0,0,1] op_sel_hi:[1,0,1]
    v_cvt_pk_bf16_f32 v48, v12, v13
    v_cvt_pk_bf16_f32 v49, v14, v15
    v_cvt_pk_bf16_f32 v50, v16, v17
    v_cvt_pk_bf16_f32 v51, v18, v19
    global_store_dwordx4 v1, v[48:51], s[14:15] sc1
    s_add_u32 s14, s14, 8192
    s_addc_u32 s15, s15, 0
    s_add_u32 s14, s10, s42
    s_addc_u32 s15, s11, 0
    v_lshlrev_b32 v12, 16, v180
    v_and_b32 v13, s22, v180
    v_lshlrev_b32 v14, 16, v181
    v_and_b32 v15, s22, v181
    v_lshlrev_b32 v16, 16, v182
    v_and_b32 v17, s22, v182
    v_lshlrev_b32 v18, 16, v183
    v_and_b32 v19, s22, v183
    v_pk_fma_f32 v[12:13], v[12:13], v[8:9], v[8:9] op_sel:[0,0,1] op_sel_hi:[1,0,1]
    v_pk_fma_f32 v[14:15], v[14:15], v[8:9], v[8:9] op_sel:[0,0,1] op_sel_hi:[1,0,1]
    v_pk_fma_f32 v[16:17], v[16:17], v[8:9], v[8:9] op_sel:[0,0,1] op_sel_hi:[1,0,1]
    v_pk_fma_f32 v[18:19], v[18:19], v[8:9], v[8:9] op_sel:[0,0,1] op_sel_hi:[1,0,1]
    v_cvt_pk_bf16_f32 v180, v12, v13
    v_cvt_pk_bf16_f32 v181, v14, v15
    v_cvt_pk_bf16_f32 v182, v16, v17
    v_cvt_pk_bf16_f32 v183, v18, v19
    global_store_dwordx4 v1, v[180:183], s[14:15] sc1
    s_add_u32 s14, s14, 8192
    s_addc_u32 s15, s15, 0
    v_lshlrev_b32 v12, 16, v184
    v_and_b32 v13, s22, v184
    v_lshlrev_b32 v14, 16, v185
    v_and_b32 v15, s22, v185
    v_lshlrev_b32 v16, 16, v186
    v_and_b32 v17, s22, v186
    v_lshlrev_b32 v18, 16, v187
    v_and_b32 v19, s22, v187
    v_pk_fma_f32 v[12:13], v[12:13], v[8:9], v[8:9] op_sel:[0,0,1] op_sel_hi:[1,0,1]
    v_pk_fma_f32 v[14:15], v[14:15], v[8:9], v[8:9] op_sel:[0,0,1] op_sel_hi:[1,0,1]
    v_pk_fma_f32 v[16:17], v[16:17], v[8:9], v[8:9] op_sel:[0,0,1] op_sel_hi:[1,0,1]
    v_pk_fma_f32 v[18:19], v[18:19], v[8:9], v[8:9] op_sel:[0,0,1] op_sel_hi:[1,0,1]
    v_cvt_pk_bf16_f32 v184, v12, v13
    v_cvt_pk_bf16_f32 v185, v14, v15
    v_cvt_pk_bf16_f32 v186, v16, v17
    v_cvt_pk_bf16_f32 v187, v18, v19
    global_store_dwordx4 v1, v[184:187], s[14:15] sc1
    s_add_u32 s14, s14, 8192
    s_addc_u32 s15, s15, 0
    v_lshlrev_b32 v12, 16, v188
    v_and_b32 v13, s22, v188
    v_lshlrev_b32 v14, 16, v189
    v_and_b32 v15, s22, v189
    v_lshlrev_b32 v16, 16, v190
    v_and_b32 v17, s22, v190
    v_lshlrev_b32 v18, 16, v191
    v_and_b32 v19, s22, v191
    v_pk_fma_f32 v[12:13], v[12:13], v[8:9], v[8:9] op_sel:[0,0,1] op_sel_hi:[1,0,1]
    v_pk_fma_f32 v[14:15], v[14:15], v[8:9], v[8:9] op_sel:[0,0,1] op_sel_hi:[1,0,1]
    v_pk_fma_f32 v[16:17], v[16:17], v[8:9], v[8:9] op_sel:[0,0,1] op_sel_hi:[1,0,1]
    v_pk_fma_f32 v[18:19], v[18:19], v[8:9], v[8:9] op_sel:[0,0,1] op_sel_hi:[1,0,1]
    v_cvt_pk_bf16_f32 v188, v12, v13
    v_cvt_pk_bf16_f32 v189, v14, v15
    v_cvt_pk_bf16_f32 v190, v16, v17
    v_cvt_pk_bf16_f32 v191, v18, v19
    global_store_dwordx4 v1, v[188:191], s[14:15] sc1
    s_add_u32 s14, s14, 8192
    s_addc_u32 s15, s15, 0
    v_mov_b32 v4, 0
    v_mov_b32 v5, 0
    v_mov_b32 v6, 0
    v_mov_b32 v7, 0
    s_waitcnt vmcnt(63)
    v_dot2c_f32_bf16 v4, s21, v244
    v_dot2c_f32_bf16 v5, s21, v245
    v_dot2c_f32_bf16 v6, s21, v246
    v_dot2c_f32_bf16 v7, s21, v247
    s_waitcnt vmcnt(63)
    v_dot2c_f32_bf16 v4, s21, v248
    v_dot2c_f32_bf16 v5, s21, v249
    v_dot2c_f32_bf16 v6, s21, v250
    v_dot2c_f32_bf16 v7, s21, v251
    s_waitcnt vmcnt(63)
    v_dot2c_f32_bf16 v4, s21, v252
    v_dot2c_f32_bf16 v5, s21, v253
    v_dot2c_f32_bf16 v6, s21, v254
    v_dot2c_f32_bf16 v7, s21, v255
    s_waitcnt vmcnt(63)
    v_dot2c_f32_bf16 v4, s21, v52
    v_dot2c_f32_bf16 v5, s21, v53
    v_dot2c_f32_bf16 v6, s21, v54
    v_dot2c_f32_bf16 v7, s21, v55
    s_waitcnt vmcnt(63)
    v_dot2c_f32_bf16 v4, s21, v56
    v_dot2c_f32_bf16 v5, s21, v57
    v_dot2c_f32_bf16 v6, s21, v58
    v_dot2c_f32_bf16 v7, s21, v59
    s_waitcnt vmcnt(63)
    v_dot2c_f32_bf16 v4, s21, v60
    v_dot2c_f32_bf16 v5, s21, v61
    v_dot2c_f32_bf16 v6, s21, v62
    v_dot2c_f32_bf16 v7, s21, v63
    s_waitcnt vmcnt(61)
    v_dot2c_f32_bf16 v4, s21, v64
    v_dot2c_f32_bf16 v5, s21, v65
    v_dot2c_f32_bf16 v6, s21, v66
    v_dot2c_f32_bf16 v7, s21, v67
    s_waitcnt vmcnt(59)
    v_dot2c_f32_bf16 v4, s21, v68
    v_dot2c_f32_bf16 v5, s21, v69
    v_dot2c_f32_bf16 v6, s21, v70
    v_dot2c_f32_bf16 v7, s21, v71
    s_waitcnt vmcnt(57)
    v_dot2c_f32_bf16 v4, s21, v72
    v_dot2c_f32_bf16 v5, s21, v73
    v_dot2c_f32_bf16 v6, s21, v74
    v_dot2c_f32_bf16 v7, s21, v75
    s_waitcnt vmcnt(55)
    v_dot2c_f32_bf16 v4, s21, v76
    v_dot2c_f32_bf16 v5, s21, v77
    v_dot2c_f32_bf16 v6, s21, v78
    v_dot2c_f32_bf16 v7, s21, v79
    s_waitcnt vmcnt(53)
    v_dot2c_f32_bf16 v4, s21, v80
    v_dot2c_f32_bf16 v5, s21, v81
    v_dot2c_f32_bf16 v6, s21, v82
    v_dot2c_f32_bf16 v7, s21, v83
    s_waitcnt vmcnt(51)
    v_dot2c_f32_bf16 v4, s21, v84
    v_dot2c_f32_bf16 v5, s21, v85
    v_dot2c_f32_bf16 v6, s21, v86
    v_dot2c_f32_bf16 v7, s21, v87
    s_waitcnt vmcnt(49)
    v_dot2c_f32_bf16 v4, s21, v88
    v_dot2c_f32_bf16 v5, s21, v89
    v_dot2c_f32_bf16 v6, s21, v90
    v_dot2c_f32_bf16 v7, s21, v91
    s_waitcnt vmcnt(47)
    v_dot2c_f32_bf16 v4, s21, v92
    v_dot2c_f32_bf16 v5, s21, v93
    v_dot2c_f32_bf16 v6, s21, v94
    v_dot2c_f32_bf16 v7, s21, v95
    s_waitcnt vmcnt(45)
    v_dot2c_f32_bf16 v4, s21, v96
    v_dot2c_f32_bf16 v5, s21, v97
    v_dot2c_f32_bf16 v6, s21, v98
    v_dot2c_f32_bf16 v7, s21, v99
    s_waitcnt vmcnt(43)
    v_dot2c_f32_bf16 v4, s21, v100
    v_dot2c_f32_bf16 v5, s21, v101
    v_dot2c_f32_bf16 v6, s21, v102
    v_dot2c_f32_bf16 v7, s21, v103
    s_nop 2
    v_add_f32 v4, v4, v5
    v_add_f32 v6, v6, v7
    v_add_f32 v4, v4, v6
    s_nop 1
    v_add_f32_dpp v5, v4, v4 row_ror:8 row_mask:0xf bank_mask:0xf
    s_nop 1
    v_add_f32_dpp v4, v5, v5 row_ror:4 row_mask:0xf bank_mask:0xf
    s_nop 1
    v_add_f32_dpp v5, v4, v4 row_ror:2 row_mask:0xf bank_mask:0xf
    s_nop 1
    v_add_f32_dpp v4, v5, v5 row_ror:1 row_mask:0xf bank_mask:0xf
    ds_write_b32 v2, v4 offset:0
    v_lshlrev_b32 v12, 16, v192
    v_and_b32 v13, s22, v192
    v_lshlrev_b32 v14, 16, v193
    v_and_b32 v15, s22, v193
    v_lshlrev_b32 v16, 16, v194
    v_and_b32 v17, s22, v194
    v_lshlrev_b32 v18, 16, v195
    v_and_b32 v19, s22, v195
    v_pk_fma_f32 v[12:13], v[12:13], v[8:9], v[8:9] op_sel:[0,0,1] op_sel_hi:[1,0,1]
    v_pk_fma_f32 v[14:15], v[14:15], v[8:9], v[8:9] op_sel:[0,0,1] op_sel_hi:[1,0,1]
    v_pk_fma_f32 v[16:17], v[16:17], v[8:9], v[8:9] op_sel:[0,0,1] op_sel_hi:[1,0,1]
    v_pk_fma_f32 v[18:19], v[18:19], v[8:9], v[8:9] op_sel:[0,0,1] op_sel_hi:[1,0,1]
    v_cvt_pk_bf16_f32 v192, v12, v13
    v_cvt_pk_bf16_f32 v193, v14, v15
    v_cvt_pk_bf16_f32 v194, v16, v17
    v_cvt_pk_bf16_f32 v195, v18, v19
    global_store_dwordx4 v1, v[192:195], s[14:15] sc1
    s_add_u32 s14, s14, 8192
    s_addc_u32 s15, s15, 0
    v_lshlrev_b32 v12, 16, v196
    v_and_b32 v13, s22, v196
    v_lshlrev_b32 v14, 16, v197
    v_and_b32 v15, s22, v197
    v_lshlrev_b32 v16, 16, v198
    v_and_b32 v17, s22, v198
    v_lshlrev_b32 v18, 16, v199
    v_and_b32 v19, s22, v199
    v_pk_fma_f32 v[12:13], v[12:13], v[8:9], v[8:9] op_sel:[0,0,1] op_sel_hi:[1,0,1]
    v_pk_fma_f32 v[14:15], v[14:15], v[8:9], v[8:9] op_sel:[0,0,1] op_sel_hi:[1,0,1]
    v_pk_fma_f32 v[16:17], v[16:17], v[8:9], v[8:9] op_sel:[0,0,1] op_sel_hi:[1,0,1]
    v_pk_fma_f32 v[18:19], v[18:19], v[8:9], v[8:9] op_sel:[0,0,1] op_sel_hi:[1,0,1]
    v_cvt_pk_bf16_f32 v196, v12, v13
    v_cvt_pk_bf16_f32 v197, v14, v15
    v_cvt_pk_bf16_f32 v198, v16, v17
    v_cvt_pk_bf16_f32 v199, v18, v19
    global_store_dwordx4 v1, v[196:199], s[14:15] sc1
    s_add_u32 s14, s14, 8192
    s_addc_u32 s15, s15, 0
    s_waitcnt lgkmcnt(0)
    s_barrier
    ds_read_b64 v[4:5], v3 offset:0
    s_waitcnt lgkmcnt(0)
    v_add_f32 v4, v4, v5
    s_nop 1
    v_add_f32_dpp v5, v4, v4 row_ror:8 row_mask:0xf bank_mask:0xf
    s_nop 1
    v_add_f32_dpp v4, v5, v5 row_ror:4 row_mask:0xf bank_mask:0xf
    s_nop 1
    v_add_f32_dpp v5, v4, v4 row_ror:2 row_mask:0xf bank_mask:0xf
    s_nop 1
    v_add_f32_dpp v4, v5, v5 row_ror:1 row_mask:0xf bank_mask:0xf
    v_mul_f32 v4, 0x37800000, v4
    v_cvt_pk_bf16_f32 v4, v4, v4
    v_lshlrev_b32 v20, 16, v4
    v_mov_b32 v4, 0
    v_mov_b32 v5, 0
    v_mov_b32 v6, 0
    v_mov_b32 v7, 0
    v_lshlrev_b32 v12, 16, v200
    v_and_b32 v13, s22, v200
    v_lshlrev_b32 v14, 16, v201
    v_and_b32 v15, s22, v201
    v_lshlrev_b32 v16, 16, v202
    v_and_b32 v17, s22, v202
    v_lshlrev_b32 v18, 16, v203
    v_and_b32 v19, s22, v203
    v_pk_fma_f32 v[12:13], v[12:13], v[8:9], v[8:9] op_sel:[0,0,1] op_sel_hi:[1,0,1]
    v_pk_fma_f32 v[14:15], v[14:15], v[8:9], v[8:9] op_sel:[0,0,1] op_sel_hi:[1,0,1]
    v_pk_fma_f32 v[16:17], v[16:17], v[8:9], v[8:9] op_sel:[0,0,1] op_sel_hi:[1,0,1]
    v_pk_fma_f32 v[18:19], v[18:19], v[8:9], v[8:9] op_sel:[0,0,1] op_sel_hi:[1,0,1]
    v_cvt_pk_bf16_f32 v200, v12, v13
    v_cvt_pk_bf16_f32 v201, v14, v15
    v_cvt_pk_bf16_f32 v202, v16, v17
    v_cvt_pk_bf16_f32 v203, v18, v19
    global_store_dwordx4 v1, v[200:203], s[14:15] sc1
    s_add_u32 s14, s14, 8192
    s_addc_u32 s15, s15, 0
    v_lshlrev_b32 v12, 16, v204
    v_and_b32 v13, s22, v204
    v_lshlrev_b32 v14, 16, v205
    v_and_b32 v15, s22, v205
    v_lshlrev_b32 v16, 16, v206
    v_and_b32 v17, s22, v206
    v_lshlrev_b32 v18, 16, v207
    v_and_b32 v19, s22, v207
    v_pk_fma_f32 v[12:13], v[12:13], v[8:9], v[8:9] op_sel:[0,0,1] op_sel_hi:[1,0,1]
    v_pk_fma_f32 v[14:15], v[14:15], v[8:9], v[8:9] op_sel:[0,0,1] op_sel_hi:[1,0,1]
    v_pk_fma_f32 v[16:17], v[16:17], v[8:9], v[8:9] op_sel:[0,0,1] op_sel_hi:[1,0,1]
    v_pk_fma_f32 v[18:19], v[18:19], v[8:9], v[8:9] op_sel:[0,0,1] op_sel_hi:[1,0,1]
    v_cvt_pk_bf16_f32 v204, v12, v13
    v_cvt_pk_bf16_f32 v205, v14, v15
    v_cvt_pk_bf16_f32 v206, v16, v17
    v_cvt_pk_bf16_f32 v207, v18, v19
    global_store_dwordx4 v1, v[204:207], s[14:15] sc1
    s_add_u32 s14, s14, 8192
    s_addc_u32 s15, s15, 0
    v_lshlrev_b32 v12, 16, v244
    v_and_b32 v13, s22, v244
    v_lshlrev_b32 v14, 16, v245
    v_and_b32 v15, s22, v245
    v_lshlrev_b32 v16, 16, v246
    v_and_b32 v17, s22, v246
    v_lshlrev_b32 v18, 16, v247
    v_and_b32 v19, s22, v247
    v_pk_add_f32 v[12:13], v[12:13], v[20:21] op_sel_hi:[1,0] neg_lo:[0,1] neg_hi:[0,1]
    v_pk_add_f32 v[14:15], v[14:15], v[20:21] op_sel_hi:[1,0] neg_lo:[0,1] neg_hi:[0,1]
    v_pk_add_f32 v[16:17], v[16:17], v[20:21] op_sel_hi:[1,0] neg_lo:[0,1] neg_hi:[0,1]
    v_pk_add_f32 v[18:19], v[18:19], v[20:21] op_sel_hi:[1,0] neg_lo:[0,1] neg_hi:[0,1]
    v_cvt_pk_bf16_f32 v244, v12, v13
    v_cvt_pk_bf16_f32 v245, v14, v15
    v_cvt_pk_bf16_f32 v246, v16, v17
    v_cvt_pk_bf16_f32 v247, v18, v19
    v_dot2c_f32_bf16 v4, v244, v244
    v_dot2c_f32_bf16 v5, v245, v245
    v_dot2c_f32_bf16 v6, v246, v246
    v_dot2c_f32_bf16 v7, v247, v247
    v_lshlrev_b32 v12, 16, v248
    v_and_b32 v13, s22, v248
    v_lshlrev_b32 v14, 16, v249
    v_and_b32 v15, s22, v249
    v_lshlrev_b32 v16, 16, v250
    v_and_b32 v17, s22, v250
    v_lshlrev_b32 v18, 16, v251
    v_and_b32 v19, s22, v251
    v_pk_add_f32 v[12:13], v[12:13], v[20:21] op_sel_hi:[1,0] neg_lo:[0,1] neg_hi:[0,1]
    v_pk_add_f32 v[14:15], v[14:15], v[20:21] op_sel_hi:[1,0] neg_lo:[0,1] neg_hi:[0,1]
    v_pk_add_f32 v[16:17], v[16:17], v[20:21] op_sel_hi:[1,0] neg_lo:[0,1] neg_hi:[0,1]
    v_pk_add_f32 v[18:19], v[18:19], v[20:21] op_sel_hi:[1,0] neg_lo:[0,1] neg_hi:[0,1]
    v_cvt_pk_bf16_f32 v248, v12, v13
    v_cvt_pk_bf16_f32 v249, v14, v15
    v_cvt_pk_bf16_f32 v250, v16, v17
    v_cvt_pk_bf16_f32 v251, v18, v19
    v_dot2c_f32_bf16 v4, v248, v248
    v_dot2c_f32_bf16 v5, v249, v249
    v_dot2c_f32_bf16 v6, v250, v250
    v_dot2c_f32_bf16 v7, v251, v251
    v_lshlrev_b32 v12, 16, v252
    v_and_b32 v13, s22, v252
    v_lshlrev_b32 v14, 16, v253
    v_and_b32 v15, s22, v253
    v_lshlrev_b32 v16, 16, v254
    v_and_b32 v17, s22, v254
    v_lshlrev_b32 v18, 16, v255
    v_and_b32 v19, s22, v255
    v_pk_add_f32 v[12:13], v[12:13], v[20:21] op_sel_hi:[1,0] neg_lo:[0,1] neg_hi:[0,1]
    v_pk_add_f32 v[14:15], v[14:15], v[20:21] op_sel_hi:[1,0] neg_lo:[0,1] neg_hi:[0,1]
    v_pk_add_f32 v[16:17], v[16:17], v[20:21] op_sel_hi:[1,0] neg_lo:[0,1] neg_hi:[0,1]
    v_pk_add_f32 v[18:19], v[18:19], v[20:21] op_sel_hi:[1,0] neg_lo:[0,1] neg_hi:[0,1]
    v_cvt_pk_bf16_f32 v252, v12, v13
    v_cvt_pk_bf16_f32 v253, v14, v15
    v_cvt_pk_bf16_f32 v254, v16, v17
    v_cvt_pk_bf16_f32 v255, v18, v19
    v_dot2c_f32_bf16 v4, v252, v252
    v_dot2c_f32_bf16 v5, v253, v253
    v_dot2c_f32_bf16 v6, v254, v254
    v_dot2c_f32_bf16 v7, v255, v255
    v_lshlrev_b32 v12, 16, v52
    v_and_b32 v13, s22, v52
    v_lshlrev_b32 v14, 16, v53
    v_and_b32 v15, s22, v53
    v_lshlrev_b32 v16, 16, v54
    v_and_b32 v17, s22, v54
    v_lshlrev_b32 v18, 16, v55
    v_and_b32 v19, s22, v55
    v_pk_add_f32 v[12:13], v[12:13], v[20:21] op_sel_hi:[1,0] neg_lo:[0,1] neg_hi:[0,1]
    v_pk_add_f32 v[14:15], v[14:15], v[20:21] op_sel_hi:[1,0] neg_lo:[0,1] neg_hi:[0,1]
    v_pk_add_f32 v[16:17], v[16:17], v[20:21] op_sel_hi:[1,0] neg_lo:[0,1] neg_hi:[0,1]
    v_pk_add_f32 v[18:19], v[18:19], v[20:21] op_sel_hi:[1,0] neg_lo:[0,1] neg_hi:[0,1]
    v_cvt_pk_bf16_f32 v52, v12, v13
    v_cvt_pk_bf16_f32 v53, v14, v15
    v_cvt_pk_bf16_f32 v54, v16, v17
    v_cvt_pk_bf16_f32 v55, v18, v19
    v_dot2c_f32_bf16 v4, v52, v52
    v_dot2c_f32_bf16 v5, v53, v53
    v_dot2c_f32_bf16 v6, v54, v54
    v_dot2c_f32_bf16 v7, v55, v55
    v_lshlrev_b32 v12, 16, v208
    v_and_b32 v13, s22, v208
    v_lshlrev_b32 v14, 16, v209
    v_and_b32 v15, s22, v209
    v_lshlrev_b32 v16, 16, v210
    v_and_b32 v17, s22, v210
    v_lshlrev_b32 v18, 16, v211
    v_and_b32 v19, s22, v211
    v_pk_fma_f32 v[12:13], v[12:13], v[8:9], v[8:9] op_sel:[0,0,1] op_sel_hi:[1,0,1]
    v_pk_fma_f32 v[14:15], v[14:15], v[8:9], v[8:9] op_sel:[0,0,1] op_sel_hi:[1,0,1]
    v_pk_fma_f32 v[16:17], v[16:17], v[8:9], v[8:9] op_sel:[0,0,1] op_sel_hi:[1,0,1]
    v_pk_fma_f32 v[18:19], v[18:19], v[8:9], v[8:9] op_sel:[0,0,1] op_sel_hi:[1,0,1]
    v_cvt_pk_bf16_f32 v208, v12, v13
    v_cvt_pk_bf16_f32 v209, v14, v15
    v_cvt_pk_bf16_f32 v210, v16, v17
    v_cvt_pk_bf16_f32 v211, v18, v19
    global_store_dwordx4 v1, v[208:211], s[14:15] sc1
    s_add_u32 s14, s14, 8192
    s_addc_u32 s15, s15, 0
    v_lshlrev_b32 v12, 16, v212
    v_and_b32 v13, s22, v212
    v_lshlrev_b32 v14, 16, v213
    v_and_b32 v15, s22, v213
    v_lshlrev_b32 v16, 16, v214
    v_and_b32 v17, s22, v214
    v_lshlrev_b32 v18, 16, v215
    v_and_b32 v19, s22, v215
    v_pk_fma_f32 v[12:13], v[12:13], v[8:9], v[8:9] op_sel:[0,0,1] op_sel_hi:[1,0,1]
    v_pk_fma_f32 v[14:15], v[14:15], v[8:9], v[8:9] op_sel:[0,0,1] op_sel_hi:[1,0,1]
    v_pk_fma_f32 v[16:17], v[16:17], v[8:9], v[8:9] op_sel:[0,0,1] op_sel_hi:[1,0,1]
    v_pk_fma_f32 v[18:19], v[18:19], v[8:9], v[8:9] op_sel:[0,0,1] op_sel_hi:[1,0,1]
    v_cvt_pk_bf16_f32 v212, v12, v13
    v_cvt_pk_bf16_f32 v213, v14, v15
    v_cvt_pk_bf16_f32 v214, v16, v17
    v_cvt_pk_bf16_f32 v215, v18, v19
    global_store_dwordx4 v1, v[212:215], s[14:15] sc1
    s_add_u32 s14, s14, 8192
    s_addc_u32 s15, s15, 0
    v_lshlrev_b32 v12, 16, v56
    v_and_b32 v13, s22, v56
    v_lshlrev_b32 v14, 16, v57
    v_and_b32 v15, s22, v57
    v_lshlrev_b32 v16, 16, v58
    v_and_b32 v17, s22, v58
    v_lshlrev_b32 v18, 16, v59
    v_and_b32 v19, s22, v59
    v_pk_add_f32 v[12:13], v[12:13], v[20:21] op_sel_hi:[1,0] neg_lo:[0,1] neg_hi:[0,1]
    v_pk_add_f32 v[14:15], v[14:15], v[20:21] op_sel_hi:[1,0] neg_lo:[0,1] neg_hi:[0,1]
    v_pk_add_f32 v[16:17], v[16:17], v[20:21] op_sel_hi:[1,0] neg_lo:[0,1] neg_hi:[0,1]
    v_pk_add_f32 v[18:19], v[18:19], v[20:21] op_sel_hi:[1,0] neg_lo:[0,1] neg_hi:[0,1]
    v_cvt_pk_bf16_f32 v56, v12, v13
    v_cvt_pk_bf16_f32 v57, v14, v15
    v_cvt_pk_bf16_f32 v58, v16, v17
    v_cvt_pk_bf16_f32 v59, v18, v19
    v_dot2c_f32_bf16 v4, v56, v56
    v_dot2c_f32_bf16 v5, v57, v57
    v_dot2c_f32_bf16 v6, v58, v58
    v_dot2c_f32_bf16 v7, v59, v59
    v_lshlrev_b32 v12, 16, v60
    v_and_b32 v13, s22, v60
    v_lshlrev_b32 v14, 16, v61
    v_and_b32 v15, s22, v61
    v_lshlrev_b32 v16, 16, v62
    v_and_b32 v17, s22, v62
    v_lshlrev_b32 v18, 16, v63
    v_and_b32 v19, s22, v63
    v_pk_add_f32 v[12:13], v[12:13], v[20:21] op_sel_hi:[1,0] neg_lo:[0,1] neg_hi:[0,1]
    v_pk_add_f32 v[14:15], v[14:15], v[20:21] op_sel_hi:[1,0] neg_lo:[0,1] neg_hi:[0,1]
    v_pk_add_f32 v[16:17], v[16:17], v[20:21] op_sel_hi:[1,0] neg_lo:[0,1] neg_hi:[0,1]
    v_pk_add_f32 v[18:19], v[18:19], v[20:21] op_sel_hi:[1,0] neg_lo:[0,1] neg_hi:[0,1]
    v_cvt_pk_bf16_f32 v60, v12, v13
    v_cvt_pk_bf16_f32 v61, v14, v15
    v_cvt_pk_bf16_f32 v62, v16, v17
    v_cvt_pk_bf16_f32 v63, v18, v19
    v_dot2c_f32_bf16 v4, v60, v60
    v_dot2c_f32_bf16 v5, v61, v61
    v_dot2c_f32_bf16 v6, v62, v62
    v_dot2c_f32_bf16 v7, v63, v63
    v_lshlrev_b32 v12, 16, v64
    v_and_b32 v13, s22, v64
    v_lshlrev_b32 v14, 16, v65
    v_and_b32 v15, s22, v65
    v_lshlrev_b32 v16, 16, v66
    v_and_b32 v17, s22, v66
    v_lshlrev_b32 v18, 16, v67
    v_and_b32 v19, s22, v67
    v_pk_add_f32 v[12:13], v[12:13], v[20:21] op_sel_hi:[1,0] neg_lo:[0,1] neg_hi:[0,1]
    v_pk_add_f32 v[14:15], v[14:15], v[20:21] op_sel_hi:[1,0] neg_lo:[0,1] neg_hi:[0,1]
    v_pk_add_f32 v[16:17], v[16:17], v[20:21] op_sel_hi:[1,0] neg_lo:[0,1] neg_hi:[0,1]
    v_pk_add_f32 v[18:19], v[18:19], v[20:21] op_sel_hi:[1,0] neg_lo:[0,1] neg_hi:[0,1]
    v_cvt_pk_bf16_f32 v64, v12, v13
    v_cvt_pk_bf16_f32 v65, v14, v15
    v_cvt_pk_bf16_f32 v66, v16, v17
    v_cvt_pk_bf16_f32 v67, v18, v19
    v_dot2c_f32_bf16 v4, v64, v64
    v_dot2c_f32_bf16 v5, v65, v65
    v_dot2c_f32_bf16 v6, v66, v66
    v_dot2c_f32_bf16 v7, v67, v67
    v_lshlrev_b32 v12, 16, v68
    v_and_b32 v13, s22, v68
    v_lshlrev_b32 v14, 16, v69
    v_and_b32 v15, s22, v69
    v_lshlrev_b32 v16, 16, v70
    v_and_b32 v17, s22, v70
    v_lshlrev_b32 v18, 16, v71
    v_and_b32 v19, s22, v71
    v_pk_add_f32 v[12:13], v[12:13], v[20:21] op_sel_hi:[1,0] neg_lo:[0,1] neg_hi:[0,1]
    v_pk_add_f32 v[14:15], v[14:15], v[20:21] op_sel_hi:[1,0] neg_lo:[0,1] neg_hi:[0,1]
    v_pk_add_f32 v[16:17], v[16:17], v[20:21] op_sel_hi:[1,0] neg_lo:[0,1] neg_hi:[0,1]
    v_pk_add_f32 v[18:19], v[18:19], v[20:21] op_sel_hi:[1,0] neg_lo:[0,1] neg_hi:[0,1]
    v_cvt_pk_bf16_f32 v68, v12, v13
    v_cvt_pk_bf16_f32 v69, v14, v15
    v_cvt_pk_bf16_f32 v70, v16, v17
    v_cvt_pk_bf16_f32 v71, v18, v19
    v_dot2c_f32_bf16 v4, v68, v68
    v_dot2c_f32_bf16 v5, v69, v69
    v_dot2c_f32_bf16 v6, v70, v70
    v_dot2c_f32_bf16 v7, v71, v71
    v_lshlrev_b32 v12, 16, v216
    v_and_b32 v13, s22, v216
    v_lshlrev_b32 v14, 16, v217
    v_and_b32 v15, s22, v217
    v_lshlrev_b32 v16, 16, v218
    v_and_b32 v17, s22, v218
    v_lshlrev_b32 v18, 16, v219
    v_and_b32 v19, s22, v219
    v_pk_fma_f32 v[12:13], v[12:13], v[8:9], v[8:9] op_sel:[0,0,1] op_sel_hi:[1,0,1]
    v_pk_fma_f32 v[14:15], v[14:15], v[8:9], v[8:9] op_sel:[0,0,1] op_sel_hi:[1,0,1]
    v_pk_fma_f32 v[16:17], v[16:17], v[8:9], v[8:9] op_sel:[0,0,1] op_sel_hi:[1,0,1]
    v_pk_fma_f32 v[18:19], v[18:19], v[8:9], v[8:9] op_sel:[0,0,1] op_sel_hi:[1,0,1]
    v_cvt_pk_bf16_f32 v216, v12, v13
    v_cvt_pk_bf16_f32 v217, v14, v15
    v_cvt_pk_bf16_f32 v218, v16, v17
    v_cvt_pk_bf16_f32 v219, v18, v19
    global_store_dwordx4 v1, v[216:219], s[14:15] sc1
    s_add_u32 s14, s14, 8192
    s_addc_u32 s15, s15, 0
    v_lshlrev_b32 v12, 16, v220
    v_and_b32 v13, s22, v220
    v_lshlrev_b32 v14, 16, v221
    v_and_b32 v15, s22, v221
    v_lshlrev_b32 v16, 16, v222
    v_and_b32 v17, s22, v222
    v_lshlrev_b32 v18, 16, v223
    v_and_b32 v19, s22, v223
    v_pk_fma_f32 v[12:13], v[12:13], v[8:9], v[8:9] op_sel:[0,0,1] op_sel_hi:[1,0,1]
    v_pk_fma_f32 v[14:15], v[14:15], v[8:9], v[8:9] op_sel:[0,0,1] op_sel_hi:[1,0,1]
    v_pk_fma_f32 v[16:17], v[16:17], v[8:9], v[8:9] op_sel:[0,0,1] op_sel_hi:[1,0,1]
    v_pk_fma_f32 v[18:19], v[18:19], v[8:9], v[8:9] op_sel:[0,0,1] op_sel_hi:[1,0,1]
    v_cvt_pk_bf16_f32 v220, v12, v13
    v_cvt_pk_bf16_f32 v221, v14, v15
    v_cvt_pk_bf16_f32 v222, v16, v17
    v_cvt_pk_bf16_f32 v223, v18, v19
    global_store_dwordx4 v1, v[220:223], s[14:15] sc1
    s_add_u32 s14, s14, 8192
    s_addc_u32 s15, s15, 0
    v_lshlrev_b32 v12, 16, v72
    v_and_b32 v13, s22, v72
    v_lshlrev_b32 v14, 16, v73
    v_and_b32 v15, s22, v73
    v_lshlrev_b32 v16, 16, v74
    v_and_b32 v17, s22, v74
    v_lshlrev_b32 v18, 16, v75
    v_and_b32 v19, s22, v75
    v_pk_add_f32 v[12:13], v[12:13], v[20:21] op_sel_hi:[1,0] neg_lo:[0,1] neg_hi:[0,1]
    v_pk_add_f32 v[14:15], v[14:15], v[20:21] op_sel_hi:[1,0] neg_lo:[0,1] neg_hi:[0,1]
    v_pk_add_f32 v[16:17], v[16:17], v[20:21] op_sel_hi:[1,0] neg_lo:[0,1] neg_hi:[0,1]
    v_pk_add_f32 v[18:19], v[18:19], v[20:21] op_sel_hi:[1,0] neg_lo:[0,1] neg_hi:[0,1]
    v_cvt_pk_bf16_f32 v72, v12, v13
    v_cvt_pk_bf16_f32 v73, v14, v15
    v_cvt_pk_bf16_f32 v74, v16, v17
    v_cvt_pk_bf16_f32 v75, v18, v19
    v_dot2c_f32_bf16 v4, v72, v72
    v_dot2c_f32_bf16 v5, v73, v73
    v_dot2c_f32_bf16 v6, v74, v74
    v_dot2c_f32_bf16 v7, v75, v75
    v_lshlrev_b32 v12, 16, v76
    v_and_b32 v13, s22, v76
    v_lshlrev_b32 v14, 16, v77
    v_and_b32 v15, s22, v77
    v_lshlrev_b32 v16, 16, v78
    v_and_b32 v17, s22, v78
    v_lshlrev_b32 v18, 16, v79
    v_and_b32 v19, s22, v79
    v_pk_add_f32 v[12:13], v[12:13], v[20:21] op_sel_hi:[1,0] neg_lo:[0,1] neg_hi:[0,1]
    v_pk_add_f32 v[14:15], v[14:15], v[20:21] op_sel_hi:[1,0] neg_lo:[0,1] neg_hi:[0,1]
    v_pk_add_f32 v[16:17], v[16:17], v[20:21] op_sel_hi:[1,0] neg_lo:[0,1] neg_hi:[0,1]
    v_pk_add_f32 v[18:19], v[18:19], v[20:21] op_sel_hi:[1,0] neg_lo:[0,1] neg_hi:[0,1]
    v_cvt_pk_bf16_f32 v76, v12, v13
    v_cvt_pk_bf16_f32 v77, v14, v15
    v_cvt_pk_bf16_f32 v78, v16, v17
    v_cvt_pk_bf16_f32 v79, v18, v19
    v_dot2c_f32_bf16 v4, v76, v76
    v_dot2c_f32_bf16 v5, v77, v77
    v_dot2c_f32_bf16 v6, v78, v78
    v_dot2c_f32_bf16 v7, v79, v79
    v_lshlrev_b32 v12, 16, v80
    v_and_b32 v13, s22, v80
    v_lshlrev_b32 v14, 16, v81
    v_and_b32 v15, s22, v81
    v_lshlrev_b32 v16, 16, v82
    v_and_b32 v17, s22, v82
    v_lshlrev_b32 v18, 16, v83
    v_and_b32 v19, s22, v83
    v_pk_add_f32 v[12:13], v[12:13], v[20:21] op_sel_hi:[1,0] neg_lo:[0,1] neg_hi:[0,1]
    v_pk_add_f32 v[14:15], v[14:15], v[20:21] op_sel_hi:[1,0] neg_lo:[0,1] neg_hi:[0,1]
    v_pk_add_f32 v[16:17], v[16:17], v[20:21] op_sel_hi:[1,0] neg_lo:[0,1] neg_hi:[0,1]
    v_pk_add_f32 v[18:19], v[18:19], v[20:21] op_sel_hi:[1,0] neg_lo:[0,1] neg_hi:[0,1]
    v_cvt_pk_bf16_f32 v80, v12, v13
    v_cvt_pk_bf16_f32 v81, v14, v15
    v_cvt_pk_bf16_f32 v82, v16, v17
    v_cvt_pk_bf16_f32 v83, v18, v19
    v_dot2c_f32_bf16 v4, v80, v80
    v_dot2c_f32_bf16 v5, v81, v81
    v_dot2c_f32_bf16 v6, v82, v82
    v_dot2c_f32_bf16 v7, v83, v83
    v_lshlrev_b32 v12, 16, v84
    v_and_b32 v13, s22, v84
    v_lshlrev_b32 v14, 16, v85
    v_and_b32 v15, s22, v85
    v_lshlrev_b32 v16, 16, v86
    v_and_b32 v17, s22, v86
    v_lshlrev_b32 v18, 16, v87
    v_and_b32 v19, s22, v87
    v_pk_add_f32 v[12:13], v[12:13], v[20:21] op_sel_hi:[1,0] neg_lo:[0,1] neg_hi:[0,1]
    v_pk_add_f32 v[14:15], v[14:15], v[20:21] op_sel_hi:[1,0] neg_lo:[0,1] neg_hi:[0,1]
    v_pk_add_f32 v[16:17], v[16:17], v[20:21] op_sel_hi:[1,0] neg_lo:[0,1] neg_hi:[0,1]
    v_pk_add_f32 v[18:19], v[18:19], v[20:21] op_sel_hi:[1,0] neg_lo:[0,1] neg_hi:[0,1]
    v_cvt_pk_bf16_f32 v84, v12, v13
    v_cvt_pk_bf16_f32 v85, v14, v15
    v_cvt_pk_bf16_f32 v86, v16, v17
    v_cvt_pk_bf16_f32 v87, v18, v19
    v_dot2c_f32_bf16 v4, v84, v84
    v_dot2c_f32_bf16 v5, v85, v85
    v_dot2c_f32_bf16 v6, v86, v86
    v_dot2c_f32_bf16 v7, v87, v87
    v_lshlrev_b32 v12, 16, v224
    v_and_b32 v13, s22, v224
    v_lshlrev_b32 v14, 16, v225
    v_and_b32 v15, s22, v225
    v_lshlrev_b32 v16, 16, v226
    v_and_b32 v17, s22, v226
    v_lshlrev_b32 v18, 16, v227
    v_and_b32 v19, s22, v227
    v_pk_fma_f32 v[12:13], v[12:13], v[8:9], v[8:9] op_sel:[0,0,1] op_sel_hi:[1,0,1]
    v_pk_fma_f32 v[14:15], v[14:15], v[8:9], v[8:9] op_sel:[0,0,1] op_sel_hi:[1,0,1]
    v_pk_fma_f32 v[16:17], v[16:17], v[8:9], v[8:9] op_sel:[0,0,1] op_sel_hi:[1,0,1]
    v_pk_fma_f32 v[18:19], v[18:19], v[8:9], v[8:9] op_sel:[0,0,1] op_sel_hi:[1,0,1]
    v_cvt_pk_bf16_f32 v224, v12, v13
    v_cvt_pk_bf16_f32 v225, v14, v15
    v_cvt_pk_bf16_f32 v226, v16, v17
    v_cvt_pk_bf16_f32 v227, v18, v19
    global_store_dwordx4 v1, v[224:227], s[14:15] sc1
    s_add_u32 s14, s14, 8192
    s_addc_u32 s15, s15, 0
    v_lshlrev_b32 v12, 16, v228
    v_and_b32 v13, s22, v228
    v_lshlrev_b32 v14, 16, v229
    v_and_b32 v15, s22, v229
    v_lshlrev_b32 v16, 16, v230
    v_and_b32 v17, s22, v230
    v_lshlrev_b32 v18, 16, v231
    v_and_b32 v19, s22, v231
    v_pk_fma_f32 v[12:13], v[12:13], v[8:9], v[8:9] op_sel:[0,0,1] op_sel_hi:[1,0,1]
    v_pk_fma_f32 v[14:15], v[14:15], v[8:9], v[8:9] op_sel:[0,0,1] op_sel_hi:[1,0,1]
    v_pk_fma_f32 v[16:17], v[16:17], v[8:9], v[8:9] op_sel:[0,0,1] op_sel_hi:[1,0,1]
    v_pk_fma_f32 v[18:19], v[18:19], v[8:9], v[8:9] op_sel:[0,0,1] op_sel_hi:[1,0,1]
    v_cvt_pk_bf16_f32 v228, v12, v13
    v_cvt_pk_bf16_f32 v229, v14, v15
    v_cvt_pk_bf16_f32 v230, v16, v17
    v_cvt_pk_bf16_f32 v231, v18, v19
    global_store_dwordx4 v1, v[228:231], s[14:15] sc1
    s_add_u32 s14, s14, 8192
    s_addc_u32 s15, s15, 0
    v_lshlrev_b32 v12, 16, v88
    v_and_b32 v13, s22, v88
    v_lshlrev_b32 v14, 16, v89
    v_and_b32 v15, s22, v89
    v_lshlrev_b32 v16, 16, v90
    v_and_b32 v17, s22, v90
    v_lshlrev_b32 v18, 16, v91
    v_and_b32 v19, s22, v91
    v_pk_add_f32 v[12:13], v[12:13], v[20:21] op_sel_hi:[1,0] neg_lo:[0,1] neg_hi:[0,1]
    v_pk_add_f32 v[14:15], v[14:15], v[20:21] op_sel_hi:[1,0] neg_lo:[0,1] neg_hi:[0,1]
    v_pk_add_f32 v[16:17], v[16:17], v[20:21] op_sel_hi:[1,0] neg_lo:[0,1] neg_hi:[0,1]
    v_pk_add_f32 v[18:19], v[18:19], v[20:21] op_sel_hi:[1,0] neg_lo:[0,1] neg_hi:[0,1]
    v_cvt_pk_bf16_f32 v88, v12, v13
    v_cvt_pk_bf16_f32 v89, v14, v15
    v_cvt_pk_bf16_f32 v90, v16, v17
    v_cvt_pk_bf16_f32 v91, v18, v19
    v_dot2c_f32_bf16 v4, v88, v88
    v_dot2c_f32_bf16 v5, v89, v89
    v_dot2c_f32_bf16 v6, v90, v90
    v_dot2c_f32_bf16 v7, v91, v91
    v_lshlrev_b32 v12, 16, v92
    v_and_b32 v13, s22, v92
    v_lshlrev_b32 v14, 16, v93
    v_and_b32 v15, s22, v93
    v_lshlrev_b32 v16, 16, v94
    v_and_b32 v17, s22, v94
    v_lshlrev_b32 v18, 16, v95
    v_and_b32 v19, s22, v95
    v_pk_add_f32 v[12:13], v[12:13], v[20:21] op_sel_hi:[1,0] neg_lo:[0,1] neg_hi:[0,1]
    v_pk_add_f32 v[14:15], v[14:15], v[20:21] op_sel_hi:[1,0] neg_lo:[0,1] neg_hi:[0,1]
    v_pk_add_f32 v[16:17], v[16:17], v[20:21] op_sel_hi:[1,0] neg_lo:[0,1] neg_hi:[0,1]
    v_pk_add_f32 v[18:19], v[18:19], v[20:21] op_sel_hi:[1,0] neg_lo:[0,1] neg_hi:[0,1]
    v_cvt_pk_bf16_f32 v92, v12, v13
    v_cvt_pk_bf16_f32 v93, v14, v15
    v_cvt_pk_bf16_f32 v94, v16, v17
    v_cvt_pk_bf16_f32 v95, v18, v19
    v_dot2c_f32_bf16 v4, v92, v92
    v_dot2c_f32_bf16 v5, v93, v93
    v_dot2c_f32_bf16 v6, v94, v94
    v_dot2c_f32_bf16 v7, v95, v95
    v_lshlrev_b32 v12, 16, v96
    v_and_b32 v13, s22, v96
    v_lshlrev_b32 v14, 16, v97
    v_and_b32 v15, s22, v97
    v_lshlrev_b32 v16, 16, v98
    v_and_b32 v17, s22, v98
    v_lshlrev_b32 v18, 16, v99
    v_and_b32 v19, s22, v99
    v_pk_add_f32 v[12:13], v[12:13], v[20:21] op_sel_hi:[1,0] neg_lo:[0,1] neg_hi:[0,1]
    v_pk_add_f32 v[14:15], v[14:15], v[20:21] op_sel_hi:[1,0] neg_lo:[0,1] neg_hi:[0,1]
    v_pk_add_f32 v[16:17], v[16:17], v[20:21] op_sel_hi:[1,0] neg_lo:[0,1] neg_hi:[0,1]
    v_pk_add_f32 v[18:19], v[18:19], v[20:21] op_sel_hi:[1,0] neg_lo:[0,1] neg_hi:[0,1]
    v_cvt_pk_bf16_f32 v96, v12, v13
    v_cvt_pk_bf16_f32 v97, v14, v15
    v_cvt_pk_bf16_f32 v98, v16, v17
    v_cvt_pk_bf16_f32 v99, v18, v19
    v_dot2c_f32_bf16 v4, v96, v96
    v_dot2c_f32_bf16 v5, v97, v97
    v_dot2c_f32_bf16 v6, v98, v98
    v_dot2c_f32_bf16 v7, v99, v99
    v_lshlrev_b32 v12, 16, v100
    v_and_b32 v13, s22, v100
    v_lshlrev_b32 v14, 16, v101
    v_and_b32 v15, s22, v101
    v_lshlrev_b32 v16, 16, v102
    v_and_b32 v17, s22, v102
    v_lshlrev_b32 v18, 16, v103
    v_and_b32 v19, s22, v103
    v_pk_add_f32 v[12:13], v[12:13], v[20:21] op_sel_hi:[1,0] neg_lo:[0,1] neg_hi:[0,1]
    v_pk_add_f32 v[14:15], v[14:15], v[20:21] op_sel_hi:[1,0] neg_lo:[0,1] neg_hi:[0,1]
    v_pk_add_f32 v[16:17], v[16:17], v[20:21] op_sel_hi:[1,0] neg_lo:[0,1] neg_hi:[0,1]
    v_pk_add_f32 v[18:19], v[18:19], v[20:21] op_sel_hi:[1,0] neg_lo:[0,1] neg_hi:[0,1]
    v_cvt_pk_bf16_f32 v100, v12, v13
    v_cvt_pk_bf16_f32 v101, v14, v15
    v_cvt_pk_bf16_f32 v102, v16, v17
    v_cvt_pk_bf16_f32 v103, v18, v19
    v_dot2c_f32_bf16 v4, v100, v100
    v_dot2c_f32_bf16 v5, v101, v101
    v_dot2c_f32_bf16 v6, v102, v102
    v_dot2c_f32_bf16 v7, v103, v103
    s_nop 2
    v_add_f32 v4, v4, v5
    v_add_f32 v6, v6, v7
    v_add_f32 v4, v4, v6
    s_nop 1
    v_add_f32_dpp v5, v4, v4 row_ror:8 row_mask:0xf bank_mask:0xf
    s_nop 1
    v_add_f32_dpp v4, v5, v5 row_ror:4 row_mask:0xf bank_mask:0xf
    s_nop 1
    v_add_f32_dpp v5, v4, v4 row_ror:2 row_mask:0xf bank_mask:0xf
    s_nop 1
    v_add_f32_dpp v4, v5, v5 row_ror:1 row_mask:0xf bank_mask:0xf
    ds_write_b32 v2, v4 offset:512
    v_lshlrev_b32 v12, 16, v232
    v_and_b32 v13, s22, v232
    v_lshlrev_b32 v14, 16, v233
    v_and_b32 v15, s22, v233
    v_lshlrev_b32 v16, 16, v234
    v_and_b32 v17, s22, v234
    v_lshlrev_b32 v18, 16, v235
    v_and_b32 v19, s22, v235
    v_pk_fma_f32 v[12:13], v[12:13], v[8:9], v[8:9] op_sel:[0,0,1] op_sel_hi:[1,0,1]
    v_pk_fma_f32 v[14:15], v[14:15], v[8:9], v[8:9] op_sel:[0,0,1] op_sel_hi:[1,0,1]
    v_pk_fma_f32 v[16:17], v[16:17], v[8:9], v[8:9] op_sel:[0,0,1] op_sel_hi:[1,0,1]
    v_pk_fma_f32 v[18:19], v[18:19], v[8:9], v[8:9] op_sel:[0,0,1] op_sel_hi:[1,0,1]
    v_cvt_pk_bf16_f32 v232, v12, v13
    v_cvt_pk_bf16_f32 v233, v14, v15
    v_cvt_pk_bf16_f32 v234, v16, v17
    v_cvt_pk_bf16_f32 v235, v18, v19
    global_store_dwordx4 v1, v[232:235], s[14:15] sc1
    s_add_u32 s14, s14, 8192
    s_addc_u32 s15, s15, 0
    v_lshlrev_b32 v12, 16, v236
    v_and_b32 v13, s22, v236
    v_lshlrev_b32 v14, 16, v237
    v_and_b32 v15, s22, v237
    v_lshlrev_b32 v16, 16, v238
    v_and_b32 v17, s22, v238
    v_lshlrev_b32 v18, 16, v239
    v_and_b32 v19, s22, v239
    v_pk_fma_f32 v[12:13], v[12:13], v[8:9], v[8:9] op_sel:[0,0,1] op_sel_hi:[1,0,1]
    v_pk_fma_f32 v[14:15], v[14:15], v[8:9], v[8:9] op_sel:[0,0,1] op_sel_hi:[1,0,1]
    v_pk_fma_f32 v[16:17], v[16:17], v[8:9], v[8:9] op_sel:[0,0,1] op_sel_hi:[1,0,1]
    v_pk_fma_f32 v[18:19], v[18:19], v[8:9], v[8:9] op_sel:[0,0,1] op_sel_hi:[1,0,1]
    v_cvt_pk_bf16_f32 v236, v12, v13
    v_cvt_pk_bf16_f32 v237, v14, v15
    v_cvt_pk_bf16_f32 v238, v16, v17
    v_cvt_pk_bf16_f32 v239, v18, v19
    global_store_dwordx4 v1, v[236:239], s[14:15] sc1
    s_add_u32 s14, s14, 8192
    s_addc_u32 s15, s15, 0
    s_waitcnt lgkmcnt(0)
    s_barrier
    ds_read_b64 v[4:5], v3 offset:512
    s_waitcnt lgkmcnt(0)
    v_add_f32 v4, v4, v5
    s_nop 1
    v_add_f32_dpp v5, v4, v4 row_ror:8 row_mask:0xf bank_mask:0xf
    s_nop 1
    v_add_f32_dpp v4, v5, v5 row_ror:4 row_mask:0xf bank_mask:0xf
    s_nop 1
    v_add_f32_dpp v5, v4, v4 row_ror:2 row_mask:0xf bank_mask:0xf
    s_nop 1
    v_add_f32_dpp v4, v5, v5 row_ror:1 row_mask:0xf bank_mask:0xf
    v_mul_f32 v4, 0x37800000, v4
    v_cvt_pk_bf16_f32 v4, v4, v4
    v_lshlrev_b32 v4, 16, v4
    v_add_f32 v4, 0x3727c5ac, v4
    v_cvt_pk_bf16_f32 v4, v4, v4
    v_lshlrev_b32 v4, 16, v4
    v_sqrt_f32 v4, v4
    s_nop 0
    v_cvt_pk_bf16_f32 v4, v4, v4
    v_lshlrev_b32 v4, 16, v4
    v_rcp_f32 v10, v4
    s_lshl_b32 s32, s66, 16
    s_and_b32 s33, s66, 0xffff0000
    s_lshl_b32 s34, s67, 16
    s_and_b32 s35, s67, 0xffff0000
    s_bitcmp1_b32 s53, 0
    s_cselect_b32 s32, s33, s32
    s_cselect_b32 s34, s35, s34
    v_mul_f32 v10, s32, v10
    v_mov_b32 v11, s34
    v_lshlrev_b32 v12, 16, v240
    v_and_b32 v13, s22, v240
    v_lshlrev_b32 v14, 16, v241
    v_and_b32 v15, s22, v241
    v_lshlrev_b32 v16, 16, v242
    v_and_b32 v17, s22, v242
    v_lshlrev_b32 v18, 16, v243
    v_and_b32 v19, s22, v243
    v_pk_fma_f32 v[12:13], v[12:13], v[8:9], v[8:9] op_sel:[0,0,1] op_sel_hi:[1,0,1]
    v_pk_fma_f32 v[14:15], v[14:15], v[8:9], v[8:9] op_sel:[0,0,1] op_sel_hi:[1,0,1]
    v_pk_fma_f32 v[16:17], v[16:17], v[8:9], v[8:9] op_sel:[0,0,1] op_sel_hi:[1,0,1]
    v_pk_fma_f32 v[18:19], v[18:19], v[8:9], v[8:9] op_sel:[0,0,1] op_sel_hi:[1,0,1]
    v_cvt_pk_bf16_f32 v240, v12, v13
    v_cvt_pk_bf16_f32 v241, v14, v15
    v_cvt_pk_bf16_f32 v242, v16, v17
    v_cvt_pk_bf16_f32 v243, v18, v19
    global_store_dwordx4 v1, v[240:243], s[14:15] sc1
    s_add_u32 s14, s14, 8192
    s_addc_u32 s15, s15, 0
    s_add_u32 s14, s10, s43
    s_addc_u32 s15, s11, 0
    v_lshlrev_b32 v12, 16, v244
    v_and_b32 v13, s22, v244
    v_lshlrev_b32 v14, 16, v245
    v_and_b32 v15, s22, v245
    v_lshlrev_b32 v16, 16, v246
    v_and_b32 v17, s22, v246
    v_lshlrev_b32 v18, 16, v247
    v_and_b32 v19, s22, v247
    v_pk_fma_f32 v[12:13], v[12:13], v[10:11], v[10:11] op_sel:[0,0,1] op_sel_hi:[1,0,1]
    v_pk_fma_f32 v[14:15], v[14:15], v[10:11], v[10:11] op_sel:[0,0,1] op_sel_hi:[1,0,1]
    v_pk_fma_f32 v[16:17], v[16:17], v[10:11], v[10:11] op_sel:[0,0,1] op_sel_hi:[1,0,1]
    v_pk_fma_f32 v[18:19], v[18:19], v[10:11], v[10:11] op_sel:[0,0,1] op_sel_hi:[1,0,1]
    v_cvt_pk_bf16_f32 v244, v12, v13
    v_cvt_pk_bf16_f32 v245, v14, v15
    v_cvt_pk_bf16_f32 v246, v16, v17
    v_cvt_pk_bf16_f32 v247, v18, v19
    global_store_dwordx4 v1, v[244:247], s[14:15] sc1
    s_add_u32 s14, s14, 8192
    s_addc_u32 s15, s15, 0
    v_lshlrev_b32 v12, 16, v248
    v_and_b32 v13, s22, v248
    v_lshlrev_b32 v14, 16, v249
    v_and_b32 v15, s22, v249
    v_lshlrev_b32 v16, 16, v250
    v_and_b32 v17, s22, v250
    v_lshlrev_b32 v18, 16, v251
    v_and_b32 v19, s22, v251
    v_pk_fma_f32 v[12:13], v[12:13], v[10:11], v[10:11] op_sel:[0,0,1] op_sel_hi:[1,0,1]
    v_pk_fma_f32 v[14:15], v[14:15], v[10:11], v[10:11] op_sel:[0,0,1] op_sel_hi:[1,0,1]
    v_pk_fma_f32 v[16:17], v[16:17], v[10:11], v[10:11] op_sel:[0,0,1] op_sel_hi:[1,0,1]
    v_pk_fma_f32 v[18:19], v[18:19], v[10:11], v[10:11] op_sel:[0,0,1] op_sel_hi:[1,0,1]
    v_cvt_pk_bf16_f32 v248, v12, v13
    v_cvt_pk_bf16_f32 v249, v14, v15
    v_cvt_pk_bf16_f32 v250, v16, v17
    v_cvt_pk_bf16_f32 v251, v18, v19
    global_store_dwordx4 v1, v[248:251], s[14:15] sc1
    s_add_u32 s14, s14, 8192
    s_addc_u32 s15, s15, 0
    v_lshlrev_b32 v12, 16, v252
    v_and_b32 v13, s22, v252
    v_lshlrev_b32 v14, 16, v253
    v_and_b32 v15, s22, v253
    v_lshlrev_b32 v16, 16, v254
    v_and_b32 v17, s22, v254
    v_lshlrev_b32 v18, 16, v255
    v_and_b32 v19, s22, v255
    v_pk_fma_f32 v[12:13], v[12:13], v[10:11], v[10:11] op_sel:[0,0,1] op_sel_hi:[1,0,1]
    v_pk_fma_f32 v[14:15], v[14:15], v[10:11], v[10:11] op_sel:[0,0,1] op_sel_hi:[1,0,1]
    v_pk_fma_f32 v[16:17], v[16:17], v[10:11], v[10:11] op_sel:[0,0,1] op_sel_hi:[1,0,1]
    v_pk_fma_f32 v[18:19], v[18:19], v[10:11], v[10:11] op_sel:[0,0,1] op_sel_hi:[1,0,1]
    v_cvt_pk_bf16_f32 v252, v12, v13
    v_cvt_pk_bf16_f32 v253, v14, v15
    v_cvt_pk_bf16_f32 v254, v16, v17
    v_cvt_pk_bf16_f32 v255, v18, v19
    global_store_dwordx4 v1, v[252:255], s[14:15] sc1
    s_add_u32 s14, s14, 8192
    s_addc_u32 s15, s15, 0
    v_mov_b32 v4, 0
    v_mov_b32 v5, 0
    v_mov_b32 v6, 0
    v_mov_b32 v7, 0
    s_waitcnt vmcnt(57)
    v_dot2c_f32_bf16 v4, s21, v104
    v_dot2c_f32_bf16 v5, s21, v105
    v_dot2c_f32_bf16 v6, s21, v106
    v_dot2c_f32_bf16 v7, s21, v107
    s_waitcnt vmcnt(55)
    v_dot2c_f32_bf16 v4, s21, v108
    v_dot2c_f32_bf16 v5, s21, v109
    v_dot2c_f32_bf16 v6, s21, v110
    v_dot2c_f32_bf16 v7, s21, v111
    s_waitcnt vmcnt(53)
    v_dot2c_f32_bf16 v4, s21, v112
    v_dot2c_f32_bf16 v5, s21, v113
    v_dot2c_f32_bf16 v6, s21, v114
    v_dot2c_f32_bf16 v7, s21, v115
    s_waitcnt vmcnt(50)
    v_dot2c_f32_bf16 v4, s21, v116
    v_dot2c_f32_bf16 v5, s21, v117
    v_dot2c_f32_bf16 v6, s21, v118
    v_dot2c_f32_bf16 v7, s21, v119
    s_waitcnt vmcnt(48)
    v_dot2c_f32_bf16 v4, s21, v120
    v_dot2c_f32_bf16 v5, s21, v121
    v_dot2c_f32_bf16 v6, s21, v122
    v_dot2c_f32_bf16 v7, s21, v123
    s_waitcnt vmcnt(46)
    v_dot2c_f32_bf16 v4, s21, v124
    v_dot2c_f32_bf16 v5, s21, v125
    v_dot2c_f32_bf16 v6, s21, v126
    v_dot2c_f32_bf16 v7, s21, v127
    s_waitcnt vmcnt(44)
    v_dot2c_f32_bf16 v4, s21, v128
    v_dot2c_f32_bf16 v5, s21, v129
    v_dot2c_f32_bf16 v6, s21, v130
    v_dot2c_f32_bf16 v7, s21, v131
    s_waitcnt vmcnt(42)
    v_dot2c_f32_bf16 v4, s21, v132
    v_dot2c_f32_bf16 v5, s21, v133
    v_dot2c_f32_bf16 v6, s21, v134
    v_dot2c_f32_bf16 v7, s21, v135
    s_waitcnt vmcnt(40)
    v_dot2c_f32_bf16 v4, s21, v136
    v_dot2c_f32_bf16 v5, s21, v137
    v_dot2c_f32_bf16 v6, s21, v138
    v_dot2c_f32_bf16 v7, s21, v139
    s_waitcnt vmcnt(38)
    v_dot2c_f32_bf16 v4, s21, v140
    v_dot2c_f32_bf16 v5, s21, v141
    v_dot2c_f32_bf16 v6, s21, v142
    v_dot2c_f32_bf16 v7, s21, v143
    s_waitcnt vmcnt(36)
    v_dot2c_f32_bf16 v4, s21, v144
    v_dot2c_f32_bf16 v5, s21, v145
    v_dot2c_f32_bf16 v6, s21, v146
    v_dot2c_f32_bf16 v7, s21, v147
    s_waitcnt vmcnt(34)
    v_dot2c_f32_bf16 v4, s21, v148
    v_dot2c_f32_bf16 v5, s21, v149
    v_dot2c_f32_bf16 v6, s21, v150
    v_dot2c_f32_bf16 v7, s21, v151
    s_waitcnt vmcnt(32)
    v_dot2c_f32_bf16 v4, s21, v152
    v_dot2c_f32_bf16 v5, s21, v153
    v_dot2c_f32_bf16 v6, s21, v154
    v_dot2c_f32_bf16 v7, s21, v155
    s_waitcnt vmcnt(30)
    v_dot2c_f32_bf16 v4, s21, v156
    v_dot2c_f32_bf16 v5, s21, v157
    v_dot2c_f32_bf16 v6, s21, v158
    v_dot2c_f32_bf16 v7, s21, v159
    s_waitcnt vmcnt(28)
    v_dot2c_f32_bf16 v4, s21, v160
    v_dot2c_f32_bf16 v5, s21, v161
    v_dot2c_f32_bf16 v6, s21, v162
    v_dot2c_f32_bf16 v7, s21, v163
    s_waitcnt vmcnt(26)
    v_dot2c_f32_bf16 v4, s21, v164
    v_dot2c_f32_bf16 v5, s21, v165
    v_dot2c_f32_bf16 v6, s21, v166
    v_dot2c_f32_bf16 v7, s21, v167
    s_nop 2
    v_add_f32 v4, v4, v5
    v_add_f32 v6, v6, v7
    v_add_f32 v4, v4, v6
    s_nop 1
    v_add_f32_dpp v5, v4, v4 row_ror:8 row_mask:0xf bank_mask:0xf
    s_nop 1
    v_add_f32_dpp v4, v5, v5 row_ror:4 row_mask:0xf bank_mask:0xf
    s_nop 1
    v_add_f32_dpp v5, v4, v4 row_ror:2 row_mask:0xf bank_mask:0xf
    s_nop 1
    v_add_f32_dpp v4, v5, v5 row_ror:1 row_mask:0xf bank_mask:0xf
    ds_write_b32 v2, v4 offset:0
    v_lshlrev_b32 v12, 16, v52
    v_and_b32 v13, s22, v52
    v_lshlrev_b32 v14, 16, v53
    v_and_b32 v15, s22, v53
    v_lshlrev_b32 v16, 16, v54
    v_and_b32 v17, s22, v54
    v_lshlrev_b32 v18, 16, v55
    v_and_b32 v19, s22, v55
    v_pk_fma_f32 v[12:13], v[12:13], v[10:11], v[10:11] op_sel:[0,0,1] op_sel_hi:[1,0,1]
    v_pk_fma_f32 v[14:15], v[14:15], v[10:11], v[10:11] op_sel:[0,0,1] op_sel_hi:[1,0,1]
    v_pk_fma_f32 v[16:17], v[16:17], v[10:11], v[10:11] op_sel:[0,0,1] op_sel_hi:[1,0,1]
    v_pk_fma_f32 v[18:19], v[18:19], v[10:11], v[10:11] op_sel:[0,0,1] op_sel_hi:[1,0,1]
    v_cvt_pk_bf16_f32 v52, v12, v13
    v_cvt_pk_bf16_f32 v53, v14, v15
    v_cvt_pk_bf16_f32 v54, v16, v17
    v_cvt_pk_bf16_f32 v55, v18, v19
    global_store_dwordx4 v1, v[52:55], s[14:15] sc1
    s_add_u32 s14, s14, 8192
    s_addc_u32 s15, s15, 0
    v_lshlrev_b32 v12, 16, v56
    v_and_b32 v13, s22, v56
    v_lshlrev_b32 v14, 16, v57
    v_and_b32 v15, s22, v57
    v_lshlrev_b32 v16, 16, v58
    v_and_b32 v17, s22, v58
    v_lshlrev_b32 v18, 16, v59
    v_and_b32 v19, s22, v59
    v_pk_fma_f32 v[12:13], v[12:13], v[10:11], v[10:11] op_sel:[0,0,1] op_sel_hi:[1,0,1]
    v_pk_fma_f32 v[14:15], v[14:15], v[10:11], v[10:11] op_sel:[0,0,1] op_sel_hi:[1,0,1]
    v_pk_fma_f32 v[16:17], v[16:17], v[10:11], v[10:11] op_sel:[0,0,1] op_sel_hi:[1,0,1]
    v_pk_fma_f32 v[18:19], v[18:19], v[10:11], v[10:11] op_sel:[0,0,1] op_sel_hi:[1,0,1]
    v_cvt_pk_bf16_f32 v56, v12, v13
    v_cvt_pk_bf16_f32 v57, v14, v15
    v_cvt_pk_bf16_f32 v58, v16, v17
    v_cvt_pk_bf16_f32 v59, v18, v19
    global_store_dwordx4 v1, v[56:59], s[14:15] sc1
    s_add_u32 s14, s14, 8192
    s_addc_u32 s15, s15, 0
    s_waitcnt lgkmcnt(0)
    s_barrier
    ds_read_b64 v[4:5], v3 offset:0
    s_waitcnt lgkmcnt(0)
    v_add_f32 v4, v4, v5
    s_nop 1
    v_add_f32_dpp v5, v4, v4 row_ror:8 row_mask:0xf bank_mask:0xf
    s_nop 1
    v_add_f32_dpp v4, v5, v5 row_ror:4 row_mask:0xf bank_mask:0xf
    s_nop 1
    v_add_f32_dpp v5, v4, v4 row_ror:2 row_mask:0xf bank_mask:0xf
    s_nop 1
    v_add_f32_dpp v4, v5, v5 row_ror:1 row_mask:0xf bank_mask:0xf
    v_mul_f32 v4, 0x37800000, v4
    v_cvt_pk_bf16_f32 v4, v4, v4
    v_lshlrev_b32 v20, 16, v4
    v_mov_b32 v4, 0
    v_mov_b32 v5, 0
    v_mov_b32 v6, 0
    v_mov_b32 v7, 0
    v_lshlrev_b32 v12, 16, v60
    v_and_b32 v13, s22, v60
    v_lshlrev_b32 v14, 16, v61
    v_and_b32 v15, s22, v61
    v_lshlrev_b32 v16, 16, v62
    v_and_b32 v17, s22, v62
    v_lshlrev_b32 v18, 16, v63
    v_and_b32 v19, s22, v63
    v_pk_fma_f32 v[12:13], v[12:13], v[10:11], v[10:11] op_sel:[0,0,1] op_sel_hi:[1,0,1]
    v_pk_fma_f32 v[14:15], v[14:15], v[10:11], v[10:11] op_sel:[0,0,1] op_sel_hi:[1,0,1]
    v_pk_fma_f32 v[16:17], v[16:17], v[10:11], v[10:11] op_sel:[0,0,1] op_sel_hi:[1,0,1]
    v_pk_fma_f32 v[18:19], v[18:19], v[10:11], v[10:11] op_sel:[0,0,1] op_sel_hi:[1,0,1]
    v_cvt_pk_bf16_f32 v60, v12, v13
    v_cvt_pk_bf16_f32 v61, v14, v15
    v_cvt_pk_bf16_f32 v62, v16, v17
    v_cvt_pk_bf16_f32 v63, v18, v19
    global_store_dwordx4 v1, v[60:63], s[14:15] sc1
    s_add_u32 s14, s14, 8192
    s_addc_u32 s15, s15, 0
    v_lshlrev_b32 v12, 16, v64
    v_and_b32 v13, s22, v64
    v_lshlrev_b32 v14, 16, v65
    v_and_b32 v15, s22, v65
    v_lshlrev_b32 v16, 16, v66
    v_and_b32 v17, s22, v66
    v_lshlrev_b32 v18, 16, v67
    v_and_b32 v19, s22, v67
    v_pk_fma_f32 v[12:13], v[12:13], v[10:11], v[10:11] op_sel:[0,0,1] op_sel_hi:[1,0,1]
    v_pk_fma_f32 v[14:15], v[14:15], v[10:11], v[10:11] op_sel:[0,0,1] op_sel_hi:[1,0,1]
    v_pk_fma_f32 v[16:17], v[16:17], v[10:11], v[10:11] op_sel:[0,0,1] op_sel_hi:[1,0,1]
    v_pk_fma_f32 v[18:19], v[18:19], v[10:11], v[10:11] op_sel:[0,0,1] op_sel_hi:[1,0,1]
    v_cvt_pk_bf16_f32 v64, v12, v13
    v_cvt_pk_bf16_f32 v65, v14, v15
    v_cvt_pk_bf16_f32 v66, v16, v17
    v_cvt_pk_bf16_f32 v67, v18, v19
    global_store_dwordx4 v1, v[64:67], s[14:15] sc1
    s_add_u32 s14, s14, 8192
    s_addc_u32 s15, s15, 0
    v_lshlrev_b32 v12, 16, v104
    v_and_b32 v13, s22, v104
    v_lshlrev_b32 v14, 16, v105
    v_and_b32 v15, s22, v105
    v_lshlrev_b32 v16, 16, v106
    v_and_b32 v17, s22, v106
    v_lshlrev_b32 v18, 16, v107
    v_and_b32 v19, s22, v107
    v_pk_add_f32 v[12:13], v[12:13], v[20:21] op_sel_hi:[1,0] neg_lo:[0,1] neg_hi:[0,1]
    v_pk_add_f32 v[14:15], v[14:15], v[20:21] op_sel_hi:[1,0] neg_lo:[0,1] neg_hi:[0,1]
    v_pk_add_f32 v[16:17], v[16:17], v[20:21] op_sel_hi:[1,0] neg_lo:[0,1] neg_hi:[0,1]
    v_pk_add_f32 v[18:19], v[18:19], v[20:21] op_sel_hi:[1,0] neg_lo:[0,1] neg_hi:[0,1]
    v_cvt_pk_bf16_f32 v104, v12, v13
    v_cvt_pk_bf16_f32 v105, v14, v15
    v_cvt_pk_bf16_f32 v106, v16, v17
    v_cvt_pk_bf16_f32 v107, v18, v19
    v_dot2c_f32_bf16 v4, v104, v104
    v_dot2c_f32_bf16 v5, v105, v105
    v_dot2c_f32_bf16 v6, v106, v106
    v_dot2c_f32_bf16 v7, v107, v107
    v_lshlrev_b32 v12, 16, v108
    v_and_b32 v13, s22, v108
    v_lshlrev_b32 v14, 16, v109
    v_and_b32 v15, s22, v109
    v_lshlrev_b32 v16, 16, v110
    v_and_b32 v17, s22, v110
    v_lshlrev_b32 v18, 16, v111
    v_and_b32 v19, s22, v111
    v_pk_add_f32 v[12:13], v[12:13], v[20:21] op_sel_hi:[1,0] neg_lo:[0,1] neg_hi:[0,1]
    v_pk_add_f32 v[14:15], v[14:15], v[20:21] op_sel_hi:[1,0] neg_lo:[0,1] neg_hi:[0,1]
    v_pk_add_f32 v[16:17], v[16:17], v[20:21] op_sel_hi:[1,0] neg_lo:[0,1] neg_hi:[0,1]
    v_pk_add_f32 v[18:19], v[18:19], v[20:21] op_sel_hi:[1,0] neg_lo:[0,1] neg_hi:[0,1]
    v_cvt_pk_bf16_f32 v108, v12, v13
    v_cvt_pk_bf16_f32 v109, v14, v15
    v_cvt_pk_bf16_f32 v110, v16, v17
    v_cvt_pk_bf16_f32 v111, v18, v19
    v_dot2c_f32_bf16 v4, v108, v108
    v_dot2c_f32_bf16 v5, v109, v109
    v_dot2c_f32_bf16 v6, v110, v110
    v_dot2c_f32_bf16 v7, v111, v111
    v_lshlrev_b32 v12, 16, v112
    v_and_b32 v13, s22, v112
    v_lshlrev_b32 v14, 16, v113
    v_and_b32 v15, s22, v113
    v_lshlrev_b32 v16, 16, v114
    v_and_b32 v17, s22, v114
    v_lshlrev_b32 v18, 16, v115
    v_and_b32 v19, s22, v115
    v_pk_add_f32 v[12:13], v[12:13], v[20:21] op_sel_hi:[1,0] neg_lo:[0,1] neg_hi:[0,1]
    v_pk_add_f32 v[14:15], v[14:15], v[20:21] op_sel_hi:[1,0] neg_lo:[0,1] neg_hi:[0,1]
    v_pk_add_f32 v[16:17], v[16:17], v[20:21] op_sel_hi:[1,0] neg_lo:[0,1] neg_hi:[0,1]
    v_pk_add_f32 v[18:19], v[18:19], v[20:21] op_sel_hi:[1,0] neg_lo:[0,1] neg_hi:[0,1]
    v_cvt_pk_bf16_f32 v112, v12, v13
    v_cvt_pk_bf16_f32 v113, v14, v15
    v_cvt_pk_bf16_f32 v114, v16, v17
    v_cvt_pk_bf16_f32 v115, v18, v19
    v_dot2c_f32_bf16 v4, v112, v112
    v_dot2c_f32_bf16 v5, v113, v113
    v_dot2c_f32_bf16 v6, v114, v114
    v_dot2c_f32_bf16 v7, v115, v115
    v_lshlrev_b32 v12, 16, v116
    v_and_b32 v13, s22, v116
    v_lshlrev_b32 v14, 16, v117
    v_and_b32 v15, s22, v117
    v_lshlrev_b32 v16, 16, v118
    v_and_b32 v17, s22, v118
    v_lshlrev_b32 v18, 16, v119
    v_and_b32 v19, s22, v119
    v_pk_add_f32 v[12:13], v[12:13], v[20:21] op_sel_hi:[1,0] neg_lo:[0,1] neg_hi:[0,1]
    v_pk_add_f32 v[14:15], v[14:15], v[20:21] op_sel_hi:[1,0] neg_lo:[0,1] neg_hi:[0,1]
    v_pk_add_f32 v[16:17], v[16:17], v[20:21] op_sel_hi:[1,0] neg_lo:[0,1] neg_hi:[0,1]
    v_pk_add_f32 v[18:19], v[18:19], v[20:21] op_sel_hi:[1,0] neg_lo:[0,1] neg_hi:[0,1]
    v_cvt_pk_bf16_f32 v116, v12, v13
    v_cvt_pk_bf16_f32 v117, v14, v15
    v_cvt_pk_bf16_f32 v118, v16, v17
    v_cvt_pk_bf16_f32 v119, v18, v19
    v_dot2c_f32_bf16 v4, v116, v116
    v_dot2c_f32_bf16 v5, v117, v117
    v_dot2c_f32_bf16 v6, v118, v118
    v_dot2c_f32_bf16 v7, v119, v119
    v_lshlrev_b32 v12, 16, v68
    v_and_b32 v13, s22, v68
    v_lshlrev_b32 v14, 16, v69
    v_and_b32 v15, s22, v69
    v_lshlrev_b32 v16, 16, v70
    v_and_b32 v17, s22, v70
    v_lshlrev_b32 v18, 16, v71
    v_and_b32 v19, s22, v71
    v_pk_fma_f32 v[12:13], v[12:13], v[10:11], v[10:11] op_sel:[0,0,1] op_sel_hi:[1,0,1]
    v_pk_fma_f32 v[14:15], v[14:15], v[10:11], v[10:11] op_sel:[0,0,1] op_sel_hi:[1,0,1]
    v_pk_fma_f32 v[16:17], v[16:17], v[10:11], v[10:11] op_sel:[0,0,1] op_sel_hi:[1,0,1]
    v_pk_fma_f32 v[18:19], v[18:19], v[10:11], v[10:11] op_sel:[0,0,1] op_sel_hi:[1,0,1]
    v_cvt_pk_bf16_f32 v68, v12, v13
    v_cvt_pk_bf16_f32 v69, v14, v15
    v_cvt_pk_bf16_f32 v70, v16, v17
    v_cvt_pk_bf16_f32 v71, v18, v19
    global_store_dwordx4 v1, v[68:71], s[14:15] sc1
    s_add_u32 s14, s14, 8192
    s_addc_u32 s15, s15, 0
    v_lshlrev_b32 v12, 16, v72
    v_and_b32 v13, s22, v72
    v_lshlrev_b32 v14, 16, v73
    v_and_b32 v15, s22, v73
    v_lshlrev_b32 v16, 16, v74
    v_and_b32 v17, s22, v74
    v_lshlrev_b32 v18, 16, v75
    v_and_b32 v19, s22, v75
    v_pk_fma_f32 v[12:13], v[12:13], v[10:11], v[10:11] op_sel:[0,0,1] op_sel_hi:[1,0,1]
    v_pk_fma_f32 v[14:15], v[14:15], v[10:11], v[10:11] op_sel:[0,0,1] op_sel_hi:[1,0,1]
    v_pk_fma_f32 v[16:17], v[16:17], v[10:11], v[10:11] op_sel:[0,0,1] op_sel_hi:[1,0,1]
    v_pk_fma_f32 v[18:19], v[18:19], v[10:11], v[10:11] op_sel:[0,0,1] op_sel_hi:[1,0,1]
    v_cvt_pk_bf16_f32 v72, v12, v13
    v_cvt_pk_bf16_f32 v73, v14, v15
    v_cvt_pk_bf16_f32 v74, v16, v17
    v_cvt_pk_bf16_f32 v75, v18, v19
    global_store_dwordx4 v1, v[72:75], s[14:15] sc1
    s_add_u32 s14, s14, 8192
    s_addc_u32 s15, s15, 0
    v_lshlrev_b32 v12, 16, v120
    v_and_b32 v13, s22, v120
    v_lshlrev_b32 v14, 16, v121
    v_and_b32 v15, s22, v121
    v_lshlrev_b32 v16, 16, v122
    v_and_b32 v17, s22, v122
    v_lshlrev_b32 v18, 16, v123
    v_and_b32 v19, s22, v123
    v_pk_add_f32 v[12:13], v[12:13], v[20:21] op_sel_hi:[1,0] neg_lo:[0,1] neg_hi:[0,1]
    v_pk_add_f32 v[14:15], v[14:15], v[20:21] op_sel_hi:[1,0] neg_lo:[0,1] neg_hi:[0,1]
    v_pk_add_f32 v[16:17], v[16:17], v[20:21] op_sel_hi:[1,0] neg_lo:[0,1] neg_hi:[0,1]
    v_pk_add_f32 v[18:19], v[18:19], v[20:21] op_sel_hi:[1,0] neg_lo:[0,1] neg_hi:[0,1]
    v_cvt_pk_bf16_f32 v120, v12, v13
    v_cvt_pk_bf16_f32 v121, v14, v15
    v_cvt_pk_bf16_f32 v122, v16, v17
    v_cvt_pk_bf16_f32 v123, v18, v19
    v_dot2c_f32_bf16 v4, v120, v120
    v_dot2c_f32_bf16 v5, v121, v121
    v_dot2c_f32_bf16 v6, v122, v122
    v_dot2c_f32_bf16 v7, v123, v123
    v_lshlrev_b32 v12, 16, v124
    v_and_b32 v13, s22, v124
    v_lshlrev_b32 v14, 16, v125
    v_and_b32 v15, s22, v125
    v_lshlrev_b32 v16, 16, v126
    v_and_b32 v17, s22, v126
    v_lshlrev_b32 v18, 16, v127
    v_and_b32 v19, s22, v127
    v_pk_add_f32 v[12:13], v[12:13], v[20:21] op_sel_hi:[1,0] neg_lo:[0,1] neg_hi:[0,1]
    v_pk_add_f32 v[14:15], v[14:15], v[20:21] op_sel_hi:[1,0] neg_lo:[0,1] neg_hi:[0,1]
    v_pk_add_f32 v[16:17], v[16:17], v[20:21] op_sel_hi:[1,0] neg_lo:[0,1] neg_hi:[0,1]
    v_pk_add_f32 v[18:19], v[18:19], v[20:21] op_sel_hi:[1,0] neg_lo:[0,1] neg_hi:[0,1]
    v_cvt_pk_bf16_f32 v124, v12, v13
    v_cvt_pk_bf16_f32 v125, v14, v15
    v_cvt_pk_bf16_f32 v126, v16, v17
    v_cvt_pk_bf16_f32 v127, v18, v19
    v_dot2c_f32_bf16 v4, v124, v124
    v_dot2c_f32_bf16 v5, v125, v125
    v_dot2c_f32_bf16 v6, v126, v126
    v_dot2c_f32_bf16 v7, v127, v127
    v_lshlrev_b32 v12, 16, v128
    v_and_b32 v13, s22, v128
    v_lshlrev_b32 v14, 16, v129
    v_and_b32 v15, s22, v129
    v_lshlrev_b32 v16, 16, v130
    v_and_b32 v17, s22, v130
    v_lshlrev_b32 v18, 16, v131
    v_and_b32 v19, s22, v131
    v_pk_add_f32 v[12:13], v[12:13], v[20:21] op_sel_hi:[1,0] neg_lo:[0,1] neg_hi:[0,1]
    v_pk_add_f32 v[14:15], v[14:15], v[20:21] op_sel_hi:[1,0] neg_lo:[0,1] neg_hi:[0,1]
    v_pk_add_f32 v[16:17], v[16:17], v[20:21] op_sel_hi:[1,0] neg_lo:[0,1] neg_hi:[0,1]
    v_pk_add_f32 v[18:19], v[18:19], v[20:21] op_sel_hi:[1,0] neg_lo:[0,1] neg_hi:[0,1]
    v_cvt_pk_bf16_f32 v128, v12, v13
    v_cvt_pk_bf16_f32 v129, v14, v15
    v_cvt_pk_bf16_f32 v130, v16, v17
    v_cvt_pk_bf16_f32 v131, v18, v19
    v_dot2c_f32_bf16 v4, v128, v128
    v_dot2c_f32_bf16 v5, v129, v129
    v_dot2c_f32_bf16 v6, v130, v130
    v_dot2c_f32_bf16 v7, v131, v131
    v_lshlrev_b32 v12, 16, v132
    v_and_b32 v13, s22, v132
    v_lshlrev_b32 v14, 16, v133
    v_and_b32 v15, s22, v133
    v_lshlrev_b32 v16, 16, v134
    v_and_b32 v17, s22, v134
    v_lshlrev_b32 v18, 16, v135
    v_and_b32 v19, s22, v135
    v_pk_add_f32 v[12:13], v[12:13], v[20:21] op_sel_hi:[1,0] neg_lo:[0,1] neg_hi:[0,1]
    v_pk_add_f32 v[14:15], v[14:15], v[20:21] op_sel_hi:[1,0] neg_lo:[0,1] neg_hi:[0,1]
    v_pk_add_f32 v[16:17], v[16:17], v[20:21] op_sel_hi:[1,0] neg_lo:[0,1] neg_hi:[0,1]
    v_pk_add_f32 v[18:19], v[18:19], v[20:21] op_sel_hi:[1,0] neg_lo:[0,1] neg_hi:[0,1]
    v_cvt_pk_bf16_f32 v132, v12, v13
    v_cvt_pk_bf16_f32 v133, v14, v15
    v_cvt_pk_bf16_f32 v134, v16, v17
    v_cvt_pk_bf16_f32 v135, v18, v19
    v_dot2c_f32_bf16 v4, v132, v132
    v_dot2c_f32_bf16 v5, v133, v133
    v_dot2c_f32_bf16 v6, v134, v134
    v_dot2c_f32_bf16 v7, v135, v135
    v_lshlrev_b32 v12, 16, v76
    v_and_b32 v13, s22, v76
    v_lshlrev_b32 v14, 16, v77
    v_and_b32 v15, s22, v77
    v_lshlrev_b32 v16, 16, v78
    v_and_b32 v17, s22, v78
    v_lshlrev_b32 v18, 16, v79
    v_and_b32 v19, s22, v79
    v_pk_fma_f32 v[12:13], v[12:13], v[10:11], v[10:11] op_sel:[0,0,1] op_sel_hi:[1,0,1]
    v_pk_fma_f32 v[14:15], v[14:15], v[10:11], v[10:11] op_sel:[0,0,1] op_sel_hi:[1,0,1]
    v_pk_fma_f32 v[16:17], v[16:17], v[10:11], v[10:11] op_sel:[0,0,1] op_sel_hi:[1,0,1]
    v_pk_fma_f32 v[18:19], v[18:19], v[10:11], v[10:11] op_sel:[0,0,1] op_sel_hi:[1,0,1]
    v_cvt_pk_bf16_f32 v76, v12, v13
    v_cvt_pk_bf16_f32 v77, v14, v15
    v_cvt_pk_bf16_f32 v78, v16, v17
    v_cvt_pk_bf16_f32 v79, v18, v19
    global_store_dwordx4 v1, v[76:79], s[14:15] sc1
    s_add_u32 s14, s14, 8192
    s_addc_u32 s15, s15, 0
    v_lshlrev_b32 v12, 16, v80
    v_and_b32 v13, s22, v80
    v_lshlrev_b32 v14, 16, v81
    v_and_b32 v15, s22, v81
    v_lshlrev_b32 v16, 16, v82
    v_and_b32 v17, s22, v82
    v_lshlrev_b32 v18, 16, v83
    v_and_b32 v19, s22, v83
    v_pk_fma_f32 v[12:13], v[12:13], v[10:11], v[10:11] op_sel:[0,0,1] op_sel_hi:[1,0,1]
    v_pk_fma_f32 v[14:15], v[14:15], v[10:11], v[10:11] op_sel:[0,0,1] op_sel_hi:[1,0,1]
    v_pk_fma_f32 v[16:17], v[16:17], v[10:11], v[10:11] op_sel:[0,0,1] op_sel_hi:[1,0,1]
    v_pk_fma_f32 v[18:19], v[18:19], v[10:11], v[10:11] op_sel:[0,0,1] op_sel_hi:[1,0,1]
    v_cvt_pk_bf16_f32 v80, v12, v13
    v_cvt_pk_bf16_f32 v81, v14, v15
    v_cvt_pk_bf16_f32 v82, v16, v17
    v_cvt_pk_bf16_f32 v83, v18, v19
    global_store_dwordx4 v1, v[80:83], s[14:15] sc1
    s_add_u32 s14, s14, 8192
    s_addc_u32 s15, s15, 0
    v_lshlrev_b32 v12, 16, v136
    v_and_b32 v13, s22, v136
    v_lshlrev_b32 v14, 16, v137
    v_and_b32 v15, s22, v137
    v_lshlrev_b32 v16, 16, v138
    v_and_b32 v17, s22, v138
    v_lshlrev_b32 v18, 16, v139
    v_and_b32 v19, s22, v139
    v_pk_add_f32 v[12:13], v[12:13], v[20:21] op_sel_hi:[1,0] neg_lo:[0,1] neg_hi:[0,1]
    v_pk_add_f32 v[14:15], v[14:15], v[20:21] op_sel_hi:[1,0] neg_lo:[0,1] neg_hi:[0,1]
    v_pk_add_f32 v[16:17], v[16:17], v[20:21] op_sel_hi:[1,0] neg_lo:[0,1] neg_hi:[0,1]
    v_pk_add_f32 v[18:19], v[18:19], v[20:21] op_sel_hi:[1,0] neg_lo:[0,1] neg_hi:[0,1]
    v_cvt_pk_bf16_f32 v136, v12, v13
    v_cvt_pk_bf16_f32 v137, v14, v15
    v_cvt_pk_bf16_f32 v138, v16, v17
    v_cvt_pk_bf16_f32 v139, v18, v19
    v_dot2c_f32_bf16 v4, v136, v136
    v_dot2c_f32_bf16 v5, v137, v137
    v_dot2c_f32_bf16 v6, v138, v138
    v_dot2c_f32_bf16 v7, v139, v139
    v_lshlrev_b32 v12, 16, v140
    v_and_b32 v13, s22, v140
    v_lshlrev_b32 v14, 16, v141
    v_and_b32 v15, s22, v141
    v_lshlrev_b32 v16, 16, v142
    v_and_b32 v17, s22, v142
    v_lshlrev_b32 v18, 16, v143
    v_and_b32 v19, s22, v143
    v_pk_add_f32 v[12:13], v[12:13], v[20:21] op_sel_hi:[1,0] neg_lo:[0,1] neg_hi:[0,1]
    v_pk_add_f32 v[14:15], v[14:15], v[20:21] op_sel_hi:[1,0] neg_lo:[0,1] neg_hi:[0,1]
    v_pk_add_f32 v[16:17], v[16:17], v[20:21] op_sel_hi:[1,0] neg_lo:[0,1] neg_hi:[0,1]
    v_pk_add_f32 v[18:19], v[18:19], v[20:21] op_sel_hi:[1,0] neg_lo:[0,1] neg_hi:[0,1]
    v_cvt_pk_bf16_f32 v140, v12, v13
    v_cvt_pk_bf16_f32 v141, v14, v15
    v_cvt_pk_bf16_f32 v142, v16, v17
    v_cvt_pk_bf16_f32 v143, v18, v19
    v_dot2c_f32_bf16 v4, v140, v140
    v_dot2c_f32_bf16 v5, v141, v141
    v_dot2c_f32_bf16 v6, v142, v142
    v_dot2c_f32_bf16 v7, v143, v143
    v_lshlrev_b32 v12, 16, v144
    v_and_b32 v13, s22, v144
    v_lshlrev_b32 v14, 16, v145
    v_and_b32 v15, s22, v145
    v_lshlrev_b32 v16, 16, v146
    v_and_b32 v17, s22, v146
    v_lshlrev_b32 v18, 16, v147
    v_and_b32 v19, s22, v147
    v_pk_add_f32 v[12:13], v[12:13], v[20:21] op_sel_hi:[1,0] neg_lo:[0,1] neg_hi:[0,1]
    v_pk_add_f32 v[14:15], v[14:15], v[20:21] op_sel_hi:[1,0] neg_lo:[0,1] neg_hi:[0,1]
    v_pk_add_f32 v[16:17], v[16:17], v[20:21] op_sel_hi:[1,0] neg_lo:[0,1] neg_hi:[0,1]
    v_pk_add_f32 v[18:19], v[18:19], v[20:21] op_sel_hi:[1,0] neg_lo:[0,1] neg_hi:[0,1]
    v_cvt_pk_bf16_f32 v144, v12, v13
    v_cvt_pk_bf16_f32 v145, v14, v15
    v_cvt_pk_bf16_f32 v146, v16, v17
    v_cvt_pk_bf16_f32 v147, v18, v19
    v_dot2c_f32_bf16 v4, v144, v144
    v_dot2c_f32_bf16 v5, v145, v145
    v_dot2c_f32_bf16 v6, v146, v146
    v_dot2c_f32_bf16 v7, v147, v147
    v_lshlrev_b32 v12, 16, v148
    v_and_b32 v13, s22, v148
    v_lshlrev_b32 v14, 16, v149
    v_and_b32 v15, s22, v149
    v_lshlrev_b32 v16, 16, v150
    v_and_b32 v17, s22, v150
    v_lshlrev_b32 v18, 16, v151
    v_and_b32 v19, s22, v151
    v_pk_add_f32 v[12:13], v[12:13], v[20:21] op_sel_hi:[1,0] neg_lo:[0,1] neg_hi:[0,1]
    v_pk_add_f32 v[14:15], v[14:15], v[20:21] op_sel_hi:[1,0] neg_lo:[0,1] neg_hi:[0,1]
    v_pk_add_f32 v[16:17], v[16:17], v[20:21] op_sel_hi:[1,0] neg_lo:[0,1] neg_hi:[0,1]
    v_pk_add_f32 v[18:19], v[18:19], v[20:21] op_sel_hi:[1,0] neg_lo:[0,1] neg_hi:[0,1]
    v_cvt_pk_bf16_f32 v148, v12, v13
    v_cvt_pk_bf16_f32 v149, v14, v15
    v_cvt_pk_bf16_f32 v150, v16, v17
    v_cvt_pk_bf16_f32 v151, v18, v19
    v_dot2c_f32_bf16 v4, v148, v148
    v_dot2c_f32_bf16 v5, v149, v149
    v_dot2c_f32_bf16 v6, v150, v150
    v_dot2c_f32_bf16 v7, v151, v151
    v_lshlrev_b32 v12, 16, v84
    v_and_b32 v13, s22, v84
    v_lshlrev_b32 v14, 16, v85
    v_and_b32 v15, s22, v85
    v_lshlrev_b32 v16, 16, v86
    v_and_b32 v17, s22, v86
    v_lshlrev_b32 v18, 16, v87
    v_and_b32 v19, s22, v87
    v_pk_fma_f32 v[12:13], v[12:13], v[10:11], v[10:11] op_sel:[0,0,1] op_sel_hi:[1,0,1]
    v_pk_fma_f32 v[14:15], v[14:15], v[10:11], v[10:11] op_sel:[0,0,1] op_sel_hi:[1,0,1]
    v_pk_fma_f32 v[16:17], v[16:17], v[10:11], v[10:11] op_sel:[0,0,1] op_sel_hi:[1,0,1]
    v_pk_fma_f32 v[18:19], v[18:19], v[10:11], v[10:11] op_sel:[0,0,1] op_sel_hi:[1,0,1]
    v_cvt_pk_bf16_f32 v84, v12, v13
    v_cvt_pk_bf16_f32 v85, v14, v15
    v_cvt_pk_bf16_f32 v86, v16, v17
    v_cvt_pk_bf16_f32 v87, v18, v19
    global_store_dwordx4 v1, v[84:87], s[14:15] sc1
    s_add_u32 s14, s14, 8192
    s_addc_u32 s15, s15, 0
    v_lshlrev_b32 v12, 16, v88
    v_and_b32 v13, s22, v88
    v_lshlrev_b32 v14, 16, v89
    v_and_b32 v15, s22, v89
    v_lshlrev_b32 v16, 16, v90
    v_and_b32 v17, s22, v90
    v_lshlrev_b32 v18, 16, v91
    v_and_b32 v19, s22, v91
    v_pk_fma_f32 v[12:13], v[12:13], v[10:11], v[10:11] op_sel:[0,0,1] op_sel_hi:[1,0,1]
    v_pk_fma_f32 v[14:15], v[14:15], v[10:11], v[10:11] op_sel:[0,0,1] op_sel_hi:[1,0,1]
    v_pk_fma_f32 v[16:17], v[16:17], v[10:11], v[10:11] op_sel:[0,0,1] op_sel_hi:[1,0,1]
    v_pk_fma_f32 v[18:19], v[18:19], v[10:11], v[10:11] op_sel:[0,0,1] op_sel_hi:[1,0,1]
    v_cvt_pk_bf16_f32 v88, v12, v13
    v_cvt_pk_bf16_f32 v89, v14, v15
    v_cvt_pk_bf16_f32 v90, v16, v17
    v_cvt_pk_bf16_f32 v91, v18, v19
    global_store_dwordx4 v1, v[88:91], s[14:15] sc1
    s_add_u32 s14, s14, 8192
    s_addc_u32 s15, s15, 0
    v_lshlrev_b32 v12, 16, v152
    v_and_b32 v13, s22, v152
    v_lshlrev_b32 v14, 16, v153
    v_and_b32 v15, s22, v153
    v_lshlrev_b32 v16, 16, v154
    v_and_b32 v17, s22, v154
    v_lshlrev_b32 v18, 16, v155
    v_and_b32 v19, s22, v155
    v_pk_add_f32 v[12:13], v[12:13], v[20:21] op_sel_hi:[1,0] neg_lo:[0,1] neg_hi:[0,1]
    v_pk_add_f32 v[14:15], v[14:15], v[20:21] op_sel_hi:[1,0] neg_lo:[0,1] neg_hi:[0,1]
    v_pk_add_f32 v[16:17], v[16:17], v[20:21] op_sel_hi:[1,0] neg_lo:[0,1] neg_hi:[0,1]
    v_pk_add_f32 v[18:19], v[18:19], v[20:21] op_sel_hi:[1,0] neg_lo:[0,1] neg_hi:[0,1]
    v_cvt_pk_bf16_f32 v152, v12, v13
    v_cvt_pk_bf16_f32 v153, v14, v15
    v_cvt_pk_bf16_f32 v154, v16, v17
    v_cvt_pk_bf16_f32 v155, v18, v19
    v_dot2c_f32_bf16 v4, v152, v152
    v_dot2c_f32_bf16 v5, v153, v153
    v_dot2c_f32_bf16 v6, v154, v154
    v_dot2c_f32_bf16 v7, v155, v155
    v_lshlrev_b32 v12, 16, v156
    v_and_b32 v13, s22, v156
    v_lshlrev_b32 v14, 16, v157
    v_and_b32 v15, s22, v157
    v_lshlrev_b32 v16, 16, v158
    v_and_b32 v17, s22, v158
    v_lshlrev_b32 v18, 16, v159
    v_and_b32 v19, s22, v159
    v_pk_add_f32 v[12:13], v[12:13], v[20:21] op_sel_hi:[1,0] neg_lo:[0,1] neg_hi:[0,1]
    v_pk_add_f32 v[14:15], v[14:15], v[20:21] op_sel_hi:[1,0] neg_lo:[0,1] neg_hi:[0,1]
    v_pk_add_f32 v[16:17], v[16:17], v[20:21] op_sel_hi:[1,0] neg_lo:[0,1] neg_hi:[0,1]
    v_pk_add_f32 v[18:19], v[18:19], v[20:21] op_sel_hi:[1,0] neg_lo:[0,1] neg_hi:[0,1]
    v_cvt_pk_bf16_f32 v156, v12, v13
    v_cvt_pk_bf16_f32 v157, v14, v15
    v_cvt_pk_bf16_f32 v158, v16, v17
    v_cvt_pk_bf16_f32 v159, v18, v19
    v_dot2c_f32_bf16 v4, v156, v156
    v_dot2c_f32_bf16 v5, v157, v157
    v_dot2c_f32_bf16 v6, v158, v158
    v_dot2c_f32_bf16 v7, v159, v159
    v_lshlrev_b32 v12, 16, v160
    v_and_b32 v13, s22, v160
    v_lshlrev_b32 v14, 16, v161
    v_and_b32 v15, s22, v161
    v_lshlrev_b32 v16, 16, v162
    v_and_b32 v17, s22, v162
    v_lshlrev_b32 v18, 16, v163
    v_and_b32 v19, s22, v163
    v_pk_add_f32 v[12:13], v[12:13], v[20:21] op_sel_hi:[1,0] neg_lo:[0,1] neg_hi:[0,1]
    v_pk_add_f32 v[14:15], v[14:15], v[20:21] op_sel_hi:[1,0] neg_lo:[0,1] neg_hi:[0,1]
    v_pk_add_f32 v[16:17], v[16:17], v[20:21] op_sel_hi:[1,0] neg_lo:[0,1] neg_hi:[0,1]
    v_pk_add_f32 v[18:19], v[18:19], v[20:21] op_sel_hi:[1,0] neg_lo:[0,1] neg_hi:[0,1]
    v_cvt_pk_bf16_f32 v160, v12, v13
    v_cvt_pk_bf16_f32 v161, v14, v15
    v_cvt_pk_bf16_f32 v162, v16, v17
    v_cvt_pk_bf16_f32 v163, v18, v19
    v_dot2c_f32_bf16 v4, v160, v160
    v_dot2c_f32_bf16 v5, v161, v161
    v_dot2c_f32_bf16 v6, v162, v162
    v_dot2c_f32_bf16 v7, v163, v163
    v_lshlrev_b32 v12, 16, v164
    v_and_b32 v13, s22, v164
    v_lshlrev_b32 v14, 16, v165
    v_and_b32 v15, s22, v165
    v_lshlrev_b32 v16, 16, v166
    v_and_b32 v17, s22, v166
    v_lshlrev_b32 v18, 16, v167
    v_and_b32 v19, s22, v167
    v_pk_add_f32 v[12:13], v[12:13], v[20:21] op_sel_hi:[1,0] neg_lo:[0,1] neg_hi:[0,1]
    v_pk_add_f32 v[14:15], v[14:15], v[20:21] op_sel_hi:[1,0] neg_lo:[0,1] neg_hi:[0,1]
    v_pk_add_f32 v[16:17], v[16:17], v[20:21] op_sel_hi:[1,0] neg_lo:[0,1] neg_hi:[0,1]
    v_pk_add_f32 v[18:19], v[18:19], v[20:21] op_sel_hi:[1,0] neg_lo:[0,1] neg_hi:[0,1]
    v_cvt_pk_bf16_f32 v164, v12, v13
    v_cvt_pk_bf16_f32 v165, v14, v15
    v_cvt_pk_bf16_f32 v166, v16, v17
    v_cvt_pk_bf16_f32 v167, v18, v19
    v_dot2c_f32_bf16 v4, v164, v164
    v_dot2c_f32_bf16 v5, v165, v165
    v_dot2c_f32_bf16 v6, v166, v166
    v_dot2c_f32_bf16 v7, v167, v167
    s_nop 2
    v_add_f32 v4, v4, v5
    v_add_f32 v6, v6, v7
    v_add_f32 v4, v4, v6
    s_nop 1
    v_add_f32_dpp v5, v4, v4 row_ror:8 row_mask:0xf bank_mask:0xf
    s_nop 1
    v_add_f32_dpp v4, v5, v5 row_ror:4 row_mask:0xf bank_mask:0xf
    s_nop 1
    v_add_f32_dpp v5, v4, v4 row_ror:2 row_mask:0xf bank_mask:0xf
    s_nop 1
    v_add_f32_dpp v4, v5, v5 row_ror:1 row_mask:0xf bank_mask:0xf
    ds_write_b32 v2, v4 offset:512
    v_lshlrev_b32 v12, 16, v92
    v_and_b32 v13, s22, v92
    v_lshlrev_b32 v14, 16, v93
    v_and_b32 v15, s22, v93
    v_lshlrev_b32 v16, 16, v94
    v_and_b32 v17, s22, v94
    v_lshlrev_b32 v18, 16, v95
    v_and_b32 v19, s22, v95
    v_pk_fma_f32 v[12:13], v[12:13], v[10:11], v[10:11] op_sel:[0,0,1] op_sel_hi:[1,0,1]
    v_pk_fma_f32 v[14:15], v[14:15], v[10:11], v[10:11] op_sel:[0,0,1] op_sel_hi:[1,0,1]
    v_pk_fma_f32 v[16:17], v[16:17], v[10:11], v[10:11] op_sel:[0,0,1] op_sel_hi:[1,0,1]
    v_pk_fma_f32 v[18:19], v[18:19], v[10:11], v[10:11] op_sel:[0,0,1] op_sel_hi:[1,0,1]
    v_cvt_pk_bf16_f32 v92, v12, v13
    v_cvt_pk_bf16_f32 v93, v14, v15
    v_cvt_pk_bf16_f32 v94, v16, v17
    v_cvt_pk_bf16_f32 v95, v18, v19
    global_store_dwordx4 v1, v[92:95], s[14:15] sc1
    s_add_u32 s14, s14, 8192
    s_addc_u32 s15, s15, 0
    v_lshlrev_b32 v12, 16, v96
    v_and_b32 v13, s22, v96
    v_lshlrev_b32 v14, 16, v97
    v_and_b32 v15, s22, v97
    v_lshlrev_b32 v16, 16, v98
    v_and_b32 v17, s22, v98
    v_lshlrev_b32 v18, 16, v99
    v_and_b32 v19, s22, v99
    v_pk_fma_f32 v[12:13], v[12:13], v[10:11], v[10:11] op_sel:[0,0,1] op_sel_hi:[1,0,1]
    v_pk_fma_f32 v[14:15], v[14:15], v[10:11], v[10:11] op_sel:[0,0,1] op_sel_hi:[1,0,1]
    v_pk_fma_f32 v[16:17], v[16:17], v[10:11], v[10:11] op_sel:[0,0,1] op_sel_hi:[1,0,1]
    v_pk_fma_f32 v[18:19], v[18:19], v[10:11], v[10:11] op_sel:[0,0,1] op_sel_hi:[1,0,1]
    v_cvt_pk_bf16_f32 v96, v12, v13
    v_cvt_pk_bf16_f32 v97, v14, v15
    v_cvt_pk_bf16_f32 v98, v16, v17
    v_cvt_pk_bf16_f32 v99, v18, v19
    global_store_dwordx4 v1, v[96:99], s[14:15] sc1
    s_add_u32 s14, s14, 8192
    s_addc_u32 s15, s15, 0
    s_waitcnt lgkmcnt(0)
    s_barrier
    ds_read_b64 v[4:5], v3 offset:512
    s_waitcnt lgkmcnt(0)
    v_add_f32 v4, v4, v5
    s_nop 1
    v_add_f32_dpp v5, v4, v4 row_ror:8 row_mask:0xf bank_mask:0xf
    s_nop 1
    v_add_f32_dpp v4, v5, v5 row_ror:4 row_mask:0xf bank_mask:0xf
    s_nop 1
    v_add_f32_dpp v5, v4, v4 row_ror:2 row_mask:0xf bank_mask:0xf
    s_nop 1
    v_add_f32_dpp v4, v5, v5 row_ror:1 row_mask:0xf bank_mask:0xf
    v_mul_f32 v4, 0x37800000, v4
    v_cvt_pk_bf16_f32 v4, v4, v4
    v_lshlrev_b32 v4, 16, v4
    v_add_f32 v4, 0x3727c5ac, v4
    v_cvt_pk_bf16_f32 v4, v4, v4
    v_lshlrev_b32 v4, 16, v4
    v_sqrt_f32 v4, v4
    s_nop 0
    v_cvt_pk_bf16_f32 v4, v4, v4
    v_lshlrev_b32 v4, 16, v4
    v_rcp_f32 v8, v4
    s_lshl_b32 s32, s68, 16
    s_and_b32 s33, s68, 0xffff0000
    s_lshl_b32 s34, s69, 16
    s_and_b32 s35, s69, 0xffff0000
    s_bitcmp1_b32 s54, 0
    s_cselect_b32 s32, s33, s32
    s_cselect_b32 s34, s35, s34
    v_mul_f32 v8, s32, v8
    v_mov_b32 v9, s34
    v_lshlrev_b32 v12, 16, v100
    v_and_b32 v13, s22, v100
    v_lshlrev_b32 v14, 16, v101
    v_and_b32 v15, s22, v101
    v_lshlrev_b32 v16, 16, v102
    v_and_b32 v17, s22, v102
    v_lshlrev_b32 v18, 16, v103
    v_and_b32 v19, s22, v103
    v_pk_fma_f32 v[12:13], v[12:13], v[10:11], v[10:11] op_sel:[0,0,1] op_sel_hi:[1,0,1]
    v_pk_fma_f32 v[14:15], v[14:15], v[10:11], v[10:11] op_sel:[0,0,1] op_sel_hi:[1,0,1]
    v_pk_fma_f32 v[16:17], v[16:17], v[10:11], v[10:11] op_sel:[0,0,1] op_sel_hi:[1,0,1]
    v_pk_fma_f32 v[18:19], v[18:19], v[10:11], v[10:11] op_sel:[0,0,1] op_sel_hi:[1,0,1]
    v_cvt_pk_bf16_f32 v100, v12, v13
    v_cvt_pk_bf16_f32 v101, v14, v15
    v_cvt_pk_bf16_f32 v102, v16, v17
    v_cvt_pk_bf16_f32 v103, v18, v19
    global_store_dwordx4 v1, v[100:103], s[14:15] sc1
    s_add_u32 s14, s14, 8192
    s_addc_u32 s15, s15, 0
    s_add_u32 s14, s10, s44
    s_addc_u32 s15, s11, 0
    v_lshlrev_b32 v12, 16, v104
    v_and_b32 v13, s22, v104
    v_lshlrev_b32 v14, 16, v105
    v_and_b32 v15, s22, v105
    v_lshlrev_b32 v16, 16, v106
    v_and_b32 v17, s22, v106
    v_lshlrev_b32 v18, 16, v107
    v_and_b32 v19, s22, v107
    v_pk_fma_f32 v[12:13], v[12:13], v[8:9], v[8:9] op_sel:[0,0,1] op_sel_hi:[1,0,1]
    v_pk_fma_f32 v[14:15], v[14:15], v[8:9], v[8:9] op_sel:[0,0,1] op_sel_hi:[1,0,1]
    v_pk_fma_f32 v[16:17], v[16:17], v[8:9], v[8:9] op_sel:[0,0,1] op_sel_hi:[1,0,1]
    v_pk_fma_f32 v[18:19], v[18:19], v[8:9], v[8:9] op_sel:[0,0,1] op_sel_hi:[1,0,1]
    v_cvt_pk_bf16_f32 v104, v12, v13
    v_cvt_pk_bf16_f32 v105, v14, v15
    v_cvt_pk_bf16_f32 v106, v16, v17
    v_cvt_pk_bf16_f32 v107, v18, v19
    global_store_dwordx4 v1, v[104:107], s[14:15] sc1
    s_add_u32 s14, s14, 8192
    s_addc_u32 s15, s15, 0
    v_lshlrev_b32 v12, 16, v108
    v_and_b32 v13, s22, v108
    v_lshlrev_b32 v14, 16, v109
    v_and_b32 v15, s22, v109
    v_lshlrev_b32 v16, 16, v110
    v_and_b32 v17, s22, v110
    v_lshlrev_b32 v18, 16, v111
    v_and_b32 v19, s22, v111
    v_pk_fma_f32 v[12:13], v[12:13], v[8:9], v[8:9] op_sel:[0,0,1] op_sel_hi:[1,0,1]
    v_pk_fma_f32 v[14:15], v[14:15], v[8:9], v[8:9] op_sel:[0,0,1] op_sel_hi:[1,0,1]
    v_pk_fma_f32 v[16:17], v[16:17], v[8:9], v[8:9] op_sel:[0,0,1] op_sel_hi:[1,0,1]
    v_pk_fma_f32 v[18:19], v[18:19], v[8:9], v[8:9] op_sel:[0,0,1] op_sel_hi:[1,0,1]
    v_cvt_pk_bf16_f32 v108, v12, v13
    v_cvt_pk_bf16_f32 v109, v14, v15
    v_cvt_pk_bf16_f32 v110, v16, v17
    v_cvt_pk_bf16_f32 v111, v18, v19
    global_store_dwordx4 v1, v[108:111], s[14:15] sc1
    s_add_u32 s14, s14, 8192
    s_addc_u32 s15, s15, 0
    v_lshlrev_b32 v12, 16, v112
    v_and_b32 v13, s22, v112
    v_lshlrev_b32 v14, 16, v113
    v_and_b32 v15, s22, v113
    v_lshlrev_b32 v16, 16, v114
    v_and_b32 v17, s22, v114
    v_lshlrev_b32 v18, 16, v115
    v_and_b32 v19, s22, v115
    v_pk_fma_f32 v[12:13], v[12:13], v[8:9], v[8:9] op_sel:[0,0,1] op_sel_hi:[1,0,1]
    v_pk_fma_f32 v[14:15], v[14:15], v[8:9], v[8:9] op_sel:[0,0,1] op_sel_hi:[1,0,1]
    v_pk_fma_f32 v[16:17], v[16:17], v[8:9], v[8:9] op_sel:[0,0,1] op_sel_hi:[1,0,1]
    v_pk_fma_f32 v[18:19], v[18:19], v[8:9], v[8:9] op_sel:[0,0,1] op_sel_hi:[1,0,1]
    v_cvt_pk_bf16_f32 v112, v12, v13
    v_cvt_pk_bf16_f32 v113, v14, v15
    v_cvt_pk_bf16_f32 v114, v16, v17
    v_cvt_pk_bf16_f32 v115, v18, v19
    global_store_dwordx4 v1, v[112:115], s[14:15] sc1
    s_add_u32 s14, s14, 8192
    s_addc_u32 s15, s15, 0
    v_lshlrev_b32 v12, 16, v116
    v_and_b32 v13, s22, v116
    v_lshlrev_b32 v14, 16, v117
    v_and_b32 v15, s22, v117
    v_lshlrev_b32 v16, 16, v118
    v_and_b32 v17, s22, v118
    v_lshlrev_b32 v18, 16, v119
    v_and_b32 v19, s22, v119
    v_pk_fma_f32 v[12:13], v[12:13], v[8:9], v[8:9] op_sel:[0,0,1] op_sel_hi:[1,0,1]
    v_pk_fma_f32 v[14:15], v[14:15], v[8:9], v[8:9] op_sel:[0,0,1] op_sel_hi:[1,0,1]
    v_pk_fma_f32 v[16:17], v[16:17], v[8:9], v[8:9] op_sel:[0,0,1] op_sel_hi:[1,0,1]
    v_pk_fma_f32 v[18:19], v[18:19], v[8:9], v[8:9] op_sel:[0,0,1] op_sel_hi:[1,0,1]
    v_cvt_pk_bf16_f32 v116, v12, v13
    v_cvt_pk_bf16_f32 v117, v14, v15
    v_cvt_pk_bf16_f32 v118, v16, v17
    v_cvt_pk_bf16_f32 v119, v18, v19
    global_store_dwordx4 v1, v[116:119], s[14:15] sc1
    s_add_u32 s14, s14, 8192
    s_addc_u32 s15, s15, 0
    v_lshlrev_b32 v12, 16, v120
    v_and_b32 v13, s22, v120
    v_lshlrev_b32 v14, 16, v121
    v_and_b32 v15, s22, v121
    v_lshlrev_b32 v16, 16, v122
    v_and_b32 v17, s22, v122
    v_lshlrev_b32 v18, 16, v123
    v_and_b32 v19, s22, v123
    v_pk_fma_f32 v[12:13], v[12:13], v[8:9], v[8:9] op_sel:[0,0,1] op_sel_hi:[1,0,1]
    v_pk_fma_f32 v[14:15], v[14:15], v[8:9], v[8:9] op_sel:[0,0,1] op_sel_hi:[1,0,1]
    v_pk_fma_f32 v[16:17], v[16:17], v[8:9], v[8:9] op_sel:[0,0,1] op_sel_hi:[1,0,1]
    v_pk_fma_f32 v[18:19], v[18:19], v[8:9], v[8:9] op_sel:[0,0,1] op_sel_hi:[1,0,1]
    v_cvt_pk_bf16_f32 v120, v12, v13
    v_cvt_pk_bf16_f32 v121, v14, v15
    v_cvt_pk_bf16_f32 v122, v16, v17
    v_cvt_pk_bf16_f32 v123, v18, v19
    global_store_dwordx4 v1, v[120:123], s[14:15] sc1
    s_add_u32 s14, s14, 8192
    s_addc_u32 s15, s15, 0
    v_lshlrev_b32 v12, 16, v124
    v_and_b32 v13, s22, v124
    v_lshlrev_b32 v14, 16, v125
    v_and_b32 v15, s22, v125
    v_lshlrev_b32 v16, 16, v126
    v_and_b32 v17, s22, v126
    v_lshlrev_b32 v18, 16, v127
    v_and_b32 v19, s22, v127
    v_pk_fma_f32 v[12:13], v[12:13], v[8:9], v[8:9] op_sel:[0,0,1] op_sel_hi:[1,0,1]
    v_pk_fma_f32 v[14:15], v[14:15], v[8:9], v[8:9] op_sel:[0,0,1] op_sel_hi:[1,0,1]
    v_pk_fma_f32 v[16:17], v[16:17], v[8:9], v[8:9] op_sel:[0,0,1] op_sel_hi:[1,0,1]
    v_pk_fma_f32 v[18:19], v[18:19], v[8:9], v[8:9] op_sel:[0,0,1] op_sel_hi:[1,0,1]
    v_cvt_pk_bf16_f32 v124, v12, v13
    v_cvt_pk_bf16_f32 v125, v14, v15
    v_cvt_pk_bf16_f32 v126, v16, v17
    v_cvt_pk_bf16_f32 v127, v18, v19
    global_store_dwordx4 v1, v[124:127], s[14:15] sc1
    s_add_u32 s14, s14, 8192
    s_addc_u32 s15, s15, 0
    v_lshlrev_b32 v12, 16, v128
    v_and_b32 v13, s22, v128
    v_lshlrev_b32 v14, 16, v129
    v_and_b32 v15, s22, v129
    v_lshlrev_b32 v16, 16, v130
    v_and_b32 v17, s22, v130
    v_lshlrev_b32 v18, 16, v131
    v_and_b32 v19, s22, v131
    v_pk_fma_f32 v[12:13], v[12:13], v[8:9], v[8:9] op_sel:[0,0,1] op_sel_hi:[1,0,1]
    v_pk_fma_f32 v[14:15], v[14:15], v[8:9], v[8:9] op_sel:[0,0,1] op_sel_hi:[1,0,1]
    v_pk_fma_f32 v[16:17], v[16:17], v[8:9], v[8:9] op_sel:[0,0,1] op_sel_hi:[1,0,1]
    v_pk_fma_f32 v[18:19], v[18:19], v[8:9], v[8:9] op_sel:[0,0,1] op_sel_hi:[1,0,1]
    v_cvt_pk_bf16_f32 v128, v12, v13
    v_cvt_pk_bf16_f32 v129, v14, v15
    v_cvt_pk_bf16_f32 v130, v16, v17
    v_cvt_pk_bf16_f32 v131, v18, v19
    global_store_dwordx4 v1, v[128:131], s[14:15] sc1
    s_add_u32 s14, s14, 8192
    s_addc_u32 s15, s15, 0
    v_lshlrev_b32 v12, 16, v132
    v_and_b32 v13, s22, v132
    v_lshlrev_b32 v14, 16, v133
    v_and_b32 v15, s22, v133
    v_lshlrev_b32 v16, 16, v134
    v_and_b32 v17, s22, v134
    v_lshlrev_b32 v18, 16, v135
    v_and_b32 v19, s22, v135
    v_pk_fma_f32 v[12:13], v[12:13], v[8:9], v[8:9] op_sel:[0,0,1] op_sel_hi:[1,0,1]
    v_pk_fma_f32 v[14:15], v[14:15], v[8:9], v[8:9] op_sel:[0,0,1] op_sel_hi:[1,0,1]
    v_pk_fma_f32 v[16:17], v[16:17], v[8:9], v[8:9] op_sel:[0,0,1] op_sel_hi:[1,0,1]
    v_pk_fma_f32 v[18:19], v[18:19], v[8:9], v[8:9] op_sel:[0,0,1] op_sel_hi:[1,0,1]
    v_cvt_pk_bf16_f32 v132, v12, v13
    v_cvt_pk_bf16_f32 v133, v14, v15
    v_cvt_pk_bf16_f32 v134, v16, v17
    v_cvt_pk_bf16_f32 v135, v18, v19
    global_store_dwordx4 v1, v[132:135], s[14:15] sc1
    s_add_u32 s14, s14, 8192
    s_addc_u32 s15, s15, 0
    v_lshlrev_b32 v12, 16, v136
    v_and_b32 v13, s22, v136
    v_lshlrev_b32 v14, 16, v137
    v_and_b32 v15, s22, v137
    v_lshlrev_b32 v16, 16, v138
    v_and_b32 v17, s22, v138
    v_lshlrev_b32 v18, 16, v139
    v_and_b32 v19, s22, v139
    v_pk_fma_f32 v[12:13], v[12:13], v[8:9], v[8:9] op_sel:[0,0,1] op_sel_hi:[1,0,1]
    v_pk_fma_f32 v[14:15], v[14:15], v[8:9], v[8:9] op_sel:[0,0,1] op_sel_hi:[1,0,1]
    v_pk_fma_f32 v[16:17], v[16:17], v[8:9], v[8:9] op_sel:[0,0,1] op_sel_hi:[1,0,1]
    v_pk_fma_f32 v[18:19], v[18:19], v[8:9], v[8:9] op_sel:[0,0,1] op_sel_hi:[1,0,1]
    v_cvt_pk_bf16_f32 v136, v12, v13
    v_cvt_pk_bf16_f32 v137, v14, v15
    v_cvt_pk_bf16_f32 v138, v16, v17
    v_cvt_pk_bf16_f32 v139, v18, v19
    global_store_dwordx4 v1, v[136:139], s[14:15] sc1
    s_add_u32 s14, s14, 8192
    s_addc_u32 s15, s15, 0
    v_lshlrev_b32 v12, 16, v140
    v_and_b32 v13, s22, v140
    v_lshlrev_b32 v14, 16, v141
    v_and_b32 v15, s22, v141
    v_lshlrev_b32 v16, 16, v142
    v_and_b32 v17, s22, v142
    v_lshlrev_b32 v18, 16, v143
    v_and_b32 v19, s22, v143
    v_pk_fma_f32 v[12:13], v[12:13], v[8:9], v[8:9] op_sel:[0,0,1] op_sel_hi:[1,0,1]
    v_pk_fma_f32 v[14:15], v[14:15], v[8:9], v[8:9] op_sel:[0,0,1] op_sel_hi:[1,0,1]
    v_pk_fma_f32 v[16:17], v[16:17], v[8:9], v[8:9] op_sel:[0,0,1] op_sel_hi:[1,0,1]
    v_pk_fma_f32 v[18:19], v[18:19], v[8:9], v[8:9] op_sel:[0,0,1] op_sel_hi:[1,0,1]
    v_cvt_pk_bf16_f32 v140, v12, v13
    v_cvt_pk_bf16_f32 v141, v14, v15
    v_cvt_pk_bf16_f32 v142, v16, v17
    v_cvt_pk_bf16_f32 v143, v18, v19
    global_store_dwordx4 v1, v[140:143], s[14:15] sc1
    s_add_u32 s14, s14, 8192
    s_addc_u32 s15, s15, 0
    v_lshlrev_b32 v12, 16, v144
    v_and_b32 v13, s22, v144
    v_lshlrev_b32 v14, 16, v145
    v_and_b32 v15, s22, v145
    v_lshlrev_b32 v16, 16, v146
    v_and_b32 v17, s22, v146
    v_lshlrev_b32 v18, 16, v147
    v_and_b32 v19, s22, v147
    v_pk_fma_f32 v[12:13], v[12:13], v[8:9], v[8:9] op_sel:[0,0,1] op_sel_hi:[1,0,1]
    v_pk_fma_f32 v[14:15], v[14:15], v[8:9], v[8:9] op_sel:[0,0,1] op_sel_hi:[1,0,1]
    v_pk_fma_f32 v[16:17], v[16:17], v[8:9], v[8:9] op_sel:[0,0,1] op_sel_hi:[1,0,1]
    v_pk_fma_f32 v[18:19], v[18:19], v[8:9], v[8:9] op_sel:[0,0,1] op_sel_hi:[1,0,1]
    v_cvt_pk_bf16_f32 v144, v12, v13
    v_cvt_pk_bf16_f32 v145, v14, v15
    v_cvt_pk_bf16_f32 v146, v16, v17
    v_cvt_pk_bf16_f32 v147, v18, v19
    global_store_dwordx4 v1, v[144:147], s[14:15] sc1
    s_add_u32 s14, s14, 8192
    s_addc_u32 s15, s15, 0
    v_lshlrev_b32 v12, 16, v148
    v_and_b32 v13, s22, v148
    v_lshlrev_b32 v14, 16, v149
    v_and_b32 v15, s22, v149
    v_lshlrev_b32 v16, 16, v150
    v_and_b32 v17, s22, v150
    v_lshlrev_b32 v18, 16, v151
    v_and_b32 v19, s22, v151
    v_pk_fma_f32 v[12:13], v[12:13], v[8:9], v[8:9] op_sel:[0,0,1] op_sel_hi:[1,0,1]
    v_pk_fma_f32 v[14:15], v[14:15], v[8:9], v[8:9] op_sel:[0,0,1] op_sel_hi:[1,0,1]
    v_pk_fma_f32 v[16:17], v[16:17], v[8:9], v[8:9] op_sel:[0,0,1] op_sel_hi:[1,0,1]
    v_pk_fma_f32 v[18:19], v[18:19], v[8:9], v[8:9] op_sel:[0,0,1] op_sel_hi:[1,0,1]
    v_cvt_pk_bf16_f32 v148, v12, v13
    v_cvt_pk_bf16_f32 v149, v14, v15
    v_cvt_pk_bf16_f32 v150, v16, v17
    v_cvt_pk_bf16_f32 v151, v18, v19
    global_store_dwordx4 v1, v[148:151], s[14:15] sc1
    s_add_u32 s14, s14, 8192
    s_addc_u32 s15, s15, 0
    v_lshlrev_b32 v12, 16, v152
    v_and_b32 v13, s22, v152
    v_lshlrev_b32 v14, 16, v153
    v_and_b32 v15, s22, v153
    v_lshlrev_b32 v16, 16, v154
    v_and_b32 v17, s22, v154
    v_lshlrev_b32 v18, 16, v155
    v_and_b32 v19, s22, v155
    v_pk_fma_f32 v[12:13], v[12:13], v[8:9], v[8:9] op_sel:[0,0,1] op_sel_hi:[1,0,1]
    v_pk_fma_f32 v[14:15], v[14:15], v[8:9], v[8:9] op_sel:[0,0,1] op_sel_hi:[1,0,1]
    v_pk_fma_f32 v[16:17], v[16:17], v[8:9], v[8:9] op_sel:[0,0,1] op_sel_hi:[1,0,1]
    v_pk_fma_f32 v[18:19], v[18:19], v[8:9], v[8:9] op_sel:[0,0,1] op_sel_hi:[1,0,1]
    v_cvt_pk_bf16_f32 v152, v12, v13
    v_cvt_pk_bf16_f32 v153, v14, v15
    v_cvt_pk_bf16_f32 v154, v16, v17
    v_cvt_pk_bf16_f32 v155, v18, v19
    global_store_dwordx4 v1, v[152:155], s[14:15] sc1
    s_add_u32 s14, s14, 8192
    s_addc_u32 s15, s15, 0
    v_lshlrev_b32 v12, 16, v156
    v_and_b32 v13, s22, v156
    v_lshlrev_b32 v14, 16, v157
    v_and_b32 v15, s22, v157
    v_lshlrev_b32 v16, 16, v158
    v_and_b32 v17, s22, v158
    v_lshlrev_b32 v18, 16, v159
    v_and_b32 v19, s22, v159
    v_pk_fma_f32 v[12:13], v[12:13], v[8:9], v[8:9] op_sel:[0,0,1] op_sel_hi:[1,0,1]
    v_pk_fma_f32 v[14:15], v[14:15], v[8:9], v[8:9] op_sel:[0,0,1] op_sel_hi:[1,0,1]
    v_pk_fma_f32 v[16:17], v[16:17], v[8:9], v[8:9] op_sel:[0,0,1] op_sel_hi:[1,0,1]
    v_pk_fma_f32 v[18:19], v[18:19], v[8:9], v[8:9] op_sel:[0,0,1] op_sel_hi:[1,0,1]
    v_cvt_pk_bf16_f32 v156, v12, v13
    v_cvt_pk_bf16_f32 v157, v14, v15
    v_cvt_pk_bf16_f32 v158, v16, v17
    v_cvt_pk_bf16_f32 v159, v18, v19
    global_store_dwordx4 v1, v[156:159], s[14:15] sc1
    s_add_u32 s14, s14, 8192
    s_addc_u32 s15, s15, 0
    v_lshlrev_b32 v12, 16, v160
    v_and_b32 v13, s22, v160
    v_lshlrev_b32 v14, 16, v161
    v_and_b32 v15, s22, v161
    v_lshlrev_b32 v16, 16, v162
    v_and_b32 v17, s22, v162
    v_lshlrev_b32 v18, 16, v163
    v_and_b32 v19, s22, v163
    v_pk_fma_f32 v[12:13], v[12:13], v[8:9], v[8:9] op_sel:[0,0,1] op_sel_hi:[1,0,1]
    v_pk_fma_f32 v[14:15], v[14:15], v[8:9], v[8:9] op_sel:[0,0,1] op_sel_hi:[1,0,1]
    v_pk_fma_f32 v[16:17], v[16:17], v[8:9], v[8:9] op_sel:[0,0,1] op_sel_hi:[1,0,1]
    v_pk_fma_f32 v[18:19], v[18:19], v[8:9], v[8:9] op_sel:[0,0,1] op_sel_hi:[1,0,1]
    v_cvt_pk_bf16_f32 v160, v12, v13
    v_cvt_pk_bf16_f32 v161, v14, v15
    v_cvt_pk_bf16_f32 v162, v16, v17
    v_cvt_pk_bf16_f32 v163, v18, v19
    global_store_dwordx4 v1, v[160:163], s[14:15] sc1
    s_add_u32 s14, s14, 8192
    s_addc_u32 s15, s15, 0
    v_lshlrev_b32 v12, 16, v164
    v_and_b32 v13, s22, v164
    v_lshlrev_b32 v14, 16, v165
    v_and_b32 v15, s22, v165
    v_lshlrev_b32 v16, 16, v166
    v_and_b32 v17, s22, v166
    v_lshlrev_b32 v18, 16, v167
    v_and_b32 v19, s22, v167
    v_pk_fma_f32 v[12:13], v[12:13], v[8:9], v[8:9] op_sel:[0,0,1] op_sel_hi:[1,0,1]
    v_pk_fma_f32 v[14:15], v[14:15], v[8:9], v[8:9] op_sel:[0,0,1] op_sel_hi:[1,0,1]
    v_pk_fma_f32 v[16:17], v[16:17], v[8:9], v[8:9] op_sel:[0,0,1] op_sel_hi:[1,0,1]
    v_pk_fma_f32 v[18:19], v[18:19], v[8:9], v[8:9] op_sel:[0,0,1] op_sel_hi:[1,0,1]
    v_cvt_pk_bf16_f32 v164, v12, v13
    v_cvt_pk_bf16_f32 v165, v14, v15
    v_cvt_pk_bf16_f32 v166, v16, v17
    v_cvt_pk_bf16_f32 v167, v18, v19
    global_store_dwordx4 v1, v[164:167], s[14:15] sc1
    s_add_u32 s14, s14, 8192
    s_addc_u32 s15, s15, 0
    s_branch L_done
L_side1:
    s_waitcnt lgkmcnt(0)
    s_add_u32 s12, s49, 32768
    s_add_u32 s12, s4, s12
    s_addc_u32 s13, s5, 0
    global_load_dwordx4 v[36:39], v1, s[12:13] nt
    s_add_u32 s12, s12, 8192
    s_addc_u32 s13, s13, 0
    global_load_dwordx4 v[40:43], v1, s[12:13] nt
    s_add_u32 s12, s12, 8192
    s_addc_u32 s13, s13, 0
    global_load_dwordx4 v[44:47], v1, s[12:13] nt
    s_add_u32 s12, s12, 8192
    s_addc_u32 s13, s13, 0
    global_load_dwordx4 v[48:51], v1, s[12:13] nt
    s_add_u32 s12, s12, 8192
    s_addc_u32 s13, s13, 0
    global_load_dwordx4 v[52:55], v1, s[12:13] nt
    s_add_u32 s12, s12, 8192
    s_addc_u32 s13, s13, 0
    global_load_dwordx4 v[56:59], v1, s[12:13] nt
    s_add_u32 s12, s12, 8192
    s_addc_u32 s13, s13, 0
    global_load_dwordx4 v[60:63], v1, s[12:13] nt
    s_add_u32 s12, s12, 8192
    s_addc_u32 s13, s13, 0
    global_load_dwordx4 v[64:67], v1, s[12:13] nt
    s_add_u32 s12, s12, 8192
    s_addc_u32 s13, s13, 0
    global_load_dwordx4 v[68:71], v1, s[12:13] nt
    s_add_u32 s12, s12, 8192
    s_addc_u32 s13, s13, 0
    global_load_dwordx4 v[72:75], v1, s[12:13] nt
    s_add_u32 s12, s12, 8192
    s_addc_u32 s13, s13, 0
    global_load_dwordx4 v[76:79], v1, s[12:13] nt
    s_add_u32 s12, s12, 8192
    s_addc_u32 s13, s13, 0
    global_load_dwordx4 v[80:83], v1, s[12:13] nt
    s_add_u32 s12, s12, 8192
    s_addc_u32 s13, s13, 0
    s_getpc_b64 s[38:39]
L_pc1:
    s_sub_u32 s38, s38, L_pc1-L_side1
    s_subb_u32 s39, s39, 0
    global_load_dwordx4 v[24:27], v1, s[38:39]
    s_add_u32 s38, s38, 8192
    s_addc_u32 s39, s39, 0
    global_load_dwordx4 v[24:27], v1, s[38:39]
    s_add_u32 s38, s38, 8192
    s_addc_u32 s39, s39, 0
    global_load_dwordx4 v[24:27], v1, s[38:39]
    s_add_u32 s38, s38, 8192
    s_addc_u32 s39, s39, 0
    global_load_dwordx4 v[24:27], v1, s[38:39]
    s_barrier
    s_add_u32 s12, s4, s45
    s_addc_u32 s13, s5, 0
    global_load_dwordx4 v[84:87], v1, s[12:13] nt
    s_add_u32 s12, s12, 8192
    s_addc_u32 s13, s13, 0
    global_load_dwordx4 v[88:91], v1, s[12:13] nt
    s_add_u32 s12, s12, 8192
    s_addc_u32 s13, s13, 0
    global_load_dwordx4 v[92:95], v1, s[12:13] nt
    s_add_u32 s12, s12, 8192
    s_addc_u32 s13, s13, 0
    global_load_dwordx4 v[96:99], v1, s[12:13] nt
    s_add_u32 s12, s12, 8192
    s_addc_u32 s13, s13, 0
    global_load_dwordx4 v[100:103], v1, s[12:13] nt
    s_add_u32 s12, s12, 8192
    s_addc_u32 s13, s13, 0
    global_load_dwordx4 v[104:107], v1, s[12:13] nt
    s_add_u32 s12, s12, 8192
    s_addc_u32 s13, s13, 0
    global_load_dwordx4 v[108:111], v1, s[12:13] nt
    s_add_u32 s12, s12, 8192
    s_addc_u32 s13, s13, 0
    global_load_dwordx4 v[112:115], v1, s[12:13] nt
    s_add_u32 s12, s12, 8192
    s_addc_u32 s13, s13, 0
    global_load_dwordx4 v[116:119], v1, s[12:13] nt
    s_add_u32 s12, s12, 8192
    s_addc_u32 s13, s13, 0
    global_load_dwordx4 v[120:123], v1, s[12:13] nt
    s_add_u32 s12, s12, 8192
    s_addc_u32 s13, s13, 0
    global_load_dwordx4 v[124:127], v1, s[12:13] nt
    s_add_u32 s12, s12, 8192
    s_addc_u32 s13, s13, 0
    global_load_dwordx4 v[128:131], v1, s[12:13] nt
    s_add_u32 s12, s12, 8192
    s_addc_u32 s13, s13, 0
    global_load_dwordx4 v[132:135], v1, s[12:13] nt
    s_add_u32 s12, s12, 8192
    s_addc_u32 s13, s13, 0
    global_load_dwordx4 v[136:139], v1, s[12:13] nt
    s_add_u32 s12, s12, 8192
    s_addc_u32 s13, s13, 0
    global_load_dwordx4 v[140:143], v1, s[12:13] nt
    s_add_u32 s12, s12, 8192
    s_addc_u32 s13, s13, 0
    global_load_dwordx4 v[144:147], v1, s[12:13] nt
    s_add_u32 s12, s12, 8192
    s_addc_u32 s13, s13, 0
    s_barrier
    s_add_u32 s12, s4, s46
    s_addc_u32 s13, s5, 0
    global_load_dwordx4 v[148:151], v1, s[12:13] nt
    s_add_u32 s12, s12, 8192
    s_addc_u32 s13, s13, 0
    global_load_dwordx4 v[152:155], v1, s[12:13] nt
    s_add_u32 s12, s12, 8192
    s_addc_u32 s13, s13, 0
    global_load_dwordx4 v[156:159], v1, s[12:13] nt
    s_add_u32 s12, s12, 8192
    s_addc_u32 s13, s13, 0
    global_load_dwordx4 v[160:163], v1, s[12:13] nt
    s_add_u32 s12, s12, 8192
    s_addc_u32 s13, s13, 0
    global_load_dwordx4 v[164:167], v1, s[12:13] nt
    s_add_u32 s12, s12, 8192
    s_addc_u32 s13, s13, 0
    global_load_dwordx4 v[168:171], v1, s[12:13] nt
    s_add_u32 s12, s12, 8192
    s_addc_u32 s13, s13, 0
    global_load_dwordx4 v[172:175], v1, s[12:13] nt
    s_add_u32 s12, s12, 8192
    s_addc_u32 s13, s13, 0
    global_load_dwordx4 v[176:179], v1, s[12:13] nt
    s_add_u32 s12, s12, 8192
    s_addc_u32 s13, s13, 0
    global_load_dwordx4 v[180:183], v1, s[12:13] nt
    s_add_u32 s12, s12, 8192
    s_addc_u32 s13, s13, 0
    global_load_dwordx4 v[184:187], v1, s[12:13] nt
    s_add_u32 s12, s12, 8192
    s_addc_u32 s13, s13, 0
    global_load_dwordx4 v[188:191], v1, s[12:13] nt
    s_add_u32 s12, s12, 8192
    s_addc_u32 s13, s13, 0
    global_load_dwordx4 v[192:195], v1, s[12:13] nt
    s_add_u32 s12, s12, 8192
    s_addc_u32 s13, s13, 0
    global_load_dwordx4 v[196:199], v1, s[12:13] nt
    s_add_u32 s12, s12, 8192
    s_addc_u32 s13, s13, 0
    global_load_dwordx4 v[200:203], v1, s[12:13] nt
    s_add_u32 s12, s12, 8192
    s_addc_u32 s13, s13, 0
    global_load_dwordx4 v[204:207], v1, s[12:13] nt
    s_add_u32 s12, s12, 8192
    s_addc_u32 s13, s13, 0
    global_load_dwordx4 v[208:211], v1, s[12:13] nt
    s_add_u32 s12, s12, 8192
    s_addc_u32 s13, s13, 0
    s_barrier
    s_add_u32 s12, s4, s47
    s_addc_u32 s13, s5, 0
    global_load_dwordx4 v[212:215], v1, s[12:13] nt
    s_add_u32 s12, s12, 8192
    s_addc_u32 s13, s13, 0
    global_load_dwordx4 v[216:219], v1, s[12:13] nt
    s_add_u32 s12, s12, 8192
    s_addc_u32 s13, s13, 0
    global_load_dwordx4 v[220:223], v1, s[12:13] nt
    s_add_u32 s12, s12, 8192
    s_addc_u32 s13, s13, 0
    global_load_dwordx4 v[224:227], v1, s[12:13] nt
    s_add_u32 s12, s12, 8192
    s_addc_u32 s13, s13, 0
    global_load_dwordx4 v[228:231], v1, s[12:13] nt
    s_add_u32 s12, s12, 8192
    s_addc_u32 s13, s13, 0
    global_load_dwordx4 v[232:235], v1, s[12:13] nt
    s_add_u32 s12, s12, 8192
    s_addc_u32 s13, s13, 0
    global_load_dwordx4 v[236:239], v1, s[12:13] nt
    s_add_u32 s12, s12, 8192
    s_addc_u32 s13, s13, 0
    global_load_dwordx4 v[240:243], v1, s[12:13] nt
    s_add_u32 s12, s12, 8192
    s_addc_u32 s13, s13, 0
    global_load_dwordx4 v[244:247], v1, s[12:13] nt
    s_add_u32 s12, s12, 8192
    s_addc_u32 s13, s13, 0
    global_load_dwordx4 v[248:251], v1, s[12:13] nt
    s_add_u32 s12, s12, 8192
    s_addc_u32 s13, s13, 0
    global_load_dwordx4 v[252:255], v1, s[12:13] nt
    s_add_u32 s12, s12, 8192
    s_addc_u32 s13, s13, 0
    s_lshl_b32 s27, s27, 6
    s_add_u32 s26, s27, 32
    s_load_dwordx4 s[76:79], s[70:71], s26 glc
    s_add_u32 s26, s27, 40
    s_add_u32 s28, s27, 0
    v_mov_b32 v30, s28
    v_lshrrev_b32 v2, 4, v0
    v_lshlrev_b32 v2, 2, v2
    v_and_b32 v3, 15, v0
    v_lshlrev_b32 v3, 3, v3
    s_mov_b32 s21, 0x3f803f80
    s_mov_b32 s22, 0xffff0000
    s_lshl_b32 s17, s55, 1
    s_and_b32 s17, s17, 0xfffffffc
    s_load_dword s60, s[6:7], s17
    s_load_dword s61, s[8:9], s17
    s_lshl_b32 s17, s56, 1
    s_and_b32 s17, s17, 0xfffffffc
    s_load_dword s62, s[6:7], s17
    s_load_dword s63, s[8:9], s17
    s_lshl_b32 s17, s57, 1
    s_and_b32 s17, s17, 0xfffffffc
    s_load_dword s64, s[6:7], s17
    s_load_dword s65, s[8:9], s17
    s_lshl_b32 s17, s58, 1
    s_and_b32 s17, s17, 0xfffffffc
    s_load_dword s66, s[6:7], s17
    s_load_dword s67, s[8:9], s17
    s_lshl_b32 s17, s59, 1
    s_and_b32 s17, s17, 0xfffffffc
    s_load_dword s68, s[6:7], s17
    s_load_dword s69, s[8:9], s17
    v_mov_b32 v4, 0
    v_mov_b32 v5, 0
    v_mov_b32 v6, 0
    v_mov_b32 v7, 0
    s_waitcnt vmcnt(58)
    v_dot2c_f32_bf16 v4, s21, v36
    v_dot2c_f32_bf16 v5, s21, v37
    v_dot2c_f32_bf16 v6, s21, v38
    v_dot2c_f32_bf16 v7, s21, v39
    s_waitcnt vmcnt(57)
    v_dot2c_f32_bf16 v4, s21, v40
    v_dot2c_f32_bf16 v5, s21, v41
    v_dot2c_f32_bf16 v6, s21, v42
    v_dot2c_f32_bf16 v7, s21, v43
    s_waitcnt vmcnt(56)
    v_dot2c_f32_bf16 v4, s21, v44
    v_dot2c_f32_bf16 v5, s21, v45
    v_dot2c_f32_bf16 v6, s21, v46
    v_dot2c_f32_bf16 v7, s21, v47
    s_waitcnt vmcnt(55)
    v_dot2c_f32_bf16 v4, s21, v48
    v_dot2c_f32_bf16 v5, s21, v49
    v_dot2c_f32_bf16 v6, s21, v50
    v_dot2c_f32_bf16 v7, s21, v51
    s_waitcnt vmcnt(54)
    v_dot2c_f32_bf16 v4, s21, v52
    v_dot2c_f32_bf16 v5, s21, v53
    v_dot2c_f32_bf16 v6, s21, v54
    v_dot2c_f32_bf16 v7, s21, v55
    s_waitcnt vmcnt(53)
    v_dot2c_f32_bf16 v4, s21, v56
    v_dot2c_f32_bf16 v5, s21, v57
    v_dot2c_f32_bf16 v6, s21, v58
    v_dot2c_f32_bf16 v7, s21, v59
    s_waitcnt vmcnt(52)
    v_dot2c_f32_bf16 v4, s21, v60
    v_dot2c_f32_bf16 v5, s21, v61
    v_dot2c_f32_bf16 v6, s21, v62
    v_dot2c_f32_bf16 v7, s21, v63
    s_waitcnt vmcnt(51)
    v_dot2c_f32_bf16 v4, s21, v64
    v_dot2c_f32_bf16 v5, s21, v65
    v_dot2c_f32_bf16 v6, s21, v66
    v_dot2c_f32_bf16 v7, s21, v67
    s_waitcnt vmcnt(50)
    v_dot2c_f32_bf16 v4, s21, v68
    v_dot2c_f32_bf16 v5, s21, v69
    v_dot2c_f32_bf16 v6, s21, v70
    v_dot2c_f32_bf16 v7, s21, v71
    s_waitcnt vmcnt(49)
    v_dot2c_f32_bf16 v4, s21, v72
    v_dot2c_f32_bf16 v5, s21, v73
    v_dot2c_f32_bf16 v6, s21, v74
    v_dot2c_f32_bf16 v7, s21, v75
    s_waitcnt vmcnt(48)
    v_dot2c_f32_bf16 v4, s21, v76
    v_dot2c_f32_bf16 v5, s21, v77
    v_dot2c_f32_bf16 v6, s21, v78
    v_dot2c_f32_bf16 v7, s21, v79
    s_waitcnt vmcnt(47)
    v_dot2c_f32_bf16 v4, s21, v80
    v_dot2c_f32_bf16 v5, s21, v81
    v_dot2c_f32_bf16 v6, s21, v82
    v_dot2c_f32_bf16 v7, s21, v83
    s_nop 2
    v_add_f32 v4, v4, v5
    v_add_f32 v6, v6, v7
    v_add_f32 v4, v4, v6
    s_nop 1
    v_add_f32_dpp v5, v4, v4 row_ror:8 row_mask:0xf bank_mask:0xf
    s_nop 1
    v_add_f32_dpp v4, v5, v5 row_ror:4 row_mask:0xf bank_mask:0xf
    s_nop 1
    v_add_f32_dpp v5, v4, v4 row_ror:2 row_mask:0xf bank_mask:0xf
    s_nop 1
    v_add_f32_dpp v4, v5, v5 row_ror:1 row_mask:0xf bank_mask:0xf
    ds_write_b32 v2, v4 offset:0
    s_waitcnt lgkmcnt(0)
    s_barrier
    ds_read_b64 v[4:5], v3 offset:0
    s_waitcnt lgkmcnt(0)
    v_add_f32 v4, v4, v5
    s_nop 1
    v_add_f32_dpp v5, v4, v4 row_ror:8 row_mask:0xf bank_mask:0xf
    s_nop 1
    v_add_f32_dpp v4, v5, v5 row_ror:4 row_mask:0xf bank_mask:0xf
    s_nop 1
    v_add_f32_dpp v5, v4, v4 row_ror:2 row_mask:0xf bank_mask:0xf
    s_nop 1
    v_add_f32_dpp v4, v5, v5 row_ror:1 row_mask:0xf bank_mask:0xf
    v_mov_b32 v28, v4
    v_mul_f32 v20, 0x37aaaaab, v4
    v_mov_b32 v4, 0
    v_mov_b32 v5, 0
    v_mov_b32 v6, 0
    v_mov_b32 v7, 0
    v_lshlrev_b32 v12, 16, v36
    v_and_b32 v13, s22, v36
    v_lshlrev_b32 v14, 16, v37
    v_and_b32 v15, s22, v37
    v_lshlrev_b32 v16, 16, v38
    v_and_b32 v17, s22, v38
    v_lshlrev_b32 v18, 16, v39
    v_and_b32 v19, s22, v39
    v_pk_add_f32 v[12:13], v[12:13], v[20:21] op_sel_hi:[1,0] neg_lo:[0,1] neg_hi:[0,1]
    v_pk_add_f32 v[14:15], v[14:15], v[20:21] op_sel_hi:[1,0] neg_lo:[0,1] neg_hi:[0,1]
    v_pk_add_f32 v[16:17], v[16:17], v[20:21] op_sel_hi:[1,0] neg_lo:[0,1] neg_hi:[0,1]
    v_pk_add_f32 v[18:19], v[18:19], v[20:21] op_sel_hi:[1,0] neg_lo:[0,1] neg_hi:[0,1]
    v_pk_fma_f32 v[4:5], v[12:13], v[12:13], v[4:5]
    v_pk_fma_f32 v[6:7], v[14:15], v[14:15], v[6:7]
    v_pk_fma_f32 v[4:5], v[16:17], v[16:17], v[4:5]
    v_pk_fma_f32 v[6:7], v[18:19], v[18:19], v[6:7]
    v_lshlrev_b32 v12, 16, v40
    v_and_b32 v13, s22, v40
    v_lshlrev_b32 v14, 16, v41
    v_and_b32 v15, s22, v41
    v_lshlrev_b32 v16, 16, v42
    v_and_b32 v17, s22, v42
    v_lshlrev_b32 v18, 16, v43
    v_and_b32 v19, s22, v43
    v_pk_add_f32 v[12:13], v[12:13], v[20:21] op_sel_hi:[1,0] neg_lo:[0,1] neg_hi:[0,1]
    v_pk_add_f32 v[14:15], v[14:15], v[20:21] op_sel_hi:[1,0] neg_lo:[0,1] neg_hi:[0,1]
    v_pk_add_f32 v[16:17], v[16:17], v[20:21] op_sel_hi:[1,0] neg_lo:[0,1] neg_hi:[0,1]
    v_pk_add_f32 v[18:19], v[18:19], v[20:21] op_sel_hi:[1,0] neg_lo:[0,1] neg_hi:[0,1]
    v_pk_fma_f32 v[4:5], v[12:13], v[12:13], v[4:5]
    v_pk_fma_f32 v[6:7], v[14:15], v[14:15], v[6:7]
    v_pk_fma_f32 v[4:5], v[16:17], v[16:17], v[4:5]
    v_pk_fma_f32 v[6:7], v[18:19], v[18:19], v[6:7]
    v_lshlrev_b32 v12, 16, v44
    v_and_b32 v13, s22, v44
    v_lshlrev_b32 v14, 16, v45
    v_and_b32 v15, s22, v45
    v_lshlrev_b32 v16, 16, v46
    v_and_b32 v17, s22, v46
    v_lshlrev_b32 v18, 16, v47
    v_and_b32 v19, s22, v47
    v_pk_add_f32 v[12:13], v[12:13], v[20:21] op_sel_hi:[1,0] neg_lo:[0,1] neg_hi:[0,1]
    v_pk_add_f32 v[14:15], v[14:15], v[20:21] op_sel_hi:[1,0] neg_lo:[0,1] neg_hi:[0,1]
    v_pk_add_f32 v[16:17], v[16:17], v[20:21] op_sel_hi:[1,0] neg_lo:[0,1] neg_hi:[0,1]
    v_pk_add_f32 v[18:19], v[18:19], v[20:21] op_sel_hi:[1,0] neg_lo:[0,1] neg_hi:[0,1]
    v_pk_fma_f32 v[4:5], v[12:13], v[12:13], v[4:5]
    v_pk_fma_f32 v[6:7], v[14:15], v[14:15], v[6:7]
    v_pk_fma_f32 v[4:5], v[16:17], v[16:17], v[4:5]
    v_pk_fma_f32 v[6:7], v[18:19], v[18:19], v[6:7]
    v_lshlrev_b32 v12, 16, v48
    v_and_b32 v13, s22, v48
    v_lshlrev_b32 v14, 16, v49
    v_and_b32 v15, s22, v49
    v_lshlrev_b32 v16, 16, v50
    v_and_b32 v17, s22, v50
    v_lshlrev_b32 v18, 16, v51
    v_and_b32 v19, s22, v51
    v_pk_add_f32 v[12:13], v[12:13], v[20:21] op_sel_hi:[1,0] neg_lo:[0,1] neg_hi:[0,1]
    v_pk_add_f32 v[14:15], v[14:15], v[20:21] op_sel_hi:[1,0] neg_lo:[0,1] neg_hi:[0,1]
    v_pk_add_f32 v[16:17], v[16:17], v[20:21] op_sel_hi:[1,0] neg_lo:[0,1] neg_hi:[0,1]
    v_pk_add_f32 v[18:19], v[18:19], v[20:21] op_sel_hi:[1,0] neg_lo:[0,1] neg_hi:[0,1]
    v_pk_fma_f32 v[4:5], v[12:13], v[12:13], v[4:5]
    v_pk_fma_f32 v[6:7], v[14:15], v[14:15], v[6:7]
    v_pk_fma_f32 v[4:5], v[16:17], v[16:17], v[4:5]
    v_pk_fma_f32 v[6:7], v[18:19], v[18:19], v[6:7]
    v_lshlrev_b32 v12, 16, v52
    v_and_b32 v13, s22, v52
    v_lshlrev_b32 v14, 16, v53
    v_and_b32 v15, s22, v53
    v_lshlrev_b32 v16, 16, v54
    v_and_b32 v17, s22, v54
    v_lshlrev_b32 v18, 16, v55
    v_and_b32 v19, s22, v55
    v_pk_add_f32 v[12:13], v[12:13], v[20:21] op_sel_hi:[1,0] neg_lo:[0,1] neg_hi:[0,1]
    v_pk_add_f32 v[14:15], v[14:15], v[20:21] op_sel_hi:[1,0] neg_lo:[0,1] neg_hi:[0,1]
    v_pk_add_f32 v[16:17], v[16:17], v[20:21] op_sel_hi:[1,0] neg_lo:[0,1] neg_hi:[0,1]
    v_pk_add_f32 v[18:19], v[18:19], v[20:21] op_sel_hi:[1,0] neg_lo:[0,1] neg_hi:[0,1]
    v_pk_fma_f32 v[4:5], v[12:13], v[12:13], v[4:5]
    v_pk_fma_f32 v[6:7], v[14:15], v[14:15], v[6:7]
    v_pk_fma_f32 v[4:5], v[16:17], v[16:17], v[4:5]
    v_pk_fma_f32 v[6:7], v[18:19], v[18:19], v[6:7]
    v_lshlrev_b32 v12, 16, v56
    v_and_b32 v13, s22, v56
    v_lshlrev_b32 v14, 16, v57
    v_and_b32 v15, s22, v57
    v_lshlrev_b32 v16, 16, v58
    v_and_b32 v17, s22, v58
    v_lshlrev_b32 v18, 16, v59
    v_and_b32 v19, s22, v59
    v_pk_add_f32 v[12:13], v[12:13], v[20:21] op_sel_hi:[1,0] neg_lo:[0,1] neg_hi:[0,1]
    v_pk_add_f32 v[14:15], v[14:15], v[20:21] op_sel_hi:[1,0] neg_lo:[0,1] neg_hi:[0,1]
    v_pk_add_f32 v[16:17], v[16:17], v[20:21] op_sel_hi:[1,0] neg_lo:[0,1] neg_hi:[0,1]
    v_pk_add_f32 v[18:19], v[18:19], v[20:21] op_sel_hi:[1,0] neg_lo:[0,1] neg_hi:[0,1]
    v_pk_fma_f32 v[4:5], v[12:13], v[12:13], v[4:5]
    v_pk_fma_f32 v[6:7], v[14:15], v[14:15], v[6:7]
    v_pk_fma_f32 v[4:5], v[16:17], v[16:17], v[4:5]
    v_pk_fma_f32 v[6:7], v[18:19], v[18:19], v[6:7]
    v_lshlrev_b32 v12, 16, v60
    v_and_b32 v13, s22, v60
    v_lshlrev_b32 v14, 16, v61
    v_and_b32 v15, s22, v61
    v_lshlrev_b32 v16, 16, v62
    v_and_b32 v17, s22, v62
    v_lshlrev_b32 v18, 16, v63
    v_and_b32 v19, s22, v63
    v_pk_add_f32 v[12:13], v[12:13], v[20:21] op_sel_hi:[1,0] neg_lo:[0,1] neg_hi:[0,1]
    v_pk_add_f32 v[14:15], v[14:15], v[20:21] op_sel_hi:[1,0] neg_lo:[0,1] neg_hi:[0,1]
    v_pk_add_f32 v[16:17], v[16:17], v[20:21] op_sel_hi:[1,0] neg_lo:[0,1] neg_hi:[0,1]
    v_pk_add_f32 v[18:19], v[18:19], v[20:21] op_sel_hi:[1,0] neg_lo:[0,1] neg_hi:[0,1]
    v_pk_fma_f32 v[4:5], v[12:13], v[12:13], v[4:5]
    v_pk_fma_f32 v[6:7], v[14:15], v[14:15], v[6:7]
    v_pk_fma_f32 v[4:5], v[16:17], v[16:17], v[4:5]
    v_pk_fma_f32 v[6:7], v[18:19], v[18:19], v[6:7]
    v_lshlrev_b32 v12, 16, v64
    v_and_b32 v13, s22, v64
    v_lshlrev_b32 v14, 16, v65
    v_and_b32 v15, s22, v65
    v_lshlrev_b32 v16, 16, v66
    v_and_b32 v17, s22, v66
    v_lshlrev_b32 v18, 16, v67
    v_and_b32 v19, s22, v67
    v_pk_add_f32 v[12:13], v[12:13], v[20:21] op_sel_hi:[1,0] neg_lo:[0,1] neg_hi:[0,1]
    v_pk_add_f32 v[14:15], v[14:15], v[20:21] op_sel_hi:[1,0] neg_lo:[0,1] neg_hi:[0,1]
    v_pk_add_f32 v[16:17], v[16:17], v[20:21] op_sel_hi:[1,0] neg_lo:[0,1] neg_hi:[0,1]
    v_pk_add_f32 v[18:19], v[18:19], v[20:21] op_sel_hi:[1,0] neg_lo:[0,1] neg_hi:[0,1]
    v_pk_fma_f32 v[4:5], v[12:13], v[12:13], v[4:5]
    v_pk_fma_f32 v[6:7], v[14:15], v[14:15], v[6:7]
    v_pk_fma_f32 v[4:5], v[16:17], v[16:17], v[4:5]
    v_pk_fma_f32 v[6:7], v[18:19], v[18:19], v[6:7]
    v_lshlrev_b32 v12, 16, v68
    v_and_b32 v13, s22, v68
    v_lshlrev_b32 v14, 16, v69
    v_and_b32 v15, s22, v69
    v_lshlrev_b32 v16, 16, v70
    v_and_b32 v17, s22, v70
    v_lshlrev_b32 v18, 16, v71
    v_and_b32 v19, s22, v71
    v_pk_add_f32 v[12:13], v[12:13], v[20:21] op_sel_hi:[1,0] neg_lo:[0,1] neg_hi:[0,1]
    v_pk_add_f32 v[14:15], v[14:15], v[20:21] op_sel_hi:[1,0] neg_lo:[0,1] neg_hi:[0,1]
    v_pk_add_f32 v[16:17], v[16:17], v[20:21] op_sel_hi:[1,0] neg_lo:[0,1] neg_hi:[0,1]
    v_pk_add_f32 v[18:19], v[18:19], v[20:21] op_sel_hi:[1,0] neg_lo:[0,1] neg_hi:[0,1]
    v_pk_fma_f32 v[4:5], v[12:13], v[12:13], v[4:5]
    v_pk_fma_f32 v[6:7], v[14:15], v[14:15], v[6:7]
    v_pk_fma_f32 v[4:5], v[16:17], v[16:17], v[4:5]
    v_pk_fma_f32 v[6:7], v[18:19], v[18:19], v[6:7]
    v_lshlrev_b32 v12, 16, v72
    v_and_b32 v13, s22, v72
    v_lshlrev_b32 v14, 16, v73
    v_and_b32 v15, s22, v73
    v_lshlrev_b32 v16, 16, v74
    v_and_b32 v17, s22, v74
    v_lshlrev_b32 v18, 16, v75
    v_and_b32 v19, s22, v75
    v_pk_add_f32 v[12:13], v[12:13], v[20:21] op_sel_hi:[1,0] neg_lo:[0,1] neg_hi:[0,1]
    v_pk_add_f32 v[14:15], v[14:15], v[20:21] op_sel_hi:[1,0] neg_lo:[0,1] neg_hi:[0,1]
    v_pk_add_f32 v[16:17], v[16:17], v[20:21] op_sel_hi:[1,0] neg_lo:[0,1] neg_hi:[0,1]
    v_pk_add_f32 v[18:19], v[18:19], v[20:21] op_sel_hi:[1,0] neg_lo:[0,1] neg_hi:[0,1]
    v_pk_fma_f32 v[4:5], v[12:13], v[12:13], v[4:5]
    v_pk_fma_f32 v[6:7], v[14:15], v[14:15], v[6:7]
    v_pk_fma_f32 v[4:5], v[16:17], v[16:17], v[4:5]
    v_pk_fma_f32 v[6:7], v[18:19], v[18:19], v[6:7]
    v_lshlrev_b32 v12, 16, v76
    v_and_b32 v13, s22, v76
    v_lshlrev_b32 v14, 16, v77
    v_and_b32 v15, s22, v77
    v_lshlrev_b32 v16, 16, v78
    v_and_b32 v17, s22, v78
    v_lshlrev_b32 v18, 16, v79
    v_and_b32 v19, s22, v79
    v_pk_add_f32 v[12:13], v[12:13], v[20:21] op_sel_hi:[1,0] neg_lo:[0,1] neg_hi:[0,1]
    v_pk_add_f32 v[14:15], v[14:15], v[20:21] op_sel_hi:[1,0] neg_lo:[0,1] neg_hi:[0,1]
    v_pk_add_f32 v[16:17], v[16:17], v[20:21] op_sel_hi:[1,0] neg_lo:[0,1] neg_hi:[0,1]
    v_pk_add_f32 v[18:19], v[18:19], v[20:21] op_sel_hi:[1,0] neg_lo:[0,1] neg_hi:[0,1]
    v_pk_fma_f32 v[4:5], v[12:13], v[12:13], v[4:5]
    v_pk_fma_f32 v[6:7], v[14:15], v[14:15], v[6:7]
    v_pk_fma_f32 v[4:5], v[16:17], v[16:17], v[4:5]
    v_pk_fma_f32 v[6:7], v[18:19], v[18:19], v[6:7]
    v_lshlrev_b32 v12, 16, v80
    v_and_b32 v13, s22, v80
    v_lshlrev_b32 v14, 16, v81
    v_and_b32 v15, s22, v81
    v_lshlrev_b32 v16, 16, v82
    v_and_b32 v17, s22, v82
    v_lshlrev_b32 v18, 16, v83
    v_and_b32 v19, s22, v83
    v_pk_add_f32 v[12:13], v[12:13], v[20:21] op_sel_hi:[1,0] neg_lo:[0,1] neg_hi:[0,1]
    v_pk_add_f32 v[14:15], v[14:15], v[20:21] op_sel_hi:[1,0] neg_lo:[0,1] neg_hi:[0,1]
    v_pk_add_f32 v[16:17], v[16:17], v[20:21] op_sel_hi:[1,0] neg_lo:[0,1] neg_hi:[0,1]
    v_pk_add_f32 v[18:19], v[18:19], v[20:21] op_sel_hi:[1,0] neg_lo:[0,1] neg_hi:[0,1]
    v_pk_fma_f32 v[4:5], v[12:13], v[12:13], v[4:5]
    v_pk_fma_f32 v[6:7], v[14:15], v[14:15], v[6:7]
    v_pk_fma_f32 v[4:5], v[16:17], v[16:17], v[4:5]
    v_pk_fma_f32 v[6:7], v[18:19], v[18:19], v[6:7]
    s_nop 2
    v_add_f32 v4, v4, v5
    v_add_f32 v6, v6, v7
    v_add_f32 v4, v4, v6
    s_nop 1
    v_add_f32_dpp v5, v4, v4 row_ror:8 row_mask:0xf bank_mask:0xf
    s_nop 1
    v_add_f32_dpp v4, v5, v5 row_ror:4 row_mask:0xf bank_mask:0xf
    s_nop 1
    v_add_f32_dpp v5, v4, v4 row_ror:2 row_mask:0xf bank_mask:0xf
    s_nop 1
    v_add_f32_dpp v4, v5, v5 row_ror:1 row_mask:0xf bank_mask:0xf
    ds_write_b32 v2, v4 offset:512
    s_waitcnt lgkmcnt(0)
    s_barrier
    ds_read_b64 v[4:5], v3 offset:512
    s_waitcnt lgkmcnt(0)
    v_add_f32 v4, v4, v5
    s_nop 1
    v_add_f32_dpp v5, v4, v4 row_ror:8 row_mask:0xf bank_mask:0xf
    s_nop 1
    v_add_f32_dpp v4, v5, v5 row_ror:4 row_mask:0xf bank_mask:0xf
    s_nop 1
    v_add_f32_dpp v5, v4, v4 row_ror:2 row_mask:0xf bank_mask:0xf
    s_nop 1
    v_add_f32_dpp v4, v5, v5 row_ror:1 row_mask:0xf bank_mask:0xf
    v_mov_b32 v29, v4
    s_mul_i32 s24, s78, 0x9e3779b1
    s_add_u32 s24, s24, 0x7f4a7c15
    s_mul_i32 s25, s79, 0x85ebca6d
    s_add_u32 s25, s25, 0x165667b1
    s_mul_i32 s18, s76, 0x9e3779b1
    s_add_u32 s18, s18, 0x7f4a7c15
    s_mul_i32 s19, s77, 0x85ebca6d
    s_add_u32 s19, s19, 0x165667b1
    v_mov_b32 v12, v28
    v_mov_b32 v13, s24
    v_mov_b32 v14, v29
    v_mov_b32 v15, s25
    s_add_u32 s28, s27, 16
    v_mov_b32 v16, s28
    s_cmp_lg_u32 s3, 0
    s_cbranch_scc1 L_nopub1
    s_mov_b64 exec, 1
    global_store_dwordx4 v16, v[12:15], s[70:71] sc0 sc1
    s_mov_b64 exec, -1
L_nopub1:
    s_nop 1
    v_mov_b32 v4, 0
    v_mov_b32 v5, 0
    v_mov_b32 v6, 0
    v_mov_b32 v7, 0
    s_waitcnt vmcnt(42)
    v_dot2c_f32_bf16 v4, s21, v84
    v_dot2c_f32_bf16 v5, s21, v85
    v_dot2c_f32_bf16 v6, s21, v86
    v_dot2c_f32_bf16 v7, s21, v87
    s_waitcnt vmcnt(41)
    v_dot2c_f32_bf16 v4, s21, v88
    v_dot2c_f32_bf16 v5, s21, v89
    v_dot2c_f32_bf16 v6, s21, v90
    v_dot2c_f32_bf16 v7, s21, v91
    s_waitcnt vmcnt(40)
    v_dot2c_f32_bf16 v4, s21, v92
    v_dot2c_f32_bf16 v5, s21, v93
    v_dot2c_f32_bf16 v6, s21, v94
    v_dot2c_f32_bf16 v7, s21, v95
    s_waitcnt vmcnt(39)
    v_dot2c_f32_bf16 v4, s21, v96
    v_dot2c_f32_bf16 v5, s21, v97
    v_dot2c_f32_bf16 v6, s21, v98
    v_dot2c_f32_bf16 v7, s21, v99
    s_waitcnt vmcnt(38)
    v_dot2c_f32_bf16 v4, s21, v100
    v_dot2c_f32_bf16 v5, s21, v101
    v_dot2c_f32_bf16 v6, s21, v102
    v_dot2c_f32_bf16 v7, s21, v103
    s_waitcnt vmcnt(37)
    v_dot2c_f32_bf16 v4, s21, v104
    v_dot2c_f32_bf16 v5, s21, v105
    v_dot2c_f32_bf16 v6, s21, v106
    v_dot2c_f32_bf16 v7, s21, v107
    s_waitcnt vmcnt(36)
    v_dot2c_f32_bf16 v4, s21, v108
    v_dot2c_f32_bf16 v5, s21, v109
    v_dot2c_f32_bf16 v6, s21, v110
    v_dot2c_f32_bf16 v7, s21, v111
    s_waitcnt vmcnt(35)
    v_dot2c_f32_bf16 v4, s21, v112
    v_dot2c_f32_bf16 v5, s21, v113
    v_dot2c_f32_bf16 v6, s21, v114
    v_dot2c_f32_bf16 v7, s21, v115
    s_waitcnt vmcnt(34)
    v_dot2c_f32_bf16 v4, s21, v116
    v_dot2c_f32_bf16 v5, s21, v117
    v_dot2c_f32_bf16 v6, s21, v118
    v_dot2c_f32_bf16 v7, s21, v119
    s_waitcnt vmcnt(33)
    v_dot2c_f32_bf16 v4, s21, v120
    v_dot2c_f32_bf16 v5, s21, v121
    v_dot2c_f32_bf16 v6, s21, v122
    v_dot2c_f32_bf16 v7, s21, v123
    s_waitcnt vmcnt(32)
    v_dot2c_f32_bf16 v4, s21, v124
    v_dot2c_f32_bf16 v5, s21, v125
    v_dot2c_f32_bf16 v6, s21, v126
    v_dot2c_f32_bf16 v7, s21, v127
    s_waitcnt vmcnt(31)
    v_dot2c_f32_bf16 v4, s21, v128
    v_dot2c_f32_bf16 v5, s21, v129
    v_dot2c_f32_bf16 v6, s21, v130
    v_dot2c_f32_bf16 v7, s21, v131
    s_waitcnt vmcnt(30)
    v_dot2c_f32_bf16 v4, s21, v132
    v_dot2c_f32_bf16 v5, s21, v133
    v_dot2c_f32_bf16 v6, s21, v134
    v_dot2c_f32_bf16 v7, s21, v135
    s_waitcnt vmcnt(29)
    v_dot2c_f32_bf16 v4, s21, v136
    v_dot2c_f32_bf16 v5, s21, v137
    v_dot2c_f32_bf16 v6, s21, v138
    v_dot2c_f32_bf16 v7, s21, v139
    s_waitcnt vmcnt(28)
    v_dot2c_f32_bf16 v4, s21, v140
    v_dot2c_f32_bf16 v5, s21, v141
    v_dot2c_f32_bf16 v6, s21, v142
    v_dot2c_f32_bf16 v7, s21, v143
    s_waitcnt vmcnt(27)
    v_dot2c_f32_bf16 v4, s21, v144
    v_dot2c_f32_bf16 v5, s21, v145
    v_dot2c_f32_bf16 v6, s21, v146
    v_dot2c_f32_bf16 v7, s21, v147
    s_nop 2
    v_add_f32 v4, v4, v5
    v_add_f32 v6, v6, v7
    v_add_f32 v4, v4, v6
    s_nop 1
    v_add_f32_dpp v5, v4, v4 row_ror:8 row_mask:0xf bank_mask:0xf
    s_nop 1
    v_add_f32_dpp v4, v5, v5 row_ror:4 row_mask:0xf bank_mask:0xf
    s_nop 1
    v_add_f32_dpp v5, v4, v4 row_ror:2 row_mask:0xf bank_mask:0xf
    s_nop 1
    v_add_f32_dpp v4, v5, v5 row_ror:1 row_mask:0xf bank_mask:0xf
    ds_write_b32 v2, v4 offset:0
    s_waitcnt lgkmcnt(0)
    s_barrier
    ds_read_b64 v[4:5], v3 offset:0
    s_waitcnt lgkmcnt(0)
    v_add_f32 v4, v4, v5
    s_nop 1
    v_add_f32_dpp v5, v4, v4 row_ror:8 row_mask:0xf bank_mask:0xf
    s_nop 1
    v_add_f32_dpp v4, v5, v5 row_ror:4 row_mask:0xf bank_mask:0xf
    s_nop 1
    v_add_f32_dpp v5, v4, v4 row_ror:2 row_mask:0xf bank_mask:0xf
    s_nop 1
    v_add_f32_dpp v4, v5, v5 row_ror:1 row_mask:0xf bank_mask:0xf
    v_mul_f32 v4, 0x37800000, v4
    v_cvt_pk_bf16_f32 v4, v4, v4
    v_lshlrev_b32 v20, 16, v4
    v_mov_b32 v4, 0
    v_mov_b32 v5, 0
    v_mov_b32 v6, 0
    v_mov_b32 v7, 0
    v_lshlrev_b32 v12, 16, v84
    v_and_b32 v13, s22, v84
    v_lshlrev_b32 v14, 16, v85
    v_and_b32 v15, s22, v85
    v_lshlrev_b32 v16, 16, v86
    v_and_b32 v17, s22, v86
    v_lshlrev_b32 v18, 16, v87
    v_and_b32 v19, s22, v87
    v_pk_add_f32 v[12:13], v[12:13], v[20:21] op_sel_hi:[1,0] neg_lo:[0,1] neg_hi:[0,1]
    v_pk_add_f32 v[14:15], v[14:15], v[20:21] op_sel_hi:[1,0] neg_lo:[0,1] neg_hi:[0,1]
    v_pk_add_f32 v[16:17], v[16:17], v[20:21] op_sel_hi:[1,0] neg_lo:[0,1] neg_hi:[0,1]
    v_pk_add_f32 v[18:19], v[18:19], v[20:21] op_sel_hi:[1,0] neg_lo:[0,1] neg_hi:[0,1]
    v_cvt_pk_bf16_f32 v84, v12, v13
    v_cvt_pk_bf16_f32 v85, v14, v15
    v_cvt_pk_bf16_f32 v86, v16, v17
    v_cvt_pk_bf16_f32 v87, v18, v19
    v_dot2c_f32_bf16 v4, v84, v84
    v_dot2c_f32_bf16 v5, v85, v85
    v_dot2c_f32_bf16 v6, v86, v86
    v_dot2c_f32_bf16 v7, v87, v87
    v_lshlrev_b32 v12, 16, v88
    v_and_b32 v13, s22, v88
    v_lshlrev_b32 v14, 16, v89
    v_and_b32 v15, s22, v89
    v_lshlrev_b32 v16, 16, v90
    v_and_b32 v17, s22, v90
    v_lshlrev_b32 v18, 16, v91
    v_and_b32 v19, s22, v91
    v_pk_add_f32 v[12:13], v[12:13], v[20:21] op_sel_hi:[1,0] neg_lo:[0,1] neg_hi:[0,1]
    v_pk_add_f32 v[14:15], v[14:15], v[20:21] op_sel_hi:[1,0] neg_lo:[0,1] neg_hi:[0,1]
    v_pk_add_f32 v[16:17], v[16:17], v[20:21] op_sel_hi:[1,0] neg_lo:[0,1] neg_hi:[0,1]
    v_pk_add_f32 v[18:19], v[18:19], v[20:21] op_sel_hi:[1,0] neg_lo:[0,1] neg_hi:[0,1]
    v_cvt_pk_bf16_f32 v88, v12, v13
    v_cvt_pk_bf16_f32 v89, v14, v15
    v_cvt_pk_bf16_f32 v90, v16, v17
    v_cvt_pk_bf16_f32 v91, v18, v19
    v_dot2c_f32_bf16 v4, v88, v88
    v_dot2c_f32_bf16 v5, v89, v89
    v_dot2c_f32_bf16 v6, v90, v90
    v_dot2c_f32_bf16 v7, v91, v91
    v_lshlrev_b32 v12, 16, v92
    v_and_b32 v13, s22, v92
    v_lshlrev_b32 v14, 16, v93
    v_and_b32 v15, s22, v93
    v_lshlrev_b32 v16, 16, v94
    v_and_b32 v17, s22, v94
    v_lshlrev_b32 v18, 16, v95
    v_and_b32 v19, s22, v95
    v_pk_add_f32 v[12:13], v[12:13], v[20:21] op_sel_hi:[1,0] neg_lo:[0,1] neg_hi:[0,1]
    v_pk_add_f32 v[14:15], v[14:15], v[20:21] op_sel_hi:[1,0] neg_lo:[0,1] neg_hi:[0,1]
    v_pk_add_f32 v[16:17], v[16:17], v[20:21] op_sel_hi:[1,0] neg_lo:[0,1] neg_hi:[0,1]
    v_pk_add_f32 v[18:19], v[18:19], v[20:21] op_sel_hi:[1,0] neg_lo:[0,1] neg_hi:[0,1]
    v_cvt_pk_bf16_f32 v92, v12, v13
    v_cvt_pk_bf16_f32 v93, v14, v15
    v_cvt_pk_bf16_f32 v94, v16, v17
    v_cvt_pk_bf16_f32 v95, v18, v19
    v_dot2c_f32_bf16 v4, v92, v92
    v_dot2c_f32_bf16 v5, v93, v93
    v_dot2c_f32_bf16 v6, v94, v94
    v_dot2c_f32_bf16 v7, v95, v95
    v_lshlrev_b32 v12, 16, v96
    v_and_b32 v13, s22, v96
    v_lshlrev_b32 v14, 16, v97
    v_and_b32 v15, s22, v97
    v_lshlrev_b32 v16, 16, v98
    v_and_b32 v17, s22, v98
    v_lshlrev_b32 v18, 16, v99
    v_and_b32 v19, s22, v99
    v_pk_add_f32 v[12:13], v[12:13], v[20:21] op_sel_hi:[1,0] neg_lo:[0,1] neg_hi:[0,1]
    v_pk_add_f32 v[14:15], v[14:15], v[20:21] op_sel_hi:[1,0] neg_lo:[0,1] neg_hi:[0,1]
    v_pk_add_f32 v[16:17], v[16:17], v[20:21] op_sel_hi:[1,0] neg_lo:[0,1] neg_hi:[0,1]
    v_pk_add_f32 v[18:19], v[18:19], v[20:21] op_sel_hi:[1,0] neg_lo:[0,1] neg_hi:[0,1]
    v_cvt_pk_bf16_f32 v96, v12, v13
    v_cvt_pk_bf16_f32 v97, v14, v15
    v_cvt_pk_bf16_f32 v98, v16, v17
    v_cvt_pk_bf16_f32 v99, v18, v19
    v_dot2c_f32_bf16 v4, v96, v96
    v_dot2c_f32_bf16 v5, v97, v97
    v_dot2c_f32_bf16 v6, v98, v98
    v_dot2c_f32_bf16 v7, v99, v99
    v_lshlrev_b32 v12, 16, v100
    v_and_b32 v13, s22, v100
    v_lshlrev_b32 v14, 16, v101
    v_and_b32 v15, s22, v101
    v_lshlrev_b32 v16, 16, v102
    v_and_b32 v17, s22, v102
    v_lshlrev_b32 v18, 16, v103
    v_and_b32 v19, s22, v103
    v_pk_add_f32 v[12:13], v[12:13], v[20:21] op_sel_hi:[1,0] neg_lo:[0,1] neg_hi:[0,1]
    v_pk_add_f32 v[14:15], v[14:15], v[20:21] op_sel_hi:[1,0] neg_lo:[0,1] neg_hi:[0,1]
    v_pk_add_f32 v[16:17], v[16:17], v[20:21] op_sel_hi:[1,0] neg_lo:[0,1] neg_hi:[0,1]
    v_pk_add_f32 v[18:19], v[18:19], v[20:21] op_sel_hi:[1,0] neg_lo:[0,1] neg_hi:[0,1]
    v_cvt_pk_bf16_f32 v100, v12, v13
    v_cvt_pk_bf16_f32 v101, v14, v15
    v_cvt_pk_bf16_f32 v102, v16, v17
    v_cvt_pk_bf16_f32 v103, v18, v19
    v_dot2c_f32_bf16 v4, v100, v100
    v_dot2c_f32_bf16 v5, v101, v101
    v_dot2c_f32_bf16 v6, v102, v102
    v_dot2c_f32_bf16 v7, v103, v103
    v_lshlrev_b32 v12, 16, v104
    v_and_b32 v13, s22, v104
    v_lshlrev_b32 v14, 16, v105
    v_and_b32 v15, s22, v105
    v_lshlrev_b32 v16, 16, v106
    v_and_b32 v17, s22, v106
    v_lshlrev_b32 v18, 16, v107
    v_and_b32 v19, s22, v107
    v_pk_add_f32 v[12:13], v[12:13], v[20:21] op_sel_hi:[1,0] neg_lo:[0,1] neg_hi:[0,1]
    v_pk_add_f32 v[14:15], v[14:15], v[20:21] op_sel_hi:[1,0] neg_lo:[0,1] neg_hi:[0,1]
    v_pk_add_f32 v[16:17], v[16:17], v[20:21] op_sel_hi:[1,0] neg_lo:[0,1] neg_hi:[0,1]
    v_pk_add_f32 v[18:19], v[18:19], v[20:21] op_sel_hi:[1,0] neg_lo:[0,1] neg_hi:[0,1]
    v_cvt_pk_bf16_f32 v104, v12, v13
    v_cvt_pk_bf16_f32 v105, v14, v15
    v_cvt_pk_bf16_f32 v106, v16, v17
    v_cvt_pk_bf16_f32 v107, v18, v19
    v_dot2c_f32_bf16 v4, v104, v104
    v_dot2c_f32_bf16 v5, v105, v105
    v_dot2c_f32_bf16 v6, v106, v106
    v_dot2c_f32_bf16 v7, v107, v107
    v_lshlrev_b32 v12, 16, v108
    v_and_b32 v13, s22, v108
    v_lshlrev_b32 v14, 16, v109
    v_and_b32 v15, s22, v109
    v_lshlrev_b32 v16, 16, v110
    v_and_b32 v17, s22, v110
    v_lshlrev_b32 v18, 16, v111
    v_and_b32 v19, s22, v111
    v_pk_add_f32 v[12:13], v[12:13], v[20:21] op_sel_hi:[1,0] neg_lo:[0,1] neg_hi:[0,1]
    v_pk_add_f32 v[14:15], v[14:15], v[20:21] op_sel_hi:[1,0] neg_lo:[0,1] neg_hi:[0,1]
    v_pk_add_f32 v[16:17], v[16:17], v[20:21] op_sel_hi:[1,0] neg_lo:[0,1] neg_hi:[0,1]
    v_pk_add_f32 v[18:19], v[18:19], v[20:21] op_sel_hi:[1,0] neg_lo:[0,1] neg_hi:[0,1]
    v_cvt_pk_bf16_f32 v108, v12, v13
    v_cvt_pk_bf16_f32 v109, v14, v15
    v_cvt_pk_bf16_f32 v110, v16, v17
    v_cvt_pk_bf16_f32 v111, v18, v19
    v_dot2c_f32_bf16 v4, v108, v108
    v_dot2c_f32_bf16 v5, v109, v109
    v_dot2c_f32_bf16 v6, v110, v110
    v_dot2c_f32_bf16 v7, v111, v111
    v_lshlrev_b32 v12, 16, v112
    v_and_b32 v13, s22, v112
    v_lshlrev_b32 v14, 16, v113
    v_and_b32 v15, s22, v113
    v_lshlrev_b32 v16, 16, v114
    v_and_b32 v17, s22, v114
    v_lshlrev_b32 v18, 16, v115
    v_and_b32 v19, s22, v115
    v_pk_add_f32 v[12:13], v[12:13], v[20:21] op_sel_hi:[1,0] neg_lo:[0,1] neg_hi:[0,1]
    v_pk_add_f32 v[14:15], v[14:15], v[20:21] op_sel_hi:[1,0] neg_lo:[0,1] neg_hi:[0,1]
    v_pk_add_f32 v[16:17], v[16:17], v[20:21] op_sel_hi:[1,0] neg_lo:[0,1] neg_hi:[0,1]
    v_pk_add_f32 v[18:19], v[18:19], v[20:21] op_sel_hi:[1,0] neg_lo:[0,1] neg_hi:[0,1]
    v_cvt_pk_bf16_f32 v112, v12, v13
    v_cvt_pk_bf16_f32 v113, v14, v15
    v_cvt_pk_bf16_f32 v114, v16, v17
    v_cvt_pk_bf16_f32 v115, v18, v19
    v_dot2c_f32_bf16 v4, v112, v112
    v_dot2c_f32_bf16 v5, v113, v113
    v_dot2c_f32_bf16 v6, v114, v114
    v_dot2c_f32_bf16 v7, v115, v115
    v_lshlrev_b32 v12, 16, v116
    v_and_b32 v13, s22, v116
    v_lshlrev_b32 v14, 16, v117
    v_and_b32 v15, s22, v117
    v_lshlrev_b32 v16, 16, v118
    v_and_b32 v17, s22, v118
    v_lshlrev_b32 v18, 16, v119
    v_and_b32 v19, s22, v119
    v_pk_add_f32 v[12:13], v[12:13], v[20:21] op_sel_hi:[1,0] neg_lo:[0,1] neg_hi:[0,1]
    v_pk_add_f32 v[14:15], v[14:15], v[20:21] op_sel_hi:[1,0] neg_lo:[0,1] neg_hi:[0,1]
    v_pk_add_f32 v[16:17], v[16:17], v[20:21] op_sel_hi:[1,0] neg_lo:[0,1] neg_hi:[0,1]
    v_pk_add_f32 v[18:19], v[18:19], v[20:21] op_sel_hi:[1,0] neg_lo:[0,1] neg_hi:[0,1]
    v_cvt_pk_bf16_f32 v116, v12, v13
    v_cvt_pk_bf16_f32 v117, v14, v15
    v_cvt_pk_bf16_f32 v118, v16, v17
    v_cvt_pk_bf16_f32 v119, v18, v19
    v_dot2c_f32_bf16 v4, v116, v116
    v_dot2c_f32_bf16 v5, v117, v117
    v_dot2c_f32_bf16 v6, v118, v118
    v_dot2c_f32_bf16 v7, v119, v119
    v_lshlrev_b32 v12, 16, v120
    v_and_b32 v13, s22, v120
    v_lshlrev_b32 v14, 16, v121
    v_and_b32 v15, s22, v121
    v_lshlrev_b32 v16, 16, v122
    v_and_b32 v17, s22, v122
    v_lshlrev_b32 v18, 16, v123
    v_and_b32 v19, s22, v123
    v_pk_add_f32 v[12:13], v[12:13], v[20:21] op_sel_hi:[1,0] neg_lo:[0,1] neg_hi:[0,1]
    v_pk_add_f32 v[14:15], v[14:15], v[20:21] op_sel_hi:[1,0] neg_lo:[0,1] neg_hi:[0,1]
    v_pk_add_f32 v[16:17], v[16:17], v[20:21] op_sel_hi:[1,0] neg_lo:[0,1] neg_hi:[0,1]
    v_pk_add_f32 v[18:19], v[18:19], v[20:21] op_sel_hi:[1,0] neg_lo:[0,1] neg_hi:[0,1]
    v_cvt_pk_bf16_f32 v120, v12, v13
    v_cvt_pk_bf16_f32 v121, v14, v15
    v_cvt_pk_bf16_f32 v122, v16, v17
    v_cvt_pk_bf16_f32 v123, v18, v19
    v_dot2c_f32_bf16 v4, v120, v120
    v_dot2c_f32_bf16 v5, v121, v121
    v_dot2c_f32_bf16 v6, v122, v122
    v_dot2c_f32_bf16 v7, v123, v123
    v_lshlrev_b32 v12, 16, v124
    v_and_b32 v13, s22, v124
    v_lshlrev_b32 v14, 16, v125
    v_and_b32 v15, s22, v125
    v_lshlrev_b32 v16, 16, v126
    v_and_b32 v17, s22, v126
    v_lshlrev_b32 v18, 16, v127
    v_and_b32 v19, s22, v127
    v_pk_add_f32 v[12:13], v[12:13], v[20:21] op_sel_hi:[1,0] neg_lo:[0,1] neg_hi:[0,1]
    v_pk_add_f32 v[14:15], v[14:15], v[20:21] op_sel_hi:[1,0] neg_lo:[0,1] neg_hi:[0,1]
    v_pk_add_f32 v[16:17], v[16:17], v[20:21] op_sel_hi:[1,0] neg_lo:[0,1] neg_hi:[0,1]
    v_pk_add_f32 v[18:19], v[18:19], v[20:21] op_sel_hi:[1,0] neg_lo:[0,1] neg_hi:[0,1]
    v_cvt_pk_bf16_f32 v124, v12, v13
    v_cvt_pk_bf16_f32 v125, v14, v15
    v_cvt_pk_bf16_f32 v126, v16, v17
    v_cvt_pk_bf16_f32 v127, v18, v19
    v_dot2c_f32_bf16 v4, v124, v124
    v_dot2c_f32_bf16 v5, v125, v125
    v_dot2c_f32_bf16 v6, v126, v126
    v_dot2c_f32_bf16 v7, v127, v127
    v_lshlrev_b32 v12, 16, v128
    v_and_b32 v13, s22, v128
    v_lshlrev_b32 v14, 16, v129
    v_and_b32 v15, s22, v129
    v_lshlrev_b32 v16, 16, v130
    v_and_b32 v17, s22, v130
    v_lshlrev_b32 v18, 16, v131
    v_and_b32 v19, s22, v131
    v_pk_add_f32 v[12:13], v[12:13], v[20:21] op_sel_hi:[1,0] neg_lo:[0,1] neg_hi:[0,1]
    v_pk_add_f32 v[14:15], v[14:15], v[20:21] op_sel_hi:[1,0] neg_lo:[0,1] neg_hi:[0,1]
    v_pk_add_f32 v[16:17], v[16:17], v[20:21] op_sel_hi:[1,0] neg_lo:[0,1] neg_hi:[0,1]
    v_pk_add_f32 v[18:19], v[18:19], v[20:21] op_sel_hi:[1,0] neg_lo:[0,1] neg_hi:[0,1]
    v_cvt_pk_bf16_f32 v128, v12, v13
    v_cvt_pk_bf16_f32 v129, v14, v15
    v_cvt_pk_bf16_f32 v130, v16, v17
    v_cvt_pk_bf16_f32 v131, v18, v19
    v_dot2c_f32_bf16 v4, v128, v128
    v_dot2c_f32_bf16 v5, v129, v129
    v_dot2c_f32_bf16 v6, v130, v130
    v_dot2c_f32_bf16 v7, v131, v131
    v_lshlrev_b32 v12, 16, v132
    v_and_b32 v13, s22, v132
    v_lshlrev_b32 v14, 16, v133
    v_and_b32 v15, s22, v133
    v_lshlrev_b32 v16, 16, v134
    v_and_b32 v17, s22, v134
    v_lshlrev_b32 v18, 16, v135
    v_and_b32 v19, s22, v135
    v_pk_add_f32 v[12:13], v[12:13], v[20:21] op_sel_hi:[1,0] neg_lo:[0,1] neg_hi:[0,1]
    v_pk_add_f32 v[14:15], v[14:15], v[20:21] op_sel_hi:[1,0] neg_lo:[0,1] neg_hi:[0,1]
    v_pk_add_f32 v[16:17], v[16:17], v[20:21] op_sel_hi:[1,0] neg_lo:[0,1] neg_hi:[0,1]
    v_pk_add_f32 v[18:19], v[18:19], v[20:21] op_sel_hi:[1,0] neg_lo:[0,1] neg_hi:[0,1]
    v_cvt_pk_bf16_f32 v132, v12, v13
    v_cvt_pk_bf16_f32 v133, v14, v15
    v_cvt_pk_bf16_f32 v134, v16, v17
    v_cvt_pk_bf16_f32 v135, v18, v19
    v_dot2c_f32_bf16 v4, v132, v132
    v_dot2c_f32_bf16 v5, v133, v133
    v_dot2c_f32_bf16 v6, v134, v134
    v_dot2c_f32_bf16 v7, v135, v135
    v_lshlrev_b32 v12, 16, v136
    v_and_b32 v13, s22, v136
    v_lshlrev_b32 v14, 16, v137
    v_and_b32 v15, s22, v137
    v_lshlrev_b32 v16, 16, v138
    v_and_b32 v17, s22, v138
    v_lshlrev_b32 v18, 16, v139
    v_and_b32 v19, s22, v139
    v_pk_add_f32 v[12:13], v[12:13], v[20:21] op_sel_hi:[1,0] neg_lo:[0,1] neg_hi:[0,1]
    v_pk_add_f32 v[14:15], v[14:15], v[20:21] op_sel_hi:[1,0] neg_lo:[0,1] neg_hi:[0,1]
    v_pk_add_f32 v[16:17], v[16:17], v[20:21] op_sel_hi:[1,0] neg_lo:[0,1] neg_hi:[0,1]
    v_pk_add_f32 v[18:19], v[18:19], v[20:21] op_sel_hi:[1,0] neg_lo:[0,1] neg_hi:[0,1]
    v_cvt_pk_bf16_f32 v136, v12, v13
    v_cvt_pk_bf16_f32 v137, v14, v15
    v_cvt_pk_bf16_f32 v138, v16, v17
    v_cvt_pk_bf16_f32 v139, v18, v19
    v_dot2c_f32_bf16 v4, v136, v136
    v_dot2c_f32_bf16 v5, v137, v137
    v_dot2c_f32_bf16 v6, v138, v138
    v_dot2c_f32_bf16 v7, v139, v139
    v_lshlrev_b32 v12, 16, v140
    v_and_b32 v13, s22, v140
    v_lshlrev_b32 v14, 16, v141
    v_and_b32 v15, s22, v141
    v_lshlrev_b32 v16, 16, v142
    v_and_b32 v17, s22, v142
    v_lshlrev_b32 v18, 16, v143
    v_and_b32 v19, s22, v143
    v_pk_add_f32 v[12:13], v[12:13], v[20:21] op_sel_hi:[1,0] neg_lo:[0,1] neg_hi:[0,1]
    v_pk_add_f32 v[14:15], v[14:15], v[20:21] op_sel_hi:[1,0] neg_lo:[0,1] neg_hi:[0,1]
    v_pk_add_f32 v[16:17], v[16:17], v[20:21] op_sel_hi:[1,0] neg_lo:[0,1] neg_hi:[0,1]
    v_pk_add_f32 v[18:19], v[18:19], v[20:21] op_sel_hi:[1,0] neg_lo:[0,1] neg_hi:[0,1]
    v_cvt_pk_bf16_f32 v140, v12, v13
    v_cvt_pk_bf16_f32 v141, v14, v15
    v_cvt_pk_bf16_f32 v142, v16, v17
    v_cvt_pk_bf16_f32 v143, v18, v19
    v_dot2c_f32_bf16 v4, v140, v140
    v_dot2c_f32_bf16 v5, v141, v141
    v_dot2c_f32_bf16 v6, v142, v142
    v_dot2c_f32_bf16 v7, v143, v143
    v_lshlrev_b32 v12, 16, v144
    v_and_b32 v13, s22, v144
    v_lshlrev_b32 v14, 16, v145
    v_and_b32 v15, s22, v145
    v_lshlrev_b32 v16, 16, v146
    v_and_b32 v17, s22, v146
    v_lshlrev_b32 v18, 16, v147
    v_and_b32 v19, s22, v147
    v_pk_add_f32 v[12:13], v[12:13], v[20:21] op_sel_hi:[1,0] neg_lo:[0,1] neg_hi:[0,1]
    v_pk_add_f32 v[14:15], v[14:15], v[20:21] op_sel_hi:[1,0] neg_lo:[0,1] neg_hi:[0,1]
    v_pk_add_f32 v[16:17], v[16:17], v[20:21] op_sel_hi:[1,0] neg_lo:[0,1] neg_hi:[0,1]
    v_pk_add_f32 v[18:19], v[18:19], v[20:21] op_sel_hi:[1,0] neg_lo:[0,1] neg_hi:[0,1]
    v_cvt_pk_bf16_f32 v144, v12, v13
    v_cvt_pk_bf16_f32 v145, v14, v15
    v_cvt_pk_bf16_f32 v146, v16, v17
    v_cvt_pk_bf16_f32 v147, v18, v19
    v_dot2c_f32_bf16 v4, v144, v144
    v_dot2c_f32_bf16 v5, v145, v145
    v_dot2c_f32_bf16 v6, v146, v146
    v_dot2c_f32_bf16 v7, v147, v147
    s_nop 2
    v_add_f32 v4, v4, v5
    v_add_f32 v6, v6, v7
    v_add_f32 v4, v4, v6
    s_nop 1
    v_add_f32_dpp v5, v4, v4 row_ror:8 row_mask:0xf bank_mask:0xf
    s_nop 1
    v_add_f32_dpp v4, v5, v5 row_ror:4 row_mask:0xf bank_mask:0xf
    s_nop 1
    v_add_f32_dpp v5, v4, v4 row_ror:2 row_mask:0xf bank_mask:0xf
    s_nop 1
    v_add_f32_dpp v4, v5, v5 row_ror:1 row_mask:0xf bank_mask:0xf
    ds_write_b32 v2, v4 offset:512
    s_waitcnt lgkmcnt(0)
    s_barrier
    ds_read_b64 v[4:5], v3 offset:512
    s_waitcnt lgkmcnt(0)
    v_add_f32 v4, v4, v5
    s_nop 1
    v_add_f32_dpp v5, v4, v4 row_ror:8 row_mask:0xf bank_mask:0xf
    s_nop 1
    v_add_f32_dpp v4, v5, v5 row_ror:4 row_mask:0xf bank_mask:0xf
    s_nop 1
    v_add_f32_dpp v5, v4, v4 row_ror:2 row_mask:0xf bank_mask:0xf
    s_nop 1
    v_add_f32_dpp v4, v5, v5 row_ror:1 row_mask:0xf bank_mask:0xf
    v_mul_f32 v4, 0x37800000, v4
    v_cvt_pk_bf16_f32 v4, v4, v4
    v_lshlrev_b32 v4, 16, v4
    v_add_f32 v4, 0x3727c5ac, v4
    v_cvt_pk_bf16_f32 v4, v4, v4
    v_lshlrev_b32 v4, 16, v4
    v_sqrt_f32 v4, v4
    s_nop 0
    v_cvt_pk_bf16_f32 v4, v4, v4
    v_lshlrev_b32 v4, 16, v4
    v_rcp_f32 v8, v4
    s_lshl_b32 s32, s60, 16
    s_and_b32 s33, s60, 0xffff0000
    s_lshl_b32 s34, s61, 16
    s_and_b32 s35, s61, 0xffff0000
    s_bitcmp1_b32 s55, 0
    s_cselect_b32 s32, s33, s32
    s_cselect_b32 s34, s35, s34
    v_mul_f32 v8, s32, v8
    v_mov_b32 v9, s34
    s_add_u32 s14, s10, s45
    s_addc_u32 s15, s11, 0
    v_lshlrev_b32 v12, 16, v84
    v_and_b32 v13, s22, v84
    v_lshlrev_b32 v14, 16, v85
    v_and_b32 v15, s22, v85
    v_lshlrev_b32 v16, 16, v86
    v_and_b32 v17, s22, v86
    v_lshlrev_b32 v18, 16, v87
    v_and_b32 v19, s22, v87
    v_pk_fma_f32 v[12:13], v[12:13], v[8:9], v[8:9] op_sel:[0,0,1] op_sel_hi:[1,0,1]
    v_pk_fma_f32 v[14:15], v[14:15], v[8:9], v[8:9] op_sel:[0,0,1] op_sel_hi:[1,0,1]
    v_pk_fma_f32 v[16:17], v[16:17], v[8:9], v[8:9] op_sel:[0,0,1] op_sel_hi:[1,0,1]
    v_pk_fma_f32 v[18:19], v[18:19], v[8:9], v[8:9] op_sel:[0,0,1] op_sel_hi:[1,0,1]
    v_cvt_pk_bf16_f32 v84, v12, v13
    v_cvt_pk_bf16_f32 v85, v14, v15
    v_cvt_pk_bf16_f32 v86, v16, v17
    v_cvt_pk_bf16_f32 v87, v18, v19
    global_store_dwordx4 v1, v[84:87], s[14:15] sc1
    s_add_u32 s14, s14, 8192
    s_addc_u32 s15, s15, 0
    global_load_dwordx4 v[84:87], v1, s[12:13] nt
    s_add_u32 s12, s12, 8192
    s_addc_u32 s13, s13, 0
    v_lshlrev_b32 v12, 16, v88
    v_and_b32 v13, s22, v88
    v_lshlrev_b32 v14, 16, v89
    v_and_b32 v15, s22, v89
    v_lshlrev_b32 v16, 16, v90
    v_and_b32 v17, s22, v90
    v_lshlrev_b32 v18, 16, v91
    v_and_b32 v19, s22, v91
    v_pk_fma_f32 v[12:13], v[12:13], v[8:9], v[8:9] op_sel:[0,0,1] op_sel_hi:[1,0,1]
    v_pk_fma_f32 v[14:15], v[14:15], v[8:9], v[8:9] op_sel:[0,0,1] op_sel_hi:[1,0,1]
    v_pk_fma_f32 v[16:17], v[16:17], v[8:9], v[8:9] op_sel:[0,0,1] op_sel_hi:[1,0,1]
    v_pk_fma_f32 v[18:19], v[18:19], v[8:9], v[8:9] op_sel:[0,0,1] op_sel_hi:[1,0,1]
    v_cvt_pk_bf16_f32 v88, v12, v13
    v_cvt_pk_bf16_f32 v89, v14, v15
    v_cvt_pk_bf16_f32 v90, v16, v17
    v_cvt_pk_bf16_f32 v91, v18, v19
    global_store_dwordx4 v1, v[88:91], s[14:15] sc1
    s_add_u32 s14, s14, 8192
    s_addc_u32 s15, s15, 0
    global_load_dwordx4 v[88:91], v1, s[12:13] nt
    s_add_u32 s12, s12, 8192
    s_addc_u32 s13, s13, 0
    v_lshlrev_b32 v12, 16, v92
    v_and_b32 v13, s22, v92
    v_lshlrev_b32 v14, 16, v93
    v_and_b32 v15, s22, v93
    v_lshlrev_b32 v16, 16, v94
    v_and_b32 v17, s22, v94
    v_lshlrev_b32 v18, 16, v95
    v_and_b32 v19, s22, v95
    v_pk_fma_f32 v[12:13], v[12:13], v[8:9], v[8:9] op_sel:[0,0,1] op_sel_hi:[1,0,1]
    v_pk_fma_f32 v[14:15], v[14:15], v[8:9], v[8:9] op_sel:[0,0,1] op_sel_hi:[1,0,1]
    v_pk_fma_f32 v[16:17], v[16:17], v[8:9], v[8:9] op_sel:[0,0,1] op_sel_hi:[1,0,1]
    v_pk_fma_f32 v[18:19], v[18:19], v[8:9], v[8:9] op_sel:[0,0,1] op_sel_hi:[1,0,1]
    v_cvt_pk_bf16_f32 v92, v12, v13
    v_cvt_pk_bf16_f32 v93, v14, v15
    v_cvt_pk_bf16_f32 v94, v16, v17
    v_cvt_pk_bf16_f32 v95, v18, v19
    global_store_dwordx4 v1, v[92:95], s[14:15] sc1
    s_add_u32 s14, s14, 8192
    s_addc_u32 s15, s15, 0
    global_load_dwordx4 v[92:95], v1, s[12:13] nt
    s_add_u32 s12, s12, 8192
    s_addc_u32 s13, s13, 0
    v_lshlrev_b32 v12, 16, v96
    v_and_b32 v13, s22, v96
    v_lshlrev_b32 v14, 16, v97
    v_and_b32 v15, s22, v97
    v_lshlrev_b32 v16, 16, v98
    v_and_b32 v17, s22, v98
    v_lshlrev_b32 v18, 16, v99
    v_and_b32 v19, s22, v99
    v_pk_fma_f32 v[12:13], v[12:13], v[8:9], v[8:9] op_sel:[0,0,1] op_sel_hi:[1,0,1]
    v_pk_fma_f32 v[14:15], v[14:15], v[8:9], v[8:9] op_sel:[0,0,1] op_sel_hi:[1,0,1]
    v_pk_fma_f32 v[16:17], v[16:17], v[8:9], v[8:9] op_sel:[0,0,1] op_sel_hi:[1,0,1]
    v_pk_fma_f32 v[18:19], v[18:19], v[8:9], v[8:9] op_sel:[0,0,1] op_sel_hi:[1,0,1]
    v_cvt_pk_bf16_f32 v96, v12, v13
    v_cvt_pk_bf16_f32 v97, v14, v15
    v_cvt_pk_bf16_f32 v98, v16, v17
    v_cvt_pk_bf16_f32 v99, v18, v19
    global_store_dwordx4 v1, v[96:99], s[14:15] sc1
    s_add_u32 s14, s14, 8192
    s_addc_u32 s15, s15, 0
    global_load_dwordx4 v[96:99], v1, s[12:13] nt
    s_add_u32 s12, s12, 8192
    s_addc_u32 s13, s13, 0
    v_lshlrev_b32 v12, 16, v100
    v_and_b32 v13, s22, v100
    v_lshlrev_b32 v14, 16, v101
    v_and_b32 v15, s22, v101
    v_lshlrev_b32 v16, 16, v102
    v_and_b32 v17, s22, v102
    v_lshlrev_b32 v18, 16, v103
    v_and_b32 v19, s22, v103
    v_pk_fma_f32 v[12:13], v[12:13], v[8:9], v[8:9] op_sel:[0,0,1] op_sel_hi:[1,0,1]
    v_pk_fma_f32 v[14:15], v[14:15], v[8:9], v[8:9] op_sel:[0,0,1] op_sel_hi:[1,0,1]
    v_pk_fma_f32 v[16:17], v[16:17], v[8:9], v[8:9] op_sel:[0,0,1] op_sel_hi:[1,0,1]
    v_pk_fma_f32 v[18:19], v[18:19], v[8:9], v[8:9] op_sel:[0,0,1] op_sel_hi:[1,0,1]
    v_cvt_pk_bf16_f32 v100, v12, v13
    v_cvt_pk_bf16_f32 v101, v14, v15
    v_cvt_pk_bf16_f32 v102, v16, v17
    v_cvt_pk_bf16_f32 v103, v18, v19
    global_store_dwordx4 v1, v[100:103], s[14:15] sc1
    s_add_u32 s14, s14, 8192
    s_addc_u32 s15, s15, 0
    global_load_dwordx4 v[100:103], v1, s[12:13] nt
    s_add_u32 s12, s12, 8192
    s_addc_u32 s13, s13, 0
    v_lshlrev_b32 v12, 16, v104
    v_and_b32 v13, s22, v104
    v_lshlrev_b32 v14, 16, v105
    v_and_b32 v15, s22, v105
    v_lshlrev_b32 v16, 16, v106
    v_and_b32 v17, s22, v106
    v_lshlrev_b32 v18, 16, v107
    v_and_b32 v19, s22, v107
    v_pk_fma_f32 v[12:13], v[12:13], v[8:9], v[8:9] op_sel:[0,0,1] op_sel_hi:[1,0,1]
    v_pk_fma_f32 v[14:15], v[14:15], v[8:9], v[8:9] op_sel:[0,0,1] op_sel_hi:[1,0,1]
    v_pk_fma_f32 v[16:17], v[16:17], v[8:9], v[8:9] op_sel:[0,0,1] op_sel_hi:[1,0,1]
    v_pk_fma_f32 v[18:19], v[18:19], v[8:9], v[8:9] op_sel:[0,0,1] op_sel_hi:[1,0,1]
    v_cvt_pk_bf16_f32 v104, v12, v13
    v_cvt_pk_bf16_f32 v105, v14, v15
    v_cvt_pk_bf16_f32 v106, v16, v17
    v_cvt_pk_bf16_f32 v107, v18, v19
    global_store_dwordx4 v1, v[104:107], s[14:15] sc1
    s_add_u32 s14, s14, 8192
    s_addc_u32 s15, s15, 0
    s_add_u32 s12, s4, s48
    s_addc_u32 s13, s5, 0
    global_load_dwordx4 v[104:107], v1, s[12:13] nt
    s_add_u32 s12, s12, 8192
    s_addc_u32 s13, s13, 0
    v_lshlrev_b32 v12, 16, v108
    v_and_b32 v13, s22, v108
    v_lshlrev_b32 v14, 16, v109
    v_and_b32 v15, s22, v109
    v_lshlrev_b32 v16, 16, v110
    v_and_b32 v17, s22, v110
    v_lshlrev_b32 v18, 16, v111
    v_and_b32 v19, s22, v111
    v_pk_fma_f32 v[12:13], v[12:13], v[8:9], v[8:9] op_sel:[0,0,1] op_sel_hi:[1,0,1]
    v_pk_fma_f32 v[14:15], v[14:15], v[8:9], v[8:9] op_sel:[0,0,1] op_sel_hi:[1,0,1]
    v_pk_fma_f32 v[16:17], v[16:17], v[8:9], v[8:9] op_sel:[0,0,1] op_sel_hi:[1,0,1]
    v_pk_fma_f32 v[18:19], v[18:19], v[8:9], v[8:9] op_sel:[0,0,1] op_sel_hi:[1,0,1]
    v_cvt_pk_bf16_f32 v108, v12, v13
    v_cvt_pk_bf16_f32 v109, v14, v15
    v_cvt_pk_bf16_f32 v110, v16, v17
    v_cvt_pk_bf16_f32 v111, v18, v19
    global_store_dwordx4 v1, v[108:111], s[14:15] sc1
    s_add_u32 s14, s14, 8192
    s_addc_u32 s15, s15, 0
    global_load_dwordx4 v[108:111], v1, s[12:13] nt
    s_add_u32 s12, s12, 8192
    s_addc_u32 s13, s13, 0
    v_lshlrev_b32 v12, 16, v112
    v_and_b32 v13, s22, v112
    v_lshlrev_b32 v14, 16, v113
    v_and_b32 v15, s22, v113
    v_lshlrev_b32 v16, 16, v114
    v_and_b32 v17, s22, v114
    v_lshlrev_b32 v18, 16, v115
    v_and_b32 v19, s22, v115
    v_pk_fma_f32 v[12:13], v[12:13], v[8:9], v[8:9] op_sel:[0,0,1] op_sel_hi:[1,0,1]
    v_pk_fma_f32 v[14:15], v[14:15], v[8:9], v[8:9] op_sel:[0,0,1] op_sel_hi:[1,0,1]
    v_pk_fma_f32 v[16:17], v[16:17], v[8:9], v[8:9] op_sel:[0,0,1] op_sel_hi:[1,0,1]
    v_pk_fma_f32 v[18:19], v[18:19], v[8:9], v[8:9] op_sel:[0,0,1] op_sel_hi:[1,0,1]
    v_cvt_pk_bf16_f32 v112, v12, v13
    v_cvt_pk_bf16_f32 v113, v14, v15
    v_cvt_pk_bf16_f32 v114, v16, v17
    v_cvt_pk_bf16_f32 v115, v18, v19
    global_store_dwordx4 v1, v[112:115], s[14:15] sc1
    s_add_u32 s14, s14, 8192
    s_addc_u32 s15, s15, 0
    global_load_dwordx4 v[112:115], v1, s[12:13] nt
    s_add_u32 s12, s12, 8192
    s_addc_u32 s13, s13, 0
    v_lshlrev_b32 v12, 16, v116
    v_and_b32 v13, s22, v116
    v_lshlrev_b32 v14, 16, v117
    v_and_b32 v15, s22, v117
    v_lshlrev_b32 v16, 16, v118
    v_and_b32 v17, s22, v118
    v_lshlrev_b32 v18, 16, v119
    v_and_b32 v19, s22, v119
    v_pk_fma_f32 v[12:13], v[12:13], v[8:9], v[8:9] op_sel:[0,0,1] op_sel_hi:[1,0,1]
    v_pk_fma_f32 v[14:15], v[14:15], v[8:9], v[8:9] op_sel:[0,0,1] op_sel_hi:[1,0,1]
    v_pk_fma_f32 v[16:17], v[16:17], v[8:9], v[8:9] op_sel:[0,0,1] op_sel_hi:[1,0,1]
    v_pk_fma_f32 v[18:19], v[18:19], v[8:9], v[8:9] op_sel:[0,0,1] op_sel_hi:[1,0,1]
    v_cvt_pk_bf16_f32 v116, v12, v13
    v_cvt_pk_bf16_f32 v117, v14, v15
    v_cvt_pk_bf16_f32 v118, v16, v17
    v_cvt_pk_bf16_f32 v119, v18, v19
    global_store_dwordx4 v1, v[116:119], s[14:15] sc1
    s_add_u32 s14, s14, 8192
    s_addc_u32 s15, s15, 0
    global_load_dwordx4 v[116:119], v1, s[12:13] nt
    s_add_u32 s12, s12, 8192
    s_addc_u32 s13, s13, 0
    v_lshlrev_b32 v12, 16, v120
    v_and_b32 v13, s22, v120
    v_lshlrev_b32 v14, 16, v121
    v_and_b32 v15, s22, v121
    v_lshlrev_b32 v16, 16, v122
    v_and_b32 v17, s22, v122
    v_lshlrev_b32 v18, 16, v123
    v_and_b32 v19, s22, v123
    v_pk_fma_f32 v[12:13], v[12:13], v[8:9], v[8:9] op_sel:[0,0,1] op_sel_hi:[1,0,1]
    v_pk_fma_f32 v[14:15], v[14:15], v[8:9], v[8:9] op_sel:[0,0,1] op_sel_hi:[1,0,1]
    v_pk_fma_f32 v[16:17], v[16:17], v[8:9], v[8:9] op_sel:[0,0,1] op_sel_hi:[1,0,1]
    v_pk_fma_f32 v[18:19], v[18:19], v[8:9], v[8:9] op_sel:[0,0,1] op_sel_hi:[1,0,1]
    v_cvt_pk_bf16_f32 v120, v12, v13
    v_cvt_pk_bf16_f32 v121, v14, v15
    v_cvt_pk_bf16_f32 v122, v16, v17
    v_cvt_pk_bf16_f32 v123, v18, v19
    global_store_dwordx4 v1, v[120:123], s[14:15] sc1
    s_add_u32 s14, s14, 8192
    s_addc_u32 s15, s15, 0
    global_load_dwordx4 v[120:123], v1, s[12:13] nt
    s_add_u32 s12, s12, 8192
    s_addc_u32 s13, s13, 0
    v_lshlrev_b32 v12, 16, v124
    v_and_b32 v13, s22, v124
    v_lshlrev_b32 v14, 16, v125
    v_and_b32 v15, s22, v125
    v_lshlrev_b32 v16, 16, v126
    v_and_b32 v17, s22, v126
    v_lshlrev_b32 v18, 16, v127
    v_and_b32 v19, s22, v127
    v_pk_fma_f32 v[12:13], v[12:13], v[8:9], v[8:9] op_sel:[0,0,1] op_sel_hi:[1,0,1]
    v_pk_fma_f32 v[14:15], v[14:15], v[8:9], v[8:9] op_sel:[0,0,1] op_sel_hi:[1,0,1]
    v_pk_fma_f32 v[16:17], v[16:17], v[8:9], v[8:9] op_sel:[0,0,1] op_sel_hi:[1,0,1]
    v_pk_fma_f32 v[18:19], v[18:19], v[8:9], v[8:9] op_sel:[0,0,1] op_sel_hi:[1,0,1]
    v_cvt_pk_bf16_f32 v124, v12, v13
    v_cvt_pk_bf16_f32 v125, v14, v15
    v_cvt_pk_bf16_f32 v126, v16, v17
    v_cvt_pk_bf16_f32 v127, v18, v19
    global_store_dwordx4 v1, v[124:127], s[14:15] sc1
    s_add_u32 s14, s14, 8192
    s_addc_u32 s15, s15, 0
    global_load_dwordx4 v[124:127], v1, s[12:13] nt
    s_add_u32 s12, s12, 8192
    s_addc_u32 s13, s13, 0
    v_lshlrev_b32 v12, 16, v128
    v_and_b32 v13, s22, v128
    v_lshlrev_b32 v14, 16, v129
    v_and_b32 v15, s22, v129
    v_lshlrev_b32 v16, 16, v130
    v_and_b32 v17, s22, v130
    v_lshlrev_b32 v18, 16, v131
    v_and_b32 v19, s22, v131
    v_pk_fma_f32 v[12:13], v[12:13], v[8:9], v[8:9] op_sel:[0,0,1] op_sel_hi:[1,0,1]
    v_pk_fma_f32 v[14:15], v[14:15], v[8:9], v[8:9] op_sel:[0,0,1] op_sel_hi:[1,0,1]
    v_pk_fma_f32 v[16:17], v[16:17], v[8:9], v[8:9] op_sel:[0,0,1] op_sel_hi:[1,0,1]
    v_pk_fma_f32 v[18:19], v[18:19], v[8:9], v[8:9] op_sel:[0,0,1] op_sel_hi:[1,0,1]
    v_cvt_pk_bf16_f32 v128, v12, v13
    v_cvt_pk_bf16_f32 v129, v14, v15
    v_cvt_pk_bf16_f32 v130, v16, v17
    v_cvt_pk_bf16_f32 v131, v18, v19
    global_store_dwordx4 v1, v[128:131], s[14:15] sc1
    s_add_u32 s14, s14, 8192
    s_addc_u32 s15, s15, 0
    global_load_dwordx4 v[128:131], v1, s[12:13] nt
    s_add_u32 s12, s12, 8192
    s_addc_u32 s13, s13, 0
    v_lshlrev_b32 v12, 16, v132
    v_and_b32 v13, s22, v132
    v_lshlrev_b32 v14, 16, v133
    v_and_b32 v15, s22, v133
    v_lshlrev_b32 v16, 16, v134
    v_and_b32 v17, s22, v134
    v_lshlrev_b32 v18, 16, v135
    v_and_b32 v19, s22, v135
    v_pk_fma_f32 v[12:13], v[12:13], v[8:9], v[8:9] op_sel:[0,0,1] op_sel_hi:[1,0,1]
    v_pk_fma_f32 v[14:15], v[14:15], v[8:9], v[8:9] op_sel:[0,0,1] op_sel_hi:[1,0,1]
    v_pk_fma_f32 v[16:17], v[16:17], v[8:9], v[8:9] op_sel:[0,0,1] op_sel_hi:[1,0,1]
    v_pk_fma_f32 v[18:19], v[18:19], v[8:9], v[8:9] op_sel:[0,0,1] op_sel_hi:[1,0,1]
    v_cvt_pk_bf16_f32 v132, v12, v13
    v_cvt_pk_bf16_f32 v133, v14, v15
    v_cvt_pk_bf16_f32 v134, v16, v17
    v_cvt_pk_bf16_f32 v135, v18, v19
    global_store_dwordx4 v1, v[132:135], s[14:15] sc1
    s_add_u32 s14, s14, 8192
    s_addc_u32 s15, s15, 0
    global_load_dwordx4 v[132:135], v1, s[12:13] nt
    s_add_u32 s12, s12, 8192
    s_addc_u32 s13, s13, 0
    v_lshlrev_b32 v12, 16, v136
    v_and_b32 v13, s22, v136
    v_lshlrev_b32 v14, 16, v137
    v_and_b32 v15, s22, v137
    v_lshlrev_b32 v16, 16, v138
    v_and_b32 v17, s22, v138
    v_lshlrev_b32 v18, 16, v139
    v_and_b32 v19, s22, v139
    v_pk_fma_f32 v[12:13], v[12:13], v[8:9], v[8:9] op_sel:[0,0,1] op_sel_hi:[1,0,1]
    v_pk_fma_f32 v[14:15], v[14:15], v[8:9], v[8:9] op_sel:[0,0,1] op_sel_hi:[1,0,1]
    v_pk_fma_f32 v[16:17], v[16:17], v[8:9], v[8:9] op_sel:[0,0,1] op_sel_hi:[1,0,1]
    v_pk_fma_f32 v[18:19], v[18:19], v[8:9], v[8:9] op_sel:[0,0,1] op_sel_hi:[1,0,1]
    v_cvt_pk_bf16_f32 v136, v12, v13
    v_cvt_pk_bf16_f32 v137, v14, v15
    v_cvt_pk_bf16_f32 v138, v16, v17
    v_cvt_pk_bf16_f32 v139, v18, v19
    global_store_dwordx4 v1, v[136:139], s[14:15] sc1
    s_add_u32 s14, s14, 8192
    s_addc_u32 s15, s15, 0
    global_load_dwordx4 v[136:139], v1, s[12:13] nt
    s_add_u32 s12, s12, 8192
    s_addc_u32 s13, s13, 0
    v_lshlrev_b32 v12, 16, v140
    v_and_b32 v13, s22, v140
    v_lshlrev_b32 v14, 16, v141
    v_and_b32 v15, s22, v141
    v_lshlrev_b32 v16, 16, v142
    v_and_b32 v17, s22, v142
    v_lshlrev_b32 v18, 16, v143
    v_and_b32 v19, s22, v143
    v_pk_fma_f32 v[12:13], v[12:13], v[8:9], v[8:9] op_sel:[0,0,1] op_sel_hi:[1,0,1]
    v_pk_fma_f32 v[14:15], v[14:15], v[8:9], v[8:9] op_sel:[0,0,1] op_sel_hi:[1,0,1]
    v_pk_fma_f32 v[16:17], v[16:17], v[8:9], v[8:9] op_sel:[0,0,1] op_sel_hi:[1,0,1]
    v_pk_fma_f32 v[18:19], v[18:19], v[8:9], v[8:9] op_sel:[0,0,1] op_sel_hi:[1,0,1]
    v_cvt_pk_bf16_f32 v140, v12, v13
    v_cvt_pk_bf16_f32 v141, v14, v15
    v_cvt_pk_bf16_f32 v142, v16, v17
    v_cvt_pk_bf16_f32 v143, v18, v19
    global_store_dwordx4 v1, v[140:143], s[14:15] sc1
    s_add_u32 s14, s14, 8192
    s_addc_u32 s15, s15, 0
    global_load_dwordx4 v[140:143], v1, s[12:13] nt
    s_add_u32 s12, s12, 8192
    s_addc_u32 s13, s13, 0
    v_mov_b32 v4, 0
    v_mov_b32 v5, 0
    v_mov_b32 v6, 0
    v_mov_b32 v7, 0
    s_waitcnt vmcnt(56)
    v_dot2c_f32_bf16 v4, s21, v148
    v_dot2c_f32_bf16 v5, s21, v149
    v_dot2c_f32_bf16 v6, s21, v150
    v_dot2c_f32_bf16 v7, s21, v151
    s_waitcnt vmcnt(55)
    v_dot2c_f32_bf16 v4, s21, v152
    v_dot2c_f32_bf16 v5, s21, v153
    v_dot2c_f32_bf16 v6, s21, v154
    v_dot2c_f32_bf16 v7, s21, v155
    s_waitcnt vmcnt(54)
    v_dot2c_f32_bf16 v4, s21, v156
    v_dot2c_f32_bf16 v5, s21, v157
    v_dot2c_f32_bf16 v6, s21, v158
    v_dot2c_f32_bf16 v7, s21, v159
    s_waitcnt vmcnt(53)
    v_dot2c_f32_bf16 v4, s21, v160
    v_dot2c_f32_bf16 v5, s21, v161
    v_dot2c_f32_bf16 v6, s21, v162
    v_dot2c_f32_bf16 v7, s21, v163
    s_waitcnt vmcnt(52)
    v_dot2c_f32_bf16 v4, s21, v164
    v_dot2c_f32_bf16 v5, s21, v165
    v_dot2c_f32_bf16 v6, s21, v166
    v_dot2c_f32_bf16 v7, s21, v167
    s_waitcnt vmcnt(51)
    v_dot2c_f32_bf16 v4, s21, v168
    v_dot2c_f32_bf16 v5, s21, v169
    v_dot2c_f32_bf16 v6, s21, v170
    v_dot2c_f32_bf16 v7, s21, v171
    s_waitcnt vmcnt(50)
    v_dot2c_f32_bf16 v4, s21, v172
    v_dot2c_f32_bf16 v5, s21, v173
    v_dot2c_f32_bf16 v6, s21, v174
    v_dot2c_f32_bf16 v7, s21, v175
    s_waitcnt vmcnt(49)
    v_dot2c_f32_bf16 v4, s21, v176
    v_dot2c_f32_bf16 v5, s21, v177
    v_dot2c_f32_bf16 v6, s21, v178
    v_dot2c_f32_bf16 v7, s21, v179
    s_waitcnt vmcnt(48)
    v_dot2c_f32_bf16 v4, s21, v180
    v_dot2c_f32_bf16 v5, s21, v181
    v_dot2c_f32_bf16 v6, s21, v182
    v_dot2c_f32_bf16 v7, s21, v183
    s_waitcnt vmcnt(47)
    v_dot2c_f32_bf16 v4, s21, v184
    v_dot2c_f32_bf16 v5, s21, v185
    v_dot2c_f32_bf16 v6, s21, v186
    v_dot2c_f32_bf16 v7, s21, v187
    s_waitcnt vmcnt(46)
    v_dot2c_f32_bf16 v4, s21, v188
    v_dot2c_f32_bf16 v5, s21, v189
    v_dot2c_f32_bf16 v6, s21, v190
    v_dot2c_f32_bf16 v7, s21, v191
    s_waitcnt vmcnt(45)
    v_dot2c_f32_bf16 v4, s21, v192
    v_dot2c_f32_bf16 v5, s21, v193
    v_dot2c_f32_bf16 v6, s21, v194
    v_dot2c_f32_bf16 v7, s21, v195
    s_waitcnt vmcnt(44)
    v_dot2c_f32_bf16 v4, s21, v196
    v_dot2c_f32_bf16 v5, s21, v197
    v_dot2c_f32_bf16 v6, s21, v198
    v_dot2c_f32_bf16 v7, s21, v199
    s_waitcnt vmcnt(43)
    v_dot2c_f32_bf16 v4, s21, v200
    v_dot2c_f32_bf16 v5, s21, v201
    v_dot2c_f32_bf16 v6, s21, v202
    v_dot2c_f32_bf16 v7, s21, v203
    s_waitcnt vmcnt(42)
    v_dot2c_f32_bf16 v4, s21, v204
    v_dot2c_f32_bf16 v5, s21, v205
    v_dot2c_f32_bf16 v6, s21, v206
    v_dot2c_f32_bf16 v7, s21, v207
    s_waitcnt vmcnt(41)
    v_dot2c_f32_bf16 v4, s21, v208
    v_dot2c_f32_bf16 v5, s21, v209
    v_dot2c_f32_bf16 v6, s21, v210
    v_dot2c_f32_bf16 v7, s21, v211
    s_nop 2
    v_add_f32 v4, v4, v5
    v_add_f32 v6, v6, v7
    v_add_f32 v4, v4, v6
    s_nop 1
    v_add_f32_dpp v5, v4, v4 row_ror:8 row_mask:0xf bank_mask:0xf
    s_nop 1
    v_add_f32_dpp v4, v5, v5 row_ror:4 row_mask:0xf bank_mask:0xf
    s_nop 1
    v_add_f32_dpp v5, v4, v4 row_ror:2 row_mask:0xf bank_mask:0xf
    s_nop 1
    v_add_f32_dpp v4, v5, v5 row_ror:1 row_mask:0xf bank_mask:0xf
    ds_write_b32 v2, v4 offset:0
    s_waitcnt lgkmcnt(0)
    s_barrier
    ds_read_b64 v[4:5], v3 offset:0
    s_waitcnt lgkmcnt(0)
    v_add_f32 v4, v4, v5
    s_nop 1
    v_add_f32_dpp v5, v4, v4 row_ror:8 row_mask:0xf bank_mask:0xf
    s_nop 1
    v_add_f32_dpp v4, v5, v5 row_ror:4 row_mask:0xf bank_mask:0xf
    s_nop 1
    v_add_f32_dpp v5, v4, v4 row_ror:2 row_mask:0xf bank_mask:0xf
    s_nop 1
    v_add_f32_dpp v4, v5, v5 row_ror:1 row_mask:0xf bank_mask:0xf
    v_mul_f32 v4, 0x37800000, v4
    v_cvt_pk_bf16_f32 v4, v4, v4
    v_lshlrev_b32 v20, 16, v4
    v_mov_b32 v4, 0
    v_mov_b32 v5, 0
    v_mov_b32 v6, 0
    v_mov_b32 v7, 0
    v_lshlrev_b32 v12, 16, v148
    v_and_b32 v13, s22, v148
    v_lshlrev_b32 v14, 16, v149
    v_and_b32 v15, s22, v149
    v_lshlrev_b32 v16, 16, v150
    v_and_b32 v17, s22, v150
    v_lshlrev_b32 v18, 16, v151
    v_and_b32 v19, s22, v151
    v_pk_add_f32 v[12:13], v[12:13], v[20:21] op_sel_hi:[1,0] neg_lo:[0,1] neg_hi:[0,1]
    v_pk_add_f32 v[14:15], v[14:15], v[20:21] op_sel_hi:[1,0] neg_lo:[0,1] neg_hi:[0,1]
    v_pk_add_f32 v[16:17], v[16:17], v[20:21] op_sel_hi:[1,0] neg_lo:[0,1] neg_hi:[0,1]
    v_pk_add_f32 v[18:19], v[18:19], v[20:21] op_sel_hi:[1,0] neg_lo:[0,1] neg_hi:[0,1]
    v_cvt_pk_bf16_f32 v148, v12, v13
    v_cvt_pk_bf16_f32 v149, v14, v15
    v_cvt_pk_bf16_f32 v150, v16, v17
    v_cvt_pk_bf16_f32 v151, v18, v19
    v_dot2c_f32_bf16 v4, v148, v148
    v_dot2c_f32_bf16 v5, v149, v149
    v_dot2c_f32_bf16 v6, v150, v150
    v_dot2c_f32_bf16 v7, v151, v151
    v_lshlrev_b32 v12, 16, v152
    v_and_b32 v13, s22, v152
    v_lshlrev_b32 v14, 16, v153
    v_and_b32 v15, s22, v153
    v_lshlrev_b32 v16, 16, v154
    v_and_b32 v17, s22, v154
    v_lshlrev_b32 v18, 16, v155
    v_and_b32 v19, s22, v155
    v_pk_add_f32 v[12:13], v[12:13], v[20:21] op_sel_hi:[1,0] neg_lo:[0,1] neg_hi:[0,1]
    v_pk_add_f32 v[14:15], v[14:15], v[20:21] op_sel_hi:[1,0] neg_lo:[0,1] neg_hi:[0,1]
    v_pk_add_f32 v[16:17], v[16:17], v[20:21] op_sel_hi:[1,0] neg_lo:[0,1] neg_hi:[0,1]
    v_pk_add_f32 v[18:19], v[18:19], v[20:21] op_sel_hi:[1,0] neg_lo:[0,1] neg_hi:[0,1]
    v_cvt_pk_bf16_f32 v152, v12, v13
    v_cvt_pk_bf16_f32 v153, v14, v15
    v_cvt_pk_bf16_f32 v154, v16, v17
    v_cvt_pk_bf16_f32 v155, v18, v19
    v_dot2c_f32_bf16 v4, v152, v152
    v_dot2c_f32_bf16 v5, v153, v153
    v_dot2c_f32_bf16 v6, v154, v154
    v_dot2c_f32_bf16 v7, v155, v155
    v_lshlrev_b32 v12, 16, v156
    v_and_b32 v13, s22, v156
    v_lshlrev_b32 v14, 16, v157
    v_and_b32 v15, s22, v157
    v_lshlrev_b32 v16, 16, v158
    v_and_b32 v17, s22, v158
    v_lshlrev_b32 v18, 16, v159
    v_and_b32 v19, s22, v159
    v_pk_add_f32 v[12:13], v[12:13], v[20:21] op_sel_hi:[1,0] neg_lo:[0,1] neg_hi:[0,1]
    v_pk_add_f32 v[14:15], v[14:15], v[20:21] op_sel_hi:[1,0] neg_lo:[0,1] neg_hi:[0,1]
    v_pk_add_f32 v[16:17], v[16:17], v[20:21] op_sel_hi:[1,0] neg_lo:[0,1] neg_hi:[0,1]
    v_pk_add_f32 v[18:19], v[18:19], v[20:21] op_sel_hi:[1,0] neg_lo:[0,1] neg_hi:[0,1]
    v_cvt_pk_bf16_f32 v156, v12, v13
    v_cvt_pk_bf16_f32 v157, v14, v15
    v_cvt_pk_bf16_f32 v158, v16, v17
    v_cvt_pk_bf16_f32 v159, v18, v19
    v_dot2c_f32_bf16 v4, v156, v156
    v_dot2c_f32_bf16 v5, v157, v157
    v_dot2c_f32_bf16 v6, v158, v158
    v_dot2c_f32_bf16 v7, v159, v159
    v_lshlrev_b32 v12, 16, v160
    v_and_b32 v13, s22, v160
    v_lshlrev_b32 v14, 16, v161
    v_and_b32 v15, s22, v161
    v_lshlrev_b32 v16, 16, v162
    v_and_b32 v17, s22, v162
    v_lshlrev_b32 v18, 16, v163
    v_and_b32 v19, s22, v163
    v_pk_add_f32 v[12:13], v[12:13], v[20:21] op_sel_hi:[1,0] neg_lo:[0,1] neg_hi:[0,1]
    v_pk_add_f32 v[14:15], v[14:15], v[20:21] op_sel_hi:[1,0] neg_lo:[0,1] neg_hi:[0,1]
    v_pk_add_f32 v[16:17], v[16:17], v[20:21] op_sel_hi:[1,0] neg_lo:[0,1] neg_hi:[0,1]
    v_pk_add_f32 v[18:19], v[18:19], v[20:21] op_sel_hi:[1,0] neg_lo:[0,1] neg_hi:[0,1]
    v_cvt_pk_bf16_f32 v160, v12, v13
    v_cvt_pk_bf16_f32 v161, v14, v15
    v_cvt_pk_bf16_f32 v162, v16, v17
    v_cvt_pk_bf16_f32 v163, v18, v19
    v_dot2c_f32_bf16 v4, v160, v160
    v_dot2c_f32_bf16 v5, v161, v161
    v_dot2c_f32_bf16 v6, v162, v162
    v_dot2c_f32_bf16 v7, v163, v163
    v_lshlrev_b32 v12, 16, v164
    v_and_b32 v13, s22, v164
    v_lshlrev_b32 v14, 16, v165
    v_and_b32 v15, s22, v165
    v_lshlrev_b32 v16, 16, v166
    v_and_b32 v17, s22, v166
    v_lshlrev_b32 v18, 16, v167
    v_and_b32 v19, s22, v167
    v_pk_add_f32 v[12:13], v[12:13], v[20:21] op_sel_hi:[1,0] neg_lo:[0,1] neg_hi:[0,1]
    v_pk_add_f32 v[14:15], v[14:15], v[20:21] op_sel_hi:[1,0] neg_lo:[0,1] neg_hi:[0,1]
    v_pk_add_f32 v[16:17], v[16:17], v[20:21] op_sel_hi:[1,0] neg_lo:[0,1] neg_hi:[0,1]
    v_pk_add_f32 v[18:19], v[18:19], v[20:21] op_sel_hi:[1,0] neg_lo:[0,1] neg_hi:[0,1]
    v_cvt_pk_bf16_f32 v164, v12, v13
    v_cvt_pk_bf16_f32 v165, v14, v15
    v_cvt_pk_bf16_f32 v166, v16, v17
    v_cvt_pk_bf16_f32 v167, v18, v19
    v_dot2c_f32_bf16 v4, v164, v164
    v_dot2c_f32_bf16 v5, v165, v165
    v_dot2c_f32_bf16 v6, v166, v166
    v_dot2c_f32_bf16 v7, v167, v167
    v_lshlrev_b32 v12, 16, v168
    v_and_b32 v13, s22, v168
    v_lshlrev_b32 v14, 16, v169
    v_and_b32 v15, s22, v169
    v_lshlrev_b32 v16, 16, v170
    v_and_b32 v17, s22, v170
    v_lshlrev_b32 v18, 16, v171
    v_and_b32 v19, s22, v171
    v_pk_add_f32 v[12:13], v[12:13], v[20:21] op_sel_hi:[1,0] neg_lo:[0,1] neg_hi:[0,1]
    v_pk_add_f32 v[14:15], v[14:15], v[20:21] op_sel_hi:[1,0] neg_lo:[0,1] neg_hi:[0,1]
    v_pk_add_f32 v[16:17], v[16:17], v[20:21] op_sel_hi:[1,0] neg_lo:[0,1] neg_hi:[0,1]
    v_pk_add_f32 v[18:19], v[18:19], v[20:21] op_sel_hi:[1,0] neg_lo:[0,1] neg_hi:[0,1]
    v_cvt_pk_bf16_f32 v168, v12, v13
    v_cvt_pk_bf16_f32 v169, v14, v15
    v_cvt_pk_bf16_f32 v170, v16, v17
    v_cvt_pk_bf16_f32 v171, v18, v19
    v_dot2c_f32_bf16 v4, v168, v168
    v_dot2c_f32_bf16 v5, v169, v169
    v_dot2c_f32_bf16 v6, v170, v170
    v_dot2c_f32_bf16 v7, v171, v171
    v_lshlrev_b32 v12, 16, v172
    v_and_b32 v13, s22, v172
    v_lshlrev_b32 v14, 16, v173
    v_and_b32 v15, s22, v173
    v_lshlrev_b32 v16, 16, v174
    v_and_b32 v17, s22, v174
    v_lshlrev_b32 v18, 16, v175
    v_and_b32 v19, s22, v175
    v_pk_add_f32 v[12:13], v[12:13], v[20:21] op_sel_hi:[1,0] neg_lo:[0,1] neg_hi:[0,1]
    v_pk_add_f32 v[14:15], v[14:15], v[20:21] op_sel_hi:[1,0] neg_lo:[0,1] neg_hi:[0,1]
    v_pk_add_f32 v[16:17], v[16:17], v[20:21] op_sel_hi:[1,0] neg_lo:[0,1] neg_hi:[0,1]
    v_pk_add_f32 v[18:19], v[18:19], v[20:21] op_sel_hi:[1,0] neg_lo:[0,1] neg_hi:[0,1]
    v_cvt_pk_bf16_f32 v172, v12, v13
    v_cvt_pk_bf16_f32 v173, v14, v15
    v_cvt_pk_bf16_f32 v174, v16, v17
    v_cvt_pk_bf16_f32 v175, v18, v19
    v_dot2c_f32_bf16 v4, v172, v172
    v_dot2c_f32_bf16 v5, v173, v173
    v_dot2c_f32_bf16 v6, v174, v174
    v_dot2c_f32_bf16 v7, v175, v175
    v_lshlrev_b32 v12, 16, v176
    v_and_b32 v13, s22, v176
    v_lshlrev_b32 v14, 16, v177
    v_and_b32 v15, s22, v177
    v_lshlrev_b32 v16, 16, v178
    v_and_b32 v17, s22, v178
    v_lshlrev_b32 v18, 16, v179
    v_and_b32 v19, s22, v179
    v_pk_add_f32 v[12:13], v[12:13], v[20:21] op_sel_hi:[1,0] neg_lo:[0,1] neg_hi:[0,1]
    v_pk_add_f32 v[14:15], v[14:15], v[20:21] op_sel_hi:[1,0] neg_lo:[0,1] neg_hi:[0,1]
    v_pk_add_f32 v[16:17], v[16:17], v[20:21] op_sel_hi:[1,0] neg_lo:[0,1] neg_hi:[0,1]
    v_pk_add_f32 v[18:19], v[18:19], v[20:21] op_sel_hi:[1,0] neg_lo:[0,1] neg_hi:[0,1]
    v_cvt_pk_bf16_f32 v176, v12, v13
    v_cvt_pk_bf16_f32 v177, v14, v15
    v_cvt_pk_bf16_f32 v178, v16, v17
    v_cvt_pk_bf16_f32 v179, v18, v19
    v_dot2c_f32_bf16 v4, v176, v176
    v_dot2c_f32_bf16 v5, v177, v177
    v_dot2c_f32_bf16 v6, v178, v178
    v_dot2c_f32_bf16 v7, v179, v179
    v_lshlrev_b32 v12, 16, v144
    v_and_b32 v13, s22, v144
    v_lshlrev_b32 v14, 16, v145
    v_and_b32 v15, s22, v145
    v_lshlrev_b32 v16, 16, v146
    v_and_b32 v17, s22, v146
    v_lshlrev_b32 v18, 16, v147
    v_and_b32 v19, s22, v147
    v_pk_fma_f32 v[12:13], v[12:13], v[8:9], v[8:9] op_sel:[0,0,1] op_sel_hi:[1,0,1]
    v_pk_fma_f32 v[14:15], v[14:15], v[8:9], v[8:9] op_sel:[0,0,1] op_sel_hi:[1,0,1]
    v_pk_fma_f32 v[16:17], v[16:17], v[8:9], v[8:9] op_sel:[0,0,1] op_sel_hi:[1,0,1]
    v_pk_fma_f32 v[18:19], v[18:19], v[8:9], v[8:9] op_sel:[0,0,1] op_sel_hi:[1,0,1]
    v_cvt_pk_bf16_f32 v144, v12, v13
    v_cvt_pk_bf16_f32 v145, v14, v15
    v_cvt_pk_bf16_f32 v146, v16, v17
    v_cvt_pk_bf16_f32 v147, v18, v19
    global_store_dwordx4 v1, v[144:147], s[14:15] sc1
    s_add_u32 s14, s14, 8192
    s_addc_u32 s15, s15, 0
    global_load_dwordx4 v[144:147], v1, s[12:13] nt
    s_add_u32 s12, s12, 8192
    s_addc_u32 s13, s13, 0
    v_lshlrev_b32 v12, 16, v180
    v_and_b32 v13, s22, v180
    v_lshlrev_b32 v14, 16, v181
    v_and_b32 v15, s22, v181
    v_lshlrev_b32 v16, 16, v182
    v_and_b32 v17, s22, v182
    v_lshlrev_b32 v18, 16, v183
    v_and_b32 v19, s22, v183
    v_pk_add_f32 v[12:13], v[12:13], v[20:21] op_sel_hi:[1,0] neg_lo:[0,1] neg_hi:[0,1]
    v_pk_add_f32 v[14:15], v[14:15], v[20:21] op_sel_hi:[1,0] neg_lo:[0,1] neg_hi:[0,1]
    v_pk_add_f32 v[16:17], v[16:17], v[20:21] op_sel_hi:[1,0] neg_lo:[0,1] neg_hi:[0,1]
    v_pk_add_f32 v[18:19], v[18:19], v[20:21] op_sel_hi:[1,0] neg_lo:[0,1] neg_hi:[0,1]
    v_cvt_pk_bf16_f32 v180, v12, v13
    v_cvt_pk_bf16_f32 v181, v14, v15
    v_cvt_pk_bf16_f32 v182, v16, v17
    v_cvt_pk_bf16_f32 v183, v18, v19
    v_dot2c_f32_bf16 v4, v180, v180
    v_dot2c_f32_bf16 v5, v181, v181
    v_dot2c_f32_bf16 v6, v182, v182
    v_dot2c_f32_bf16 v7, v183, v183
    v_lshlrev_b32 v12, 16, v184
    v_and_b32 v13, s22, v184
    v_lshlrev_b32 v14, 16, v185
    v_and_b32 v15, s22, v185
    v_lshlrev_b32 v16, 16, v186
    v_and_b32 v17, s22, v186
    v_lshlrev_b32 v18, 16, v187
    v_and_b32 v19, s22, v187
    v_pk_add_f32 v[12:13], v[12:13], v[20:21] op_sel_hi:[1,0] neg_lo:[0,1] neg_hi:[0,1]
    v_pk_add_f32 v[14:15], v[14:15], v[20:21] op_sel_hi:[1,0] neg_lo:[0,1] neg_hi:[0,1]
    v_pk_add_f32 v[16:17], v[16:17], v[20:21] op_sel_hi:[1,0] neg_lo:[0,1] neg_hi:[0,1]
    v_pk_add_f32 v[18:19], v[18:19], v[20:21] op_sel_hi:[1,0] neg_lo:[0,1] neg_hi:[0,1]
    v_cvt_pk_bf16_f32 v184, v12, v13
    v_cvt_pk_bf16_f32 v185, v14, v15
    v_cvt_pk_bf16_f32 v186, v16, v17
    v_cvt_pk_bf16_f32 v187, v18, v19
    v_dot2c_f32_bf16 v4, v184, v184
    v_dot2c_f32_bf16 v5, v185, v185
    v_dot2c_f32_bf16 v6, v186, v186
    v_dot2c_f32_bf16 v7, v187, v187
    v_lshlrev_b32 v12, 16, v188
    v_and_b32 v13, s22, v188
    v_lshlrev_b32 v14, 16, v189
    v_and_b32 v15, s22, v189
    v_lshlrev_b32 v16, 16, v190
    v_and_b32 v17, s22, v190
    v_lshlrev_b32 v18, 16, v191
    v_and_b32 v19, s22, v191
    v_pk_add_f32 v[12:13], v[12:13], v[20:21] op_sel_hi:[1,0] neg_lo:[0,1] neg_hi:[0,1]
    v_pk_add_f32 v[14:15], v[14:15], v[20:21] op_sel_hi:[1,0] neg_lo:[0,1] neg_hi:[0,1]
    v_pk_add_f32 v[16:17], v[16:17], v[20:21] op_sel_hi:[1,0] neg_lo:[0,1] neg_hi:[0,1]
    v_pk_add_f32 v[18:19], v[18:19], v[20:21] op_sel_hi:[1,0] neg_lo:[0,1] neg_hi:[0,1]
    v_cvt_pk_bf16_f32 v188, v12, v13
    v_cvt_pk_bf16_f32 v189, v14, v15
    v_cvt_pk_bf16_f32 v190, v16, v17
    v_cvt_pk_bf16_f32 v191, v18, v19
    v_dot2c_f32_bf16 v4, v188, v188
    v_dot2c_f32_bf16 v5, v189, v189
    v_dot2c_f32_bf16 v6, v190, v190
    v_dot2c_f32_bf16 v7, v191, v191
    v_lshlrev_b32 v12, 16, v192
    v_and_b32 v13, s22, v192
    v_lshlrev_b32 v14, 16, v193
    v_and_b32 v15, s22, v193
    v_lshlrev_b32 v16, 16, v194
    v_and_b32 v17, s22, v194
    v_lshlrev_b32 v18, 16, v195
    v_and_b32 v19, s22, v195
    v_pk_add_f32 v[12:13], v[12:13], v[20:21] op_sel_hi:[1,0] neg_lo:[0,1] neg_hi:[0,1]
    v_pk_add_f32 v[14:15], v[14:15], v[20:21] op_sel_hi:[1,0] neg_lo:[0,1] neg_hi:[0,1]
    v_pk_add_f32 v[16:17], v[16:17], v[20:21] op_sel_hi:[1,0] neg_lo:[0,1] neg_hi:[0,1]
    v_pk_add_f32 v[18:19], v[18:19], v[20:21] op_sel_hi:[1,0] neg_lo:[0,1] neg_hi:[0,1]
    v_cvt_pk_bf16_f32 v192, v12, v13
    v_cvt_pk_bf16_f32 v193, v14, v15
    v_cvt_pk_bf16_f32 v194, v16, v17
    v_cvt_pk_bf16_f32 v195, v18, v19
    v_dot2c_f32_bf16 v4, v192, v192
    v_dot2c_f32_bf16 v5, v193, v193
    v_dot2c_f32_bf16 v6, v194, v194
    v_dot2c_f32_bf16 v7, v195, v195
    v_lshlrev_b32 v12, 16, v196
    v_and_b32 v13, s22, v196
    v_lshlrev_b32 v14, 16, v197
    v_and_b32 v15, s22, v197
    v_lshlrev_b32 v16, 16, v198
    v_and_b32 v17, s22, v198
    v_lshlrev_b32 v18, 16, v199
    v_and_b32 v19, s22, v199
    v_pk_add_f32 v[12:13], v[12:13], v[20:21] op_sel_hi:[1,0] neg_lo:[0,1] neg_hi:[0,1]
    v_pk_add_f32 v[14:15], v[14:15], v[20:21] op_sel_hi:[1,0] neg_lo:[0,1] neg_hi:[0,1]
    v_pk_add_f32 v[16:17], v[16:17], v[20:21] op_sel_hi:[1,0] neg_lo:[0,1] neg_hi:[0,1]
    v_pk_add_f32 v[18:19], v[18:19], v[20:21] op_sel_hi:[1,0] neg_lo:[0,1] neg_hi:[0,1]
    v_cvt_pk_bf16_f32 v196, v12, v13
    v_cvt_pk_bf16_f32 v197, v14, v15
    v_cvt_pk_bf16_f32 v198, v16, v17
    v_cvt_pk_bf16_f32 v199, v18, v19
    v_dot2c_f32_bf16 v4, v196, v196
    v_dot2c_f32_bf16 v5, v197, v197
    v_dot2c_f32_bf16 v6, v198, v198
    v_dot2c_f32_bf16 v7, v199, v199
    v_lshlrev_b32 v12, 16, v200
    v_and_b32 v13, s22, v200
    v_lshlrev_b32 v14, 16, v201
    v_and_b32 v15, s22, v201
    v_lshlrev_b32 v16, 16, v202
    v_and_b32 v17, s22, v202
    v_lshlrev_b32 v18, 16, v203
    v_and_b32 v19, s22, v203
    v_pk_add_f32 v[12:13], v[12:13], v[20:21] op_sel_hi:[1,0] neg_lo:[0,1] neg_hi:[0,1]
    v_pk_add_f32 v[14:15], v[14:15], v[20:21] op_sel_hi:[1,0] neg_lo:[0,1] neg_hi:[0,1]
    v_pk_add_f32 v[16:17], v[16:17], v[20:21] op_sel_hi:[1,0] neg_lo:[0,1] neg_hi:[0,1]
    v_pk_add_f32 v[18:19], v[18:19], v[20:21] op_sel_hi:[1,0] neg_lo:[0,1] neg_hi:[0,1]
    v_cvt_pk_bf16_f32 v200, v12, v13
    v_cvt_pk_bf16_f32 v201, v14, v15
    v_cvt_pk_bf16_f32 v202, v16, v17
    v_cvt_pk_bf16_f32 v203, v18, v19
    v_dot2c_f32_bf16 v4, v200, v200
    v_dot2c_f32_bf16 v5, v201, v201
    v_dot2c_f32_bf16 v6, v202, v202
    v_dot2c_f32_bf16 v7, v203, v203
    v_lshlrev_b32 v12, 16, v204
    v_and_b32 v13, s22, v204
    v_lshlrev_b32 v14, 16, v205
    v_and_b32 v15, s22, v205
    v_lshlrev_b32 v16, 16, v206
    v_and_b32 v17, s22, v206
    v_lshlrev_b32 v18, 16, v207
    v_and_b32 v19, s22, v207
    v_pk_add_f32 v[12:13], v[12:13], v[20:21] op_sel_hi:[1,0] neg_lo:[0,1] neg_hi:[0,1]
    v_pk_add_f32 v[14:15], v[14:15], v[20:21] op_sel_hi:[1,0] neg_lo:[0,1] neg_hi:[0,1]
    v_pk_add_f32 v[16:17], v[16:17], v[20:21] op_sel_hi:[1,0] neg_lo:[0,1] neg_hi:[0,1]
    v_pk_add_f32 v[18:19], v[18:19], v[20:21] op_sel_hi:[1,0] neg_lo:[0,1] neg_hi:[0,1]
    v_cvt_pk_bf16_f32 v204, v12, v13
    v_cvt_pk_bf16_f32 v205, v14, v15
    v_cvt_pk_bf16_f32 v206, v16, v17
    v_cvt_pk_bf16_f32 v207, v18, v19
    v_dot2c_f32_bf16 v4, v204, v204
    v_dot2c_f32_bf16 v5, v205, v205
    v_dot2c_f32_bf16 v6, v206, v206
    v_dot2c_f32_bf16 v7, v207, v207
    v_lshlrev_b32 v12, 16, v208
    v_and_b32 v13, s22, v208
    v_lshlrev_b32 v14, 16, v209
    v_and_b32 v15, s22, v209
    v_lshlrev_b32 v16, 16, v210
    v_and_b32 v17, s22, v210
    v_lshlrev_b32 v18, 16, v211
    v_and_b32 v19, s22, v211
    v_pk_add_f32 v[12:13], v[12:13], v[20:21] op_sel_hi:[1,0] neg_lo:[0,1] neg_hi:[0,1]
    v_pk_add_f32 v[14:15], v[14:15], v[20:21] op_sel_hi:[1,0] neg_lo:[0,1] neg_hi:[0,1]
    v_pk_add_f32 v[16:17], v[16:17], v[20:21] op_sel_hi:[1,0] neg_lo:[0,1] neg_hi:[0,1]
    v_pk_add_f32 v[18:19], v[18:19], v[20:21] op_sel_hi:[1,0] neg_lo:[0,1] neg_hi:[0,1]
    v_cvt_pk_bf16_f32 v208, v12, v13
    v_cvt_pk_bf16_f32 v209, v14, v15
    v_cvt_pk_bf16_f32 v210, v16, v17
    v_cvt_pk_bf16_f32 v211, v18, v19
    v_dot2c_f32_bf16 v4, v208, v208
    v_dot2c_f32_bf16 v5, v209, v209
    v_dot2c_f32_bf16 v6, v210, v210
    v_dot2c_f32_bf16 v7, v211, v211
    s_nop 2
    v_add_f32 v4, v4, v5
    v_add_f32 v6, v6, v7
    v_add_f32 v4, v4, v6
    s_nop 1
    v_add_f32_dpp v5, v4, v4 row_ror:8 row_mask:0xf bank_mask:0xf
    s_nop 1
    v_add_f32_dpp v4, v5, v5 row_ror:4 row_mask:0xf bank_mask:0xf
    s_nop 1
    v_add_f32_dpp v5, v4, v4 row_ror:2 row_mask:0xf bank_mask:0xf
    s_nop 1
    v_add_f32_dpp v4, v5, v5 row_ror:1 row_mask:0xf bank_mask:0xf
    ds_write_b32 v2, v4 offset:512
    s_waitcnt lgkmcnt(0)
    s_barrier
    ds_read_b64 v[4:5], v3 offset:512
    s_waitcnt lgkmcnt(0)
    v_add_f32 v4, v4, v5
    s_nop 1
    v_add_f32_dpp v5, v4, v4 row_ror:8 row_mask:0xf bank_mask:0xf
    s_nop 1
    v_add_f32_dpp v4, v5, v5 row_ror:4 row_mask:0xf bank_mask:0xf
    s_nop 1
    v_add_f32_dpp v5, v4, v4 row_ror:2 row_mask:0xf bank_mask:0xf
    s_nop 1
    v_add_f32_dpp v4, v5, v5 row_ror:1 row_mask:0xf bank_mask:0xf
    v_mul_f32 v4, 0x37800000, v4
    v_cvt_pk_bf16_f32 v4, v4, v4
    v_lshlrev_b32 v4, 16, v4
    v_add_f32 v4, 0x3727c5ac, v4
    v_cvt_pk_bf16_f32 v4, v4, v4
    v_lshlrev_b32 v4, 16, v4
    v_sqrt_f32 v4, v4
    s_nop 0
    v_cvt_pk_bf16_f32 v4, v4, v4
    v_lshlrev_b32 v4, 16, v4
    v_rcp_f32 v10, v4
    s_lshl_b32 s32, s62, 16
    s_and_b32 s33, s62, 0xffff0000
    s_lshl_b32 s34, s63, 16
    s_and_b32 s35, s63, 0xffff0000
    s_bitcmp1_b32 s56, 0
    s_cselect_b32 s32, s33, s32
    s_cselect_b32 s34, s35, s34
    v_mul_f32 v10, s32, v10
    v_mov_b32 v11, s34
    global_load_dwordx4 v[24:27], v30, s[70:71] sc0 sc1
    s_add_u32 s14, s10, s46
    s_addc_u32 s15, s11, 0
    v_lshlrev_b32 v12, 16, v148
    v_and_b32 v13, s22, v148
    v_lshlrev_b32 v14, 16, v149
    v_and_b32 v15, s22, v149
    v_lshlrev_b32 v16, 16, v150
    v_and_b32 v17, s22, v150
    v_lshlrev_b32 v18, 16, v151
    v_and_b32 v19, s22, v151
    v_pk_fma_f32 v[12:13], v[12:13], v[10:11], v[10:11] op_sel:[0,0,1] op_sel_hi:[1,0,1]
    v_pk_fma_f32 v[14:15], v[14:15], v[10:11], v[10:11] op_sel:[0,0,1] op_sel_hi:[1,0,1]
    v_pk_fma_f32 v[16:17], v[16:17], v[10:11], v[10:11] op_sel:[0,0,1] op_sel_hi:[1,0,1]
    v_pk_fma_f32 v[18:19], v[18:19], v[10:11], v[10:11] op_sel:[0,0,1] op_sel_hi:[1,0,1]
    v_cvt_pk_bf16_f32 v148, v12, v13
    v_cvt_pk_bf16_f32 v149, v14, v15
    v_cvt_pk_bf16_f32 v150, v16, v17
    v_cvt_pk_bf16_f32 v151, v18, v19
    global_store_dwordx4 v1, v[148:151], s[14:15] sc1
    s_add_u32 s14, s14, 8192
    s_addc_u32 s15, s15, 0
    global_load_dwordx4 v[148:151], v1, s[12:13] nt
    s_add_u32 s12, s12, 8192
    s_addc_u32 s13, s13, 0
    v_lshlrev_b32 v12, 16, v152
    v_and_b32 v13, s22, v152
    v_lshlrev_b32 v14, 16, v153
    v_and_b32 v15, s22, v153
    v_lshlrev_b32 v16, 16, v154
    v_and_b32 v17, s22, v154
    v_lshlrev_b32 v18, 16, v155
    v_and_b32 v19, s22, v155
    v_pk_fma_f32 v[12:13], v[12:13], v[10:11], v[10:11] op_sel:[0,0,1] op_sel_hi:[1,0,1]
    v_pk_fma_f32 v[14:15], v[14:15], v[10:11], v[10:11] op_sel:[0,0,1] op_sel_hi:[1,0,1]
    v_pk_fma_f32 v[16:17], v[16:17], v[10:11], v[10:11] op_sel:[0,0,1] op_sel_hi:[1,0,1]
    v_pk_fma_f32 v[18:19], v[18:19], v[10:11], v[10:11] op_sel:[0,0,1] op_sel_hi:[1,0,1]
    v_cvt_pk_bf16_f32 v152, v12, v13
    v_cvt_pk_bf16_f32 v153, v14, v15
    v_cvt_pk_bf16_f32 v154, v16, v17
    v_cvt_pk_bf16_f32 v155, v18, v19
    global_store_dwordx4 v1, v[152:155], s[14:15] sc1
    s_add_u32 s14, s14, 8192
    s_addc_u32 s15, s15, 0
    global_load_dwordx4 v[152:155], v1, s[12:13] nt
    s_add_u32 s12, s12, 8192
    s_addc_u32 s13, s13, 0
    v_lshlrev_b32 v12, 16, v156
    v_and_b32 v13, s22, v156
    v_lshlrev_b32 v14, 16, v157
    v_and_b32 v15, s22, v157
    v_lshlrev_b32 v16, 16, v158
    v_and_b32 v17, s22, v158
    v_lshlrev_b32 v18, 16, v159
    v_and_b32 v19, s22, v159
    v_pk_fma_f32 v[12:13], v[12:13], v[10:11], v[10:11] op_sel:[0,0,1] op_sel_hi:[1,0,1]
    v_pk_fma_f32 v[14:15], v[14:15], v[10:11], v[10:11] op_sel:[0,0,1] op_sel_hi:[1,0,1]
    v_pk_fma_f32 v[16:17], v[16:17], v[10:11], v[10:11] op_sel:[0,0,1] op_sel_hi:[1,0,1]
    v_pk_fma_f32 v[18:19], v[18:19], v[10:11], v[10:11] op_sel:[0,0,1] op_sel_hi:[1,0,1]
    v_cvt_pk_bf16_f32 v156, v12, v13
    v_cvt_pk_bf16_f32 v157, v14, v15
    v_cvt_pk_bf16_f32 v158, v16, v17
    v_cvt_pk_bf16_f32 v159, v18, v19
    global_store_dwordx4 v1, v[156:159], s[14:15] sc1
    s_add_u32 s14, s14, 8192
    s_addc_u32 s15, s15, 0
    global_load_dwordx4 v[156:159], v1, s[12:13] nt
    s_add_u32 s12, s12, 8192
    s_addc_u32 s13, s13, 0
    v_mov_b32 v4, 0
    v_mov_b32 v5, 0
    v_mov_b32 v6, 0
    v_mov_b32 v7, 0
    s_waitcnt vmcnt(49)
    v_dot2c_f32_bf16 v4, s21, v212
    v_dot2c_f32_bf16 v5, s21, v213
    v_dot2c_f32_bf16 v6, s21, v214
    v_dot2c_f32_bf16 v7, s21, v215
    s_waitcnt vmcnt(48)
    v_dot2c_f32_bf16 v4, s21, v216
    v_dot2c_f32_bf16 v5, s21, v217
    v_dot2c_f32_bf16 v6, s21, v218
    v_dot2c_f32_bf16 v7, s21, v219
    s_waitcnt vmcnt(47)
    v_dot2c_f32_bf16 v4, s21, v220
    v_dot2c_f32_bf16 v5, s21, v221
    v_dot2c_f32_bf16 v6, s21, v222
    v_dot2c_f32_bf16 v7, s21, v223
    s_waitcnt vmcnt(46)
    v_dot2c_f32_bf16 v4, s21, v224
    v_dot2c_f32_bf16 v5, s21, v225
    v_dot2c_f32_bf16 v6, s21, v226
    v_dot2c_f32_bf16 v7, s21, v227
    s_waitcnt vmcnt(45)
    v_dot2c_f32_bf16 v4, s21, v228
    v_dot2c_f32_bf16 v5, s21, v229
    v_dot2c_f32_bf16 v6, s21, v230
    v_dot2c_f32_bf16 v7, s21, v231
    s_waitcnt vmcnt(44)
    v_dot2c_f32_bf16 v4, s21, v232
    v_dot2c_f32_bf16 v5, s21, v233
    v_dot2c_f32_bf16 v6, s21, v234
    v_dot2c_f32_bf16 v7, s21, v235
    s_waitcnt vmcnt(43)
    v_dot2c_f32_bf16 v4, s21, v236
    v_dot2c_f32_bf16 v5, s21, v237
    v_dot2c_f32_bf16 v6, s21, v238
    v_dot2c_f32_bf16 v7, s21, v239
    s_waitcnt vmcnt(42)
    v_dot2c_f32_bf16 v4, s21, v240
    v_dot2c_f32_bf16 v5, s21, v241
    v_dot2c_f32_bf16 v6, s21, v242
    v_dot2c_f32_bf16 v7, s21, v243
    s_waitcnt vmcnt(41)
    v_dot2c_f32_bf16 v4, s21, v244
    v_dot2c_f32_bf16 v5, s21, v245
    v_dot2c_f32_bf16 v6, s21, v246
    v_dot2c_f32_bf16 v7, s21, v247
    s_waitcnt vmcnt(40)
    v_dot2c_f32_bf16 v4, s21, v248
    v_dot2c_f32_bf16 v5, s21, v249
    v_dot2c_f32_bf16 v6, s21, v250
    v_dot2c_f32_bf16 v7, s21, v251
    s_waitcnt vmcnt(39)
    v_dot2c_f32_bf16 v4, s21, v252
    v_dot2c_f32_bf16 v5, s21, v253
    v_dot2c_f32_bf16 v6, s21, v254
    v_dot2c_f32_bf16 v7, s21, v255
    s_waitcnt vmcnt(37)
    v_dot2c_f32_bf16 v4, s21, v84
    v_dot2c_f32_bf16 v5, s21, v85
    v_dot2c_f32_bf16 v6, s21, v86
    v_dot2c_f32_bf16 v7, s21, v87
    s_waitcnt vmcnt(35)
    v_dot2c_f32_bf16 v4, s21, v88
    v_dot2c_f32_bf16 v5, s21, v89
    v_dot2c_f32_bf16 v6, s21, v90
    v_dot2c_f32_bf16 v7, s21, v91
    s_waitcnt vmcnt(33)
    v_dot2c_f32_bf16 v4, s21, v92
    v_dot2c_f32_bf16 v5, s21, v93
    v_dot2c_f32_bf16 v6, s21, v94
    v_dot2c_f32_bf16 v7, s21, v95
    s_waitcnt vmcnt(31)
    v_dot2c_f32_bf16 v4, s21, v96
    v_dot2c_f32_bf16 v5, s21, v97
    v_dot2c_f32_bf16 v6, s21, v98
    v_dot2c_f32_bf16 v7, s21, v99
    s_waitcnt vmcnt(29)
    v_dot2c_f32_bf16 v4, s21, v100
    v_dot2c_f32_bf16 v5, s21, v101
    v_dot2c_f32_bf16 v6, s21, v102
    v_dot2c_f32_bf16 v7, s21, v103
    s_nop 2
    v_add_f32 v4, v4, v5
    v_add_f32 v6, v6, v7
    v_add_f32 v4, v4, v6
    s_nop 1
    v_add_f32_dpp v5, v4, v4 row_ror:8 row_mask:0xf bank_mask:0xf
    s_nop 1
    v_add_f32_dpp v4, v5, v5 row_ror:4 row_mask:0xf bank_mask:0xf
    s_nop 1
    v_add_f32_dpp v5, v4, v4 row_ror:2 row_mask:0xf bank_mask:0xf
    s_nop 1
    v_add_f32_dpp v4, v5, v5 row_ror:1 row_mask:0xf bank_mask:0xf
    ds_write_b32 v2, v4 offset:0
    v_lshlrev_b32 v12, 16, v160
    v_and_b32 v13, s22, v160
    v_lshlrev_b32 v14, 16, v161
    v_and_b32 v15, s22, v161
    v_lshlrev_b32 v16, 16, v162
    v_and_b32 v17, s22, v162
    v_lshlrev_b32 v18, 16, v163
    v_and_b32 v19, s22, v163
    v_pk_fma_f32 v[12:13], v[12:13], v[10:11], v[10:11] op_sel:[0,0,1] op_sel_hi:[1,0,1]
    v_pk_fma_f32 v[14:15], v[14:15], v[10:11], v[10:11] op_sel:[0,0,1] op_sel_hi:[1,0,1]
    v_pk_fma_f32 v[16:17], v[16:17], v[10:11], v[10:11] op_sel:[0,0,1] op_sel_hi:[1,0,1]
    v_pk_fma_f32 v[18:19], v[18:19], v[10:11], v[10:11] op_sel:[0,0,1] op_sel_hi:[1,0,1]
    v_cvt_pk_bf16_f32 v160, v12, v13
    v_cvt_pk_bf16_f32 v161, v14, v15
    v_cvt_pk_bf16_f32 v162, v16, v17
    v_cvt_pk_bf16_f32 v163, v18, v19
    global_store_dwordx4 v1, v[160:163], s[14:15] sc1
    s_add_u32 s14, s14, 8192
    s_addc_u32 s15, s15, 0
    global_load_dwordx4 v[160:163], v1, s[12:13] nt
    s_add_u32 s12, s12, 8192
    s_addc_u32 s13, s13, 0
    v_lshlrev_b32 v12, 16, v164
    v_and_b32 v13, s22, v164
    v_lshlrev_b32 v14, 16, v165
    v_and_b32 v15, s22, v165
    v_lshlrev_b32 v16, 16, v166
    v_and_b32 v17, s22, v166
    v_lshlrev_b32 v18, 16, v167
    v_and_b32 v19, s22, v167
    v_pk_fma_f32 v[12:13], v[12:13], v[10:11], v[10:11] op_sel:[0,0,1] op_sel_hi:[1,0,1]
    v_pk_fma_f32 v[14:15], v[14:15], v[10:11], v[10:11] op_sel:[0,0,1] op_sel_hi:[1,0,1]
    v_pk_fma_f32 v[16:17], v[16:17], v[10:11], v[10:11] op_sel:[0,0,1] op_sel_hi:[1,0,1]
    v_pk_fma_f32 v[18:19], v[18:19], v[10:11], v[10:11] op_sel:[0,0,1] op_sel_hi:[1,0,1]
    v_cvt_pk_bf16_f32 v164, v12, v13
    v_cvt_pk_bf16_f32 v165, v14, v15
    v_cvt_pk_bf16_f32 v166, v16, v17
    v_cvt_pk_bf16_f32 v167, v18, v19
    global_store_dwordx4 v1, v[164:167], s[14:15] sc1
    s_add_u32 s14, s14, 8192
    s_addc_u32 s15, s15, 0
    global_load_dwordx4 v[164:167], v1, s[12:13] nt
    s_add_u32 s12, s12, 8192
    s_addc_u32 s13, s13, 0
    s_waitcnt lgkmcnt(0)
    s_barrier
    ds_read_b64 v[4:5], v3 offset:0
    s_waitcnt lgkmcnt(0)
    v_add_f32 v4, v4, v5
    s_nop 1
    v_add_f32_dpp v5, v4, v4 row_ror:8 row_mask:0xf bank_mask:0xf
    s_nop 1
    v_add_f32_dpp v4, v5, v5 row_ror:4 row_mask:0xf bank_mask:0xf
    s_nop 1
    v_add_f32_dpp v5, v4, v4 row_ror:2 row_mask:0xf bank_mask:0xf
    s_nop 1
    v_add_f32_dpp v4, v5, v5 row_ror:1 row_mask:0xf bank_mask:0xf
    v_mul_f32 v4, 0x37800000, v4
    v_cvt_pk_bf16_f32 v4, v4, v4
    v_lshlrev_b32 v20, 16, v4
    v_mov_b32 v4, 0
    v_mov_b32 v5, 0
    v_mov_b32 v6, 0
    v_mov_b32 v7, 0
    v_lshlrev_b32 v12, 16, v168
    v_and_b32 v13, s22, v168
    v_lshlrev_b32 v14, 16, v169
    v_and_b32 v15, s22, v169
    v_lshlrev_b32 v16, 16, v170
    v_and_b32 v17, s22, v170
    v_lshlrev_b32 v18, 16, v171
    v_and_b32 v19, s22, v171
    v_pk_fma_f32 v[12:13], v[12:13], v[10:11], v[10:11] op_sel:[0,0,1] op_sel_hi:[1,0,1]
    v_pk_fma_f32 v[14:15], v[14:15], v[10:11], v[10:11] op_sel:[0,0,1] op_sel_hi:[1,0,1]
    v_pk_fma_f32 v[16:17], v[16:17], v[10:11], v[10:11] op_sel:[0,0,1] op_sel_hi:[1,0,1]
    v_pk_fma_f32 v[18:19], v[18:19], v[10:11], v[10:11] op_sel:[0,0,1] op_sel_hi:[1,0,1]
    v_cvt_pk_bf16_f32 v168, v12, v13
    v_cvt_pk_bf16_f32 v169, v14, v15
    v_cvt_pk_bf16_f32 v170, v16, v17
    v_cvt_pk_bf16_f32 v171, v18, v19
    global_store_dwordx4 v1, v[168:171], s[14:15] sc1
    s_add_u32 s14, s14, 8192
    s_addc_u32 s15, s15, 0
    v_lshlrev_b32 v12, 16, v172
    v_and_b32 v13, s22, v172
    v_lshlrev_b32 v14, 16, v173
    v_and_b32 v15, s22, v173
    v_lshlrev_b32 v16, 16, v174
    v_and_b32 v17, s22, v174
    v_lshlrev_b32 v18, 16, v175
    v_and_b32 v19, s22, v175
    v_pk_fma_f32 v[12:13], v[12:13], v[10:11], v[10:11] op_sel:[0,0,1] op_sel_hi:[1,0,1]
    v_pk_fma_f32 v[14:15], v[14:15], v[10:11], v[10:11] op_sel:[0,0,1] op_sel_hi:[1,0,1]
    v_pk_fma_f32 v[16:17], v[16:17], v[10:11], v[10:11] op_sel:[0,0,1] op_sel_hi:[1,0,1]
    v_pk_fma_f32 v[18:19], v[18:19], v[10:11], v[10:11] op_sel:[0,0,1] op_sel_hi:[1,0,1]
    v_cvt_pk_bf16_f32 v172, v12, v13
    v_cvt_pk_bf16_f32 v173, v14, v15
    v_cvt_pk_bf16_f32 v174, v16, v17
    v_cvt_pk_bf16_f32 v175, v18, v19
    global_store_dwordx4 v1, v[172:175], s[14:15] sc1
    s_add_u32 s14, s14, 8192
    s_addc_u32 s15, s15, 0
    v_lshlrev_b32 v12, 16, v212
    v_and_b32 v13, s22, v212
    v_lshlrev_b32 v14, 16, v213
    v_and_b32 v15, s22, v213
    v_lshlrev_b32 v16, 16, v214
    v_and_b32 v17, s22, v214
    v_lshlrev_b32 v18, 16, v215
    v_and_b32 v19, s22, v215
    v_pk_add_f32 v[12:13], v[12:13], v[20:21] op_sel_hi:[1,0] neg_lo:[0,1] neg_hi:[0,1]
    v_pk_add_f32 v[14:15], v[14:15], v[20:21] op_sel_hi:[1,0] neg_lo:[0,1] neg_hi:[0,1]
    v_pk_add_f32 v[16:17], v[16:17], v[20:21] op_sel_hi:[1,0] neg_lo:[0,1] neg_hi:[0,1]
    v_pk_add_f32 v[18:19], v[18:19], v[20:21] op_sel_hi:[1,0] neg_lo:[0,1] neg_hi:[0,1]
    v_cvt_pk_bf16_f32 v212, v12, v13
    v_cvt_pk_bf16_f32 v213, v14, v15
    v_cvt_pk_bf16_f32 v214, v16, v17
    v_cvt_pk_bf16_f32 v215, v18, v19
    v_dot2c_f32_bf16 v4, v212, v212
    v_dot2c_f32_bf16 v5, v213, v213
    v_dot2c_f32_bf16 v6, v214, v214
    v_dot2c_f32_bf16 v7, v215, v215
    v_lshlrev_b32 v12, 16, v216
    v_and_b32 v13, s22, v216
    v_lshlrev_b32 v14, 16, v217
    v_and_b32 v15, s22, v217
    v_lshlrev_b32 v16, 16, v218
    v_and_b32 v17, s22, v218
    v_lshlrev_b32 v18, 16, v219
    v_and_b32 v19, s22, v219
    v_pk_add_f32 v[12:13], v[12:13], v[20:21] op_sel_hi:[1,0] neg_lo:[0,1] neg_hi:[0,1]
    v_pk_add_f32 v[14:15], v[14:15], v[20:21] op_sel_hi:[1,0] neg_lo:[0,1] neg_hi:[0,1]
    v_pk_add_f32 v[16:17], v[16:17], v[20:21] op_sel_hi:[1,0] neg_lo:[0,1] neg_hi:[0,1]
    v_pk_add_f32 v[18:19], v[18:19], v[20:21] op_sel_hi:[1,0] neg_lo:[0,1] neg_hi:[0,1]
    v_cvt_pk_bf16_f32 v216, v12, v13
    v_cvt_pk_bf16_f32 v217, v14, v15
    v_cvt_pk_bf16_f32 v218, v16, v17
    v_cvt_pk_bf16_f32 v219, v18, v19
    v_dot2c_f32_bf16 v4, v216, v216
    v_dot2c_f32_bf16 v5, v217, v217
    v_dot2c_f32_bf16 v6, v218, v218
    v_dot2c_f32_bf16 v7, v219, v219
    v_lshlrev_b32 v12, 16, v220
    v_and_b32 v13, s22, v220
    v_lshlrev_b32 v14, 16, v221
    v_and_b32 v15, s22, v221
    v_lshlrev_b32 v16, 16, v222
    v_and_b32 v17, s22, v222
    v_lshlrev_b32 v18, 16, v223
    v_and_b32 v19, s22, v223
    v_pk_add_f32 v[12:13], v[12:13], v[20:21] op_sel_hi:[1,0] neg_lo:[0,1] neg_hi:[0,1]
    v_pk_add_f32 v[14:15], v[14:15], v[20:21] op_sel_hi:[1,0] neg_lo:[0,1] neg_hi:[0,1]
    v_pk_add_f32 v[16:17], v[16:17], v[20:21] op_sel_hi:[1,0] neg_lo:[0,1] neg_hi:[0,1]
    v_pk_add_f32 v[18:19], v[18:19], v[20:21] op_sel_hi:[1,0] neg_lo:[0,1] neg_hi:[0,1]
    v_cvt_pk_bf16_f32 v220, v12, v13
    v_cvt_pk_bf16_f32 v221, v14, v15
    v_cvt_pk_bf16_f32 v222, v16, v17
    v_cvt_pk_bf16_f32 v223, v18, v19
    v_dot2c_f32_bf16 v4, v220, v220
    v_dot2c_f32_bf16 v5, v221, v221
    v_dot2c_f32_bf16 v6, v222, v222
    v_dot2c_f32_bf16 v7, v223, v223
    v_lshlrev_b32 v12, 16, v224
    v_and_b32 v13, s22, v224
    v_lshlrev_b32 v14, 16, v225
    v_and_b32 v15, s22, v225
    v_lshlrev_b32 v16, 16, v226
    v_and_b32 v17, s22, v226
    v_lshlrev_b32 v18, 16, v227
    v_and_b32 v19, s22, v227
    v_pk_add_f32 v[12:13], v[12:13], v[20:21] op_sel_hi:[1,0] neg_lo:[0,1] neg_hi:[0,1]
    v_pk_add_f32 v[14:15], v[14:15], v[20:21] op_sel_hi:[1,0] neg_lo:[0,1] neg_hi:[0,1]
    v_pk_add_f32 v[16:17], v[16:17], v[20:21] op_sel_hi:[1,0] neg_lo:[0,1] neg_hi:[0,1]
    v_pk_add_f32 v[18:19], v[18:19], v[20:21] op_sel_hi:[1,0] neg_lo:[0,1] neg_hi:[0,1]
    v_cvt_pk_bf16_f32 v224, v12, v13
    v_cvt_pk_bf16_f32 v225, v14, v15
    v_cvt_pk_bf16_f32 v226, v16, v17
    v_cvt_pk_bf16_f32 v227, v18, v19
    v_dot2c_f32_bf16 v4, v224, v224
    v_dot2c_f32_bf16 v5, v225, v225
    v_dot2c_f32_bf16 v6, v226, v226
    v_dot2c_f32_bf16 v7, v227, v227
    v_lshlrev_b32 v12, 16, v176
    v_and_b32 v13, s22, v176
    v_lshlrev_b32 v14, 16, v177
    v_and_b32 v15, s22, v177
    v_lshlrev_b32 v16, 16, v178
    v_and_b32 v17, s22, v178
    v_lshlrev_b32 v18, 16, v179
    v_and_b32 v19, s22, v179
    v_pk_fma_f32 v[12:13], v[12:13], v[10:11], v[10:11] op_sel:[0,0,1] op_sel_hi:[1,0,1]
    v_pk_fma_f32 v[14:15], v[14:15], v[10:11], v[10:11] op_sel:[0,0,1] op_sel_hi:[1,0,1]
    v_pk_fma_f32 v[16:17], v[16:17], v[10:11], v[10:11] op_sel:[0,0,1] op_sel_hi:[1,0,1]
    v_pk_fma_f32 v[18:19], v[18:19], v[10:11], v[10:11] op_sel:[0,0,1] op_sel_hi:[1,0,1]
    v_cvt_pk_bf16_f32 v176, v12, v13
    v_cvt_pk_bf16_f32 v177, v14, v15
    v_cvt_pk_bf16_f32 v178, v16, v17
    v_cvt_pk_bf16_f32 v179, v18, v19
    global_store_dwordx4 v1, v[176:179], s[14:15] sc1
    s_add_u32 s14, s14, 8192
    s_addc_u32 s15, s15, 0
    v_lshlrev_b32 v12, 16, v180
    v_and_b32 v13, s22, v180
    v_lshlrev_b32 v14, 16, v181
    v_and_b32 v15, s22, v181
    v_lshlrev_b32 v16, 16, v182
    v_and_b32 v17, s22, v182
    v_lshlrev_b32 v18, 16, v183
    v_and_b32 v19, s22, v183
    v_pk_fma_f32 v[12:13], v[12:13], v[10:11], v[10:11] op_sel:[0,0,1] op_sel_hi:[1,0,1]
    v_pk_fma_f32 v[14:15], v[14:15], v[10:11], v[10:11] op_sel:[0,0,1] op_sel_hi:[1,0,1]
    v_pk_fma_f32 v[16:17], v[16:17], v[10:11], v[10:11] op_sel:[0,0,1] op_sel_hi:[1,0,1]
    v_pk_fma_f32 v[18:19], v[18:19], v[10:11], v[10:11] op_sel:[0,0,1] op_sel_hi:[1,0,1]
    v_cvt_pk_bf16_f32 v180, v12, v13
    v_cvt_pk_bf16_f32 v181, v14, v15
    v_cvt_pk_bf16_f32 v182, v16, v17
    v_cvt_pk_bf16_f32 v183, v18, v19
    global_store_dwordx4 v1, v[180:183], s[14:15] sc1
    s_add_u32 s14, s14, 8192
    s_addc_u32 s15, s15, 0
    v_lshlrev_b32 v12, 16, v228
    v_and_b32 v13, s22, v228
    v_lshlrev_b32 v14, 16, v229
    v_and_b32 v15, s22, v229
    v_lshlrev_b32 v16, 16, v230
    v_and_b32 v17, s22, v230
    v_lshlrev_b32 v18, 16, v231
    v_and_b32 v19, s22, v231
    v_pk_add_f32 v[12:13], v[12:13], v[20:21] op_sel_hi:[1,0] neg_lo:[0,1] neg_hi:[0,1]
    v_pk_add_f32 v[14:15], v[14:15], v[20:21] op_sel_hi:[1,0] neg_lo:[0,1] neg_hi:[0,1]
    v_pk_add_f32 v[16:17], v[16:17], v[20:21] op_sel_hi:[1,0] neg_lo:[0,1] neg_hi:[0,1]
    v_pk_add_f32 v[18:19], v[18:19], v[20:21] op_sel_hi:[1,0] neg_lo:[0,1] neg_hi:[0,1]
    v_cvt_pk_bf16_f32 v228, v12, v13
    v_cvt_pk_bf16_f32 v229, v14, v15
    v_cvt_pk_bf16_f32 v230, v16, v17
    v_cvt_pk_bf16_f32 v231, v18, v19
    v_dot2c_f32_bf16 v4, v228, v228
    v_dot2c_f32_bf16 v5, v229, v229
    v_dot2c_f32_bf16 v6, v230, v230
    v_dot2c_f32_bf16 v7, v231, v231
    v_lshlrev_b32 v12, 16, v232
    v_and_b32 v13, s22, v232
    v_lshlrev_b32 v14, 16, v233
    v_and_b32 v15, s22, v233
    v_lshlrev_b32 v16, 16, v234
    v_and_b32 v17, s22, v234
    v_lshlrev_b32 v18, 16, v235
    v_and_b32 v19, s22, v235
    v_pk_add_f32 v[12:13], v[12:13], v[20:21] op_sel_hi:[1,0] neg_lo:[0,1] neg_hi:[0,1]
    v_pk_add_f32 v[14:15], v[14:15], v[20:21] op_sel_hi:[1,0] neg_lo:[0,1] neg_hi:[0,1]
    v_pk_add_f32 v[16:17], v[16:17], v[20:21] op_sel_hi:[1,0] neg_lo:[0,1] neg_hi:[0,1]
    v_pk_add_f32 v[18:19], v[18:19], v[20:21] op_sel_hi:[1,0] neg_lo:[0,1] neg_hi:[0,1]
    v_cvt_pk_bf16_f32 v232, v12, v13
    v_cvt_pk_bf16_f32 v233, v14, v15
    v_cvt_pk_bf16_f32 v234, v16, v17
    v_cvt_pk_bf16_f32 v235, v18, v19
    v_dot2c_f32_bf16 v4, v232, v232
    v_dot2c_f32_bf16 v5, v233, v233
    v_dot2c_f32_bf16 v6, v234, v234
    v_dot2c_f32_bf16 v7, v235, v235
    v_lshlrev_b32 v12, 16, v236
    v_and_b32 v13, s22, v236
    v_lshlrev_b32 v14, 16, v237
    v_and_b32 v15, s22, v237
    v_lshlrev_b32 v16, 16, v238
    v_and_b32 v17, s22, v238
    v_lshlrev_b32 v18, 16, v239
    v_and_b32 v19, s22, v239
    v_pk_add_f32 v[12:13], v[12:13], v[20:21] op_sel_hi:[1,0] neg_lo:[0,1] neg_hi:[0,1]
    v_pk_add_f32 v[14:15], v[14:15], v[20:21] op_sel_hi:[1,0] neg_lo:[0,1] neg_hi:[0,1]
    v_pk_add_f32 v[16:17], v[16:17], v[20:21] op_sel_hi:[1,0] neg_lo:[0,1] neg_hi:[0,1]
    v_pk_add_f32 v[18:19], v[18:19], v[20:21] op_sel_hi:[1,0] neg_lo:[0,1] neg_hi:[0,1]
    v_cvt_pk_bf16_f32 v236, v12, v13
    v_cvt_pk_bf16_f32 v237, v14, v15
    v_cvt_pk_bf16_f32 v238, v16, v17
    v_cvt_pk_bf16_f32 v239, v18, v19
    v_dot2c_f32_bf16 v4, v236, v236
    v_dot2c_f32_bf16 v5, v237, v237
    v_dot2c_f32_bf16 v6, v238, v238
    v_dot2c_f32_bf16 v7, v239, v239
    v_lshlrev_b32 v12, 16, v240
    v_and_b32 v13, s22, v240
    v_lshlrev_b32 v14, 16, v241
    v_and_b32 v15, s22, v241
    v_lshlrev_b32 v16, 16, v242
    v_and_b32 v17, s22, v242
    v_lshlrev_b32 v18, 16, v243
    v_and_b32 v19, s22, v243
    v_pk_add_f32 v[12:13], v[12:13], v[20:21] op_sel_hi:[1,0] neg_lo:[0,1] neg_hi:[0,1]
    v_pk_add_f32 v[14:15], v[14:15], v[20:21] op_sel_hi:[1,0] neg_lo:[0,1] neg_hi:[0,1]
    v_pk_add_f32 v[16:17], v[16:17], v[20:21] op_sel_hi:[1,0] neg_lo:[0,1] neg_hi:[0,1]
    v_pk_add_f32 v[18:19], v[18:19], v[20:21] op_sel_hi:[1,0] neg_lo:[0,1] neg_hi:[0,1]
    v_cvt_pk_bf16_f32 v240, v12, v13
    v_cvt_pk_bf16_f32 v241, v14, v15
    v_cvt_pk_bf16_f32 v242, v16, v17
    v_cvt_pk_bf16_f32 v243, v18, v19
    v_dot2c_f32_bf16 v4, v240, v240
    v_dot2c_f32_bf16 v5, v241, v241
    v_dot2c_f32_bf16 v6, v242, v242
    v_dot2c_f32_bf16 v7, v243, v243
    v_lshlrev_b32 v12, 16, v184
    v_and_b32 v13, s22, v184
    v_lshlrev_b32 v14, 16, v185
    v_and_b32 v15, s22, v185
    v_lshlrev_b32 v16, 16, v186
    v_and_b32 v17, s22, v186
    v_lshlrev_b32 v18, 16, v187
    v_and_b32 v19, s22, v187
    v_pk_fma_f32 v[12:13], v[12:13], v[10:11], v[10:11] op_sel:[0,0,1] op_sel_hi:[1,0,1]
    v_pk_fma_f32 v[14:15], v[14:15], v[10:11], v[10:11] op_sel:[0,0,1] op_sel_hi:[1,0,1]
    v_pk_fma_f32 v[16:17], v[16:17], v[10:11], v[10:11] op_sel:[0,0,1] op_sel_hi:[1,0,1]
    v_pk_fma_f32 v[18:19], v[18:19], v[10:11], v[10:11] op_sel:[0,0,1] op_sel_hi:[1,0,1]
    v_cvt_pk_bf16_f32 v184, v12, v13
    v_cvt_pk_bf16_f32 v185, v14, v15
    v_cvt_pk_bf16_f32 v186, v16, v17
    v_cvt_pk_bf16_f32 v187, v18, v19
    global_store_dwordx4 v1, v[184:187], s[14:15] sc1
    s_add_u32 s14, s14, 8192
    s_addc_u32 s15, s15, 0
    v_lshlrev_b32 v12, 16, v188
    v_and_b32 v13, s22, v188
    v_lshlrev_b32 v14, 16, v189
    v_and_b32 v15, s22, v189
    v_lshlrev_b32 v16, 16, v190
    v_and_b32 v17, s22, v190
    v_lshlrev_b32 v18, 16, v191
    v_and_b32 v19, s22, v191
    v_pk_fma_f32 v[12:13], v[12:13], v[10:11], v[10:11] op_sel:[0,0,1] op_sel_hi:[1,0,1]
    v_pk_fma_f32 v[14:15], v[14:15], v[10:11], v[10:11] op_sel:[0,0,1] op_sel_hi:[1,0,1]
    v_pk_fma_f32 v[16:17], v[16:17], v[10:11], v[10:11] op_sel:[0,0,1] op_sel_hi:[1,0,1]
    v_pk_fma_f32 v[18:19], v[18:19], v[10:11], v[10:11] op_sel:[0,0,1] op_sel_hi:[1,0,1]
    v_cvt_pk_bf16_f32 v188, v12, v13
    v_cvt_pk_bf16_f32 v189, v14, v15
    v_cvt_pk_bf16_f32 v190, v16, v17
    v_cvt_pk_bf16_f32 v191, v18, v19
    global_store_dwordx4 v1, v[188:191], s[14:15] sc1
    s_add_u32 s14, s14, 8192
    s_addc_u32 s15, s15, 0
    v_lshlrev_b32 v12, 16, v244
    v_and_b32 v13, s22, v244
    v_lshlrev_b32 v14, 16, v245
    v_and_b32 v15, s22, v245
    v_lshlrev_b32 v16, 16, v246
    v_and_b32 v17, s22, v246
    v_lshlrev_b32 v18, 16, v247
    v_and_b32 v19, s22, v247
    v_pk_add_f32 v[12:13], v[12:13], v[20:21] op_sel_hi:[1,0] neg_lo:[0,1] neg_hi:[0,1]
    v_pk_add_f32 v[14:15], v[14:15], v[20:21] op_sel_hi:[1,0] neg_lo:[0,1] neg_hi:[0,1]
    v_pk_add_f32 v[16:17], v[16:17], v[20:21] op_sel_hi:[1,0] neg_lo:[0,1] neg_hi:[0,1]
    v_pk_add_f32 v[18:19], v[18:19], v[20:21] op_sel_hi:[1,0] neg_lo:[0,1] neg_hi:[0,1]
    v_cvt_pk_bf16_f32 v244, v12, v13
    v_cvt_pk_bf16_f32 v245, v14, v15
    v_cvt_pk_bf16_f32 v246, v16, v17
    v_cvt_pk_bf16_f32 v247, v18, v19
    v_dot2c_f32_bf16 v4, v244, v244
    v_dot2c_f32_bf16 v5, v245, v245
    v_dot2c_f32_bf16 v6, v246, v246
    v_dot2c_f32_bf16 v7, v247, v247
    v_lshlrev_b32 v12, 16, v248
    v_and_b32 v13, s22, v248
    v_lshlrev_b32 v14, 16, v249
    v_and_b32 v15, s22, v249
    v_lshlrev_b32 v16, 16, v250
    v_and_b32 v17, s22, v250
    v_lshlrev_b32 v18, 16, v251
    v_and_b32 v19, s22, v251
    v_pk_add_f32 v[12:13], v[12:13], v[20:21] op_sel_hi:[1,0] neg_lo:[0,1] neg_hi:[0,1]
    v_pk_add_f32 v[14:15], v[14:15], v[20:21] op_sel_hi:[1,0] neg_lo:[0,1] neg_hi:[0,1]
    v_pk_add_f32 v[16:17], v[16:17], v[20:21] op_sel_hi:[1,0] neg_lo:[0,1] neg_hi:[0,1]
    v_pk_add_f32 v[18:19], v[18:19], v[20:21] op_sel_hi:[1,0] neg_lo:[0,1] neg_hi:[0,1]
    v_cvt_pk_bf16_f32 v248, v12, v13
    v_cvt_pk_bf16_f32 v249, v14, v15
    v_cvt_pk_bf16_f32 v250, v16, v17
    v_cvt_pk_bf16_f32 v251, v18, v19
    v_dot2c_f32_bf16 v4, v248, v248
    v_dot2c_f32_bf16 v5, v249, v249
    v_dot2c_f32_bf16 v6, v250, v250
    v_dot2c_f32_bf16 v7, v251, v251
    v_lshlrev_b32 v12, 16, v252
    v_and_b32 v13, s22, v252
    v_lshlrev_b32 v14, 16, v253
    v_and_b32 v15, s22, v253
    v_lshlrev_b32 v16, 16, v254
    v_and_b32 v17, s22, v254
    v_lshlrev_b32 v18, 16, v255
    v_and_b32 v19, s22, v255
    v_pk_add_f32 v[12:13], v[12:13], v[20:21] op_sel_hi:[1,0] neg_lo:[0,1] neg_hi:[0,1]
    v_pk_add_f32 v[14:15], v[14:15], v[20:21] op_sel_hi:[1,0] neg_lo:[0,1] neg_hi:[0,1]
    v_pk_add_f32 v[16:17], v[16:17], v[20:21] op_sel_hi:[1,0] neg_lo:[0,1] neg_hi:[0,1]
    v_pk_add_f32 v[18:19], v[18:19], v[20:21] op_sel_hi:[1,0] neg_lo:[0,1] neg_hi:[0,1]
    v_cvt_pk_bf16_f32 v252, v12, v13
    v_cvt_pk_bf16_f32 v253, v14, v15
    v_cvt_pk_bf16_f32 v254, v16, v17
    v_cvt_pk_bf16_f32 v255, v18, v19
    v_dot2c_f32_bf16 v4, v252, v252
    v_dot2c_f32_bf16 v5, v253, v253
    v_dot2c_f32_bf16 v6, v254, v254
    v_dot2c_f32_bf16 v7, v255, v255
    v_lshlrev_b32 v12, 16, v84
    v_and_b32 v13, s22, v84
    v_lshlrev_b32 v14, 16, v85
    v_and_b32 v15, s22, v85
    v_lshlrev_b32 v16, 16, v86
    v_and_b32 v17, s22, v86
    v_lshlrev_b32 v18, 16, v87
    v_and_b32 v19, s22, v87
    v_pk_add_f32 v[12:13], v[12:13], v[20:21] op_sel_hi:[1,0] neg_lo:[0,1] neg_hi:[0,1]
    v_pk_add_f32 v[14:15], v[14:15], v[20:21] op_sel_hi:[1,0] neg_lo:[0,1] neg_hi:[0,1]
    v_pk_add_f32 v[16:17], v[16:17], v[20:21] op_sel_hi:[1,0] neg_lo:[0,1] neg_hi:[0,1]
    v_pk_add_f32 v[18:19], v[18:19], v[20:21] op_sel_hi:[1,0] neg_lo:[0,1] neg_hi:[0,1]
    v_cvt_pk_bf16_f32 v84, v12, v13
    v_cvt_pk_bf16_f32 v85, v14, v15
    v_cvt_pk_bf16_f32 v86, v16, v17
    v_cvt_pk_bf16_f32 v87, v18, v19
    v_dot2c_f32_bf16 v4, v84, v84
    v_dot2c_f32_bf16 v5, v85, v85
    v_dot2c_f32_bf16 v6, v86, v86
    v_dot2c_f32_bf16 v7, v87, v87
    v_lshlrev_b32 v12, 16, v192
    v_and_b32 v13, s22, v192
    v_lshlrev_b32 v14, 16, v193
    v_and_b32 v15, s22, v193
    v_lshlrev_b32 v16, 16, v194
    v_and_b32 v17, s22, v194
    v_lshlrev_b32 v18, 16, v195
    v_and_b32 v19, s22, v195
    v_pk_fma_f32 v[12:13], v[12:13], v[10:11], v[10:11] op_sel:[0,0,1] op_sel_hi:[1,0,1]
    v_pk_fma_f32 v[14:15], v[14:15], v[10:11], v[10:11] op_sel:[0,0,1] op_sel_hi:[1,0,1]
    v_pk_fma_f32 v[16:17], v[16:17], v[10:11], v[10:11] op_sel:[0,0,1] op_sel_hi:[1,0,1]
    v_pk_fma_f32 v[18:19], v[18:19], v[10:11], v[10:11] op_sel:[0,0,1] op_sel_hi:[1,0,1]
    v_cvt_pk_bf16_f32 v192, v12, v13
    v_cvt_pk_bf16_f32 v193, v14, v15
    v_cvt_pk_bf16_f32 v194, v16, v17
    v_cvt_pk_bf16_f32 v195, v18, v19
    global_store_dwordx4 v1, v[192:195], s[14:15] sc1
    s_add_u32 s14, s14, 8192
    s_addc_u32 s15, s15, 0
    v_lshlrev_b32 v12, 16, v196
    v_and_b32 v13, s22, v196
    v_lshlrev_b32 v14, 16, v197
    v_and_b32 v15, s22, v197
    v_lshlrev_b32 v16, 16, v198
    v_and_b32 v17, s22, v198
    v_lshlrev_b32 v18, 16, v199
    v_and_b32 v19, s22, v199
    v_pk_fma_f32 v[12:13], v[12:13], v[10:11], v[10:11] op_sel:[0,0,1] op_sel_hi:[1,0,1]
    v_pk_fma_f32 v[14:15], v[14:15], v[10:11], v[10:11] op_sel:[0,0,1] op_sel_hi:[1,0,1]
    v_pk_fma_f32 v[16:17], v[16:17], v[10:11], v[10:11] op_sel:[0,0,1] op_sel_hi:[1,0,1]
    v_pk_fma_f32 v[18:19], v[18:19], v[10:11], v[10:11] op_sel:[0,0,1] op_sel_hi:[1,0,1]
    v_cvt_pk_bf16_f32 v196, v12, v13
    v_cvt_pk_bf16_f32 v197, v14, v15
    v_cvt_pk_bf16_f32 v198, v16, v17
    v_cvt_pk_bf16_f32 v199, v18, v19
    global_store_dwordx4 v1, v[196:199], s[14:15] sc1
    s_add_u32 s14, s14, 8192
    s_addc_u32 s15, s15, 0
    v_lshlrev_b32 v12, 16, v88
    v_and_b32 v13, s22, v88
    v_lshlrev_b32 v14, 16, v89
    v_and_b32 v15, s22, v89
    v_lshlrev_b32 v16, 16, v90
    v_and_b32 v17, s22, v90
    v_lshlrev_b32 v18, 16, v91
    v_and_b32 v19, s22, v91
    v_pk_add_f32 v[12:13], v[12:13], v[20:21] op_sel_hi:[1,0] neg_lo:[0,1] neg_hi:[0,1]
    v_pk_add_f32 v[14:15], v[14:15], v[20:21] op_sel_hi:[1,0] neg_lo:[0,1] neg_hi:[0,1]
    v_pk_add_f32 v[16:17], v[16:17], v[20:21] op_sel_hi:[1,0] neg_lo:[0,1] neg_hi:[0,1]
    v_pk_add_f32 v[18:19], v[18:19], v[20:21] op_sel_hi:[1,0] neg_lo:[0,1] neg_hi:[0,1]
    v_cvt_pk_bf16_f32 v88, v12, v13
    v_cvt_pk_bf16_f32 v89, v14, v15
    v_cvt_pk_bf16_f32 v90, v16, v17
    v_cvt_pk_bf16_f32 v91, v18, v19
    v_dot2c_f32_bf16 v4, v88, v88
    v_dot2c_f32_bf16 v5, v89, v89
    v_dot2c_f32_bf16 v6, v90, v90
    v_dot2c_f32_bf16 v7, v91, v91
    v_lshlrev_b32 v12, 16, v92
    v_and_b32 v13, s22, v92
    v_lshlrev_b32 v14, 16, v93
    v_and_b32 v15, s22, v93
    v_lshlrev_b32 v16, 16, v94
    v_and_b32 v17, s22, v94
    v_lshlrev_b32 v18, 16, v95
    v_and_b32 v19, s22, v95
    v_pk_add_f32 v[12:13], v[12:13], v[20:21] op_sel_hi:[1,0] neg_lo:[0,1] neg_hi:[0,1]
    v_pk_add_f32 v[14:15], v[14:15], v[20:21] op_sel_hi:[1,0] neg_lo:[0,1] neg_hi:[0,1]
    v_pk_add_f32 v[16:17], v[16:17], v[20:21] op_sel_hi:[1,0] neg_lo:[0,1] neg_hi:[0,1]
    v_pk_add_f32 v[18:19], v[18:19], v[20:21] op_sel_hi:[1,0] neg_lo:[0,1] neg_hi:[0,1]
    v_cvt_pk_bf16_f32 v92, v12, v13
    v_cvt_pk_bf16_f32 v93, v14, v15
    v_cvt_pk_bf16_f32 v94, v16, v17
    v_cvt_pk_bf16_f32 v95, v18, v19
    v_dot2c_f32_bf16 v4, v92, v92
    v_dot2c_f32_bf16 v5, v93, v93
    v_dot2c_f32_bf16 v6, v94, v94
    v_dot2c_f32_bf16 v7, v95, v95
    v_lshlrev_b32 v12, 16, v96
    v_and_b32 v13, s22, v96
    v_lshlrev_b32 v14, 16, v97
    v_and_b32 v15, s22, v97
    v_lshlrev_b32 v16, 16, v98
    v_and_b32 v17, s22, v98
    v_lshlrev_b32 v18, 16, v99
    v_and_b32 v19, s22, v99
    v_pk_add_f32 v[12:13], v[12:13], v[20:21] op_sel_hi:[1,0] neg_lo:[0,1] neg_hi:[0,1]
    v_pk_add_f32 v[14:15], v[14:15], v[20:21] op_sel_hi:[1,0] neg_lo:[0,1] neg_hi:[0,1]
    v_pk_add_f32 v[16:17], v[16:17], v[20:21] op_sel_hi:[1,0] neg_lo:[0,1] neg_hi:[0,1]
    v_pk_add_f32 v[18:19], v[18:19], v[20:21] op_sel_hi:[1,0] neg_lo:[0,1] neg_hi:[0,1]
    v_cvt_pk_bf16_f32 v96, v12, v13
    v_cvt_pk_bf16_f32 v97, v14, v15
    v_cvt_pk_bf16_f32 v98, v16, v17
    v_cvt_pk_bf16_f32 v99, v18, v19
    v_dot2c_f32_bf16 v4, v96, v96
    v_dot2c_f32_bf16 v5, v97, v97
    v_dot2c_f32_bf16 v6, v98, v98
    v_dot2c_f32_bf16 v7, v99, v99
    v_lshlrev_b32 v12, 16, v100
    v_and_b32 v13, s22, v100
    v_lshlrev_b32 v14, 16, v101
    v_and_b32 v15, s22, v101
    v_lshlrev_b32 v16, 16, v102
    v_and_b32 v17, s22, v102
    v_lshlrev_b32 v18, 16, v103
    v_and_b32 v19, s22, v103
    v_pk_add_f32 v[12:13], v[12:13], v[20:21] op_sel_hi:[1,0] neg_lo:[0,1] neg_hi:[0,1]
    v_pk_add_f32 v[14:15], v[14:15], v[20:21] op_sel_hi:[1,0] neg_lo:[0,1] neg_hi:[0,1]
    v_pk_add_f32 v[16:17], v[16:17], v[20:21] op_sel_hi:[1,0] neg_lo:[0,1] neg_hi:[0,1]
    v_pk_add_f32 v[18:19], v[18:19], v[20:21] op_sel_hi:[1,0] neg_lo:[0,1] neg_hi:[0,1]
    v_cvt_pk_bf16_f32 v100, v12, v13
    v_cvt_pk_bf16_f32 v101, v14, v15
    v_cvt_pk_bf16_f32 v102, v16, v17
    v_cvt_pk_bf16_f32 v103, v18, v19
    v_dot2c_f32_bf16 v4, v100, v100
    v_dot2c_f32_bf16 v5, v101, v101
    v_dot2c_f32_bf16 v6, v102, v102
    v_dot2c_f32_bf16 v7, v103, v103
    s_nop 2
    v_add_f32 v4, v4, v5
    v_add_f32 v6, v6, v7
    v_add_f32 v4, v4, v6
    s_nop 1
    v_add_f32_dpp v5, v4, v4 row_ror:8 row_mask:0xf bank_mask:0xf
    s_nop 1
    v_add_f32_dpp v4, v5, v5 row_ror:4 row_mask:0xf bank_mask:0xf
    s_nop 1
    v_add_f32_dpp v5, v4, v4 row_ror:2 row_mask:0xf bank_mask:0xf
    s_nop 1
    v_add_f32_dpp v4, v5, v5 row_ror:1 row_mask:0xf bank_mask:0xf
    ds_write_b32 v2, v4 offset:512
    v_lshlrev_b32 v12, 16, v200
    v_and_b32 v13, s22, v200
    v_lshlrev_b32 v14, 16, v201
    v_and_b32 v15, s22, v201
    v_lshlrev_b32 v16, 16, v202
    v_and_b32 v17, s22, v202
    v_lshlrev_b32 v18, 16, v203
    v_and_b32 v19, s22, v203
    v_pk_fma_f32 v[12:13], v[12:13], v[10:11], v[10:11] op_sel:[0,0,1] op_sel_hi:[1,0,1]
    v_pk_fma_f32 v[14:15], v[14:15], v[10:11], v[10:11] op_sel:[0,0,1] op_sel_hi:[1,0,1]
    v_pk_fma_f32 v[16:17], v[16:17], v[10:11], v[10:11] op_sel:[0,0,1] op_sel_hi:[1,0,1]
    v_pk_fma_f32 v[18:19], v[18:19], v[10:11], v[10:11] op_sel:[0,0,1] op_sel_hi:[1,0,1]
    v_cvt_pk_bf16_f32 v200, v12, v13
    v_cvt_pk_bf16_f32 v201, v14, v15
    v_cvt_pk_bf16_f32 v202, v16, v17
    v_cvt_pk_bf16_f32 v203, v18, v19
    global_store_dwordx4 v1, v[200:203], s[14:15] sc1
    s_add_u32 s14, s14, 8192
    s_addc_u32 s15, s15, 0
    v_lshlrev_b32 v12, 16, v204
    v_and_b32 v13, s22, v204
    v_lshlrev_b32 v14, 16, v205
    v_and_b32 v15, s22, v205
    v_lshlrev_b32 v16, 16, v206
    v_and_b32 v17, s22, v206
    v_lshlrev_b32 v18, 16, v207
    v_and_b32 v19, s22, v207
    v_pk_fma_f32 v[12:13], v[12:13], v[10:11], v[10:11] op_sel:[0,0,1] op_sel_hi:[1,0,1]
    v_pk_fma_f32 v[14:15], v[14:15], v[10:11], v[10:11] op_sel:[0,0,1] op_sel_hi:[1,0,1]
    v_pk_fma_f32 v[16:17], v[16:17], v[10:11], v[10:11] op_sel:[0,0,1] op_sel_hi:[1,0,1]
    v_pk_fma_f32 v[18:19], v[18:19], v[10:11], v[10:11] op_sel:[0,0,1] op_sel_hi:[1,0,1]
    v_cvt_pk_bf16_f32 v204, v12, v13
    v_cvt_pk_bf16_f32 v205, v14, v15
    v_cvt_pk_bf16_f32 v206, v16, v17
    v_cvt_pk_bf16_f32 v207, v18, v19
    global_store_dwordx4 v1, v[204:207], s[14:15] sc1
    s_add_u32 s14, s14, 8192
    s_addc_u32 s15, s15, 0
    s_waitcnt lgkmcnt(0)
    s_barrier
    ds_read_b64 v[4:5], v3 offset:512
    s_waitcnt lgkmcnt(0)
    v_add_f32 v4, v4, v5
    s_nop 1
    v_add_f32_dpp v5, v4, v4 row_ror:8 row_mask:0xf bank_mask:0xf
    s_nop 1
    v_add_f32_dpp v4, v5, v5 row_ror:4 row_mask:0xf bank_mask:0xf
    s_nop 1
    v_add_f32_dpp v5, v4, v4 row_ror:2 row_mask:0xf bank_mask:0xf
    s_nop 1
    v_add_f32_dpp v4, v5, v5 row_ror:1 row_mask:0xf bank_mask:0xf
    v_mul_f32 v4, 0x37800000, v4
    v_cvt_pk_bf16_f32 v4, v4, v4
    v_lshlrev_b32 v4, 16, v4
    v_add_f32 v4, 0x3727c5ac, v4
    v_cvt_pk_bf16_f32 v4, v4, v4
    v_lshlrev_b32 v4, 16, v4
    v_sqrt_f32 v4, v4
    s_nop 0
    v_cvt_pk_bf16_f32 v4, v4, v4
    v_lshlrev_b32 v4, 16, v4
    v_rcp_f32 v8, v4
    s_lshl_b32 s32, s64, 16
    s_and_b32 s33, s64, 0xffff0000
    s_lshl_b32 s34, s65, 16
    s_and_b32 s35, s65, 0xffff0000
    s_bitcmp1_b32 s57, 0
    s_cselect_b32 s32, s33, s32
    s_cselect_b32 s34, s35, s34
    v_mul_f32 v8, s32, v8
    v_mov_b32 v9, s34
    v_lshlrev_b32 v12, 16, v208
    v_and_b32 v13, s22, v208
    v_lshlrev_b32 v14, 16, v209
    v_and_b32 v15, s22, v209
    v_lshlrev_b32 v16, 16, v210
    v_and_b32 v17, s22, v210
    v_lshlrev_b32 v18, 16, v211
    v_and_b32 v19, s22, v211
    v_pk_fma_f32 v[12:13], v[12:13], v[10:11], v[10:11] op_sel:[0,0,1] op_sel_hi:[1,0,1]
    v_pk_fma_f32 v[14:15], v[14:15], v[10:11], v[10:11] op_sel:[0,0,1] op_sel_hi:[1,0,1]
    v_pk_fma_f32 v[16:17], v[16:17], v[10:11], v[10:11] op_sel:[0,0,1] op_sel_hi:[1,0,1]
    v_pk_fma_f32 v[18:19], v[18:19], v[10:11], v[10:11] op_sel:[0,0,1] op_sel_hi:[1,0,1]
    v_cvt_pk_bf16_f32 v208, v12, v13
    v_cvt_pk_bf16_f32 v209, v14, v15
    v_cvt_pk_bf16_f32 v210, v16, v17
    v_cvt_pk_bf16_f32 v211, v18, v19
    global_store_dwordx4 v1, v[208:211], s[14:15] sc1
    s_add_u32 s14, s14, 8192
    s_addc_u32 s15, s15, 0
    s_waitcnt vmcnt(21)
    s_mov_b32 s28, 65536
L_chk1:
    v_cmp_ne_u32 vcc, s18, v25
    v_cmp_ne_u32 s[30:31], s19, v27
    s_or_b64 s[30:31], vcc, s[30:31]
    s_cmp_eq_u64 s[30:31], 0
    s_cbranch_scc1 L_ready1
    s_sleep 4
    global_load_dwordx4 v[24:27], v30, s[70:71] sc0 sc1
    s_waitcnt vmcnt(0)
    s_sub_u32 s28, s28, 1
    s_cmp_lg_u32 s28, 0
    s_cbranch_scc1 L_chk1
    v_and_b32 v33, 63, v0
    v_lshlrev_b32 v33, 4, v33
    v_mov_b32 v4, 0
    v_mov_b32 v5, 0
    v_mov_b32 v6, 0
    v_mov_b32 v7, 0
    s_add_u32 s38, s49, 0
    s_add_u32 s38, s4, s38
    s_addc_u32 s39, s5, 0
    s_mov_b32 s28, 32
L_fb1_1:
    global_load_dwordx4 v[24:27], v33, s[38:39]
    s_add_u32 s38, s38, 1024
    s_addc_u32 s39, s39, 0
    s_waitcnt vmcnt(0)
    v_dot2c_f32_bf16 v4, s21, v24
    v_dot2c_f32_bf16 v5, s21, v25
    v_dot2c_f32_bf16 v6, s21, v26
    v_dot2c_f32_bf16 v7, s21, v27
    s_sub_u32 s28, s28, 1
    s_cmp_lg_u32 s28, 0
    s_cbranch_scc1 L_fb1_1
    s_nop 2
    v_add_f32 v4, v4, v5
    v_add_f32 v6, v6, v7
    v_add_f32 v34, v4, v6
    s_nop 1
    v_add_f32_dpp v5, v34, v34 row_ror:8 row_mask:0xf bank_mask:0xf
    s_nop 1
    v_add_f32_dpp v34, v5, v5 row_ror:4 row_mask:0xf bank_mask:0xf
    s_nop 1
    v_add_f32_dpp v5, v34, v34 row_ror:2 row_mask:0xf bank_mask:0xf
    s_nop 1
    v_add_f32_dpp v34, v5, v5 row_ror:1 row_mask:0xf bank_mask:0xf
    v_mov_b32 v5, v34
    s_nop 1
    v_permlane16_swap_b32 v34, v5
    v_add_f32 v34, v34, v5
    v_mov_b32 v5, v34
    s_nop 1
    v_permlane32_swap_b32 v34, v5
    v_add_f32 v34, v34, v5
    v_mul_f32 v32, 0x38800000, v34
    v_mov_b32 v4, 0
    v_mov_b32 v5, 0
    v_mov_b32 v6, 0
    v_mov_b32 v7, 0
    s_add_u32 s38, s49, 0
    s_add_u32 s38, s4, s38
    s_addc_u32 s39, s5, 0
    s_mov_b32 s28, 32
L_fb2_1:
    global_load_dwordx4 v[24:27], v33, s[38:39]
    s_add_u32 s38, s38, 1024
    s_addc_u32 s39, s39, 0
    s_waitcnt vmcnt(0)
    v_lshlrev_b32 v12, 16, v24
    v_and_b32 v13, s22, v24
    v_lshlrev_b32 v14, 16, v25
    v_and_b32 v15, s22, v25
    v_lshlrev_b32 v16, 16, v26
    v_and_b32 v17, s22, v26
    v_lshlrev_b32 v18, 16, v27
    v_and_b32 v19, s22, v27
    v_pk_add_f32 v[12:13], v[12:13], v[32:33] op_sel_hi:[1,0] neg_lo:[0,1] neg_hi:[0,1]
    v_pk_add_f32 v[14:15], v[14:15], v[32:33] op_sel_hi:[1,0] neg_lo:[0,1] neg_hi:[0,1]
    v_pk_add_f32 v[16:17], v[16:17], v[32:33] op_sel_hi:[1,0] neg_lo:[0,1] neg_hi:[0,1]
    v_pk_add_f32 v[18:19], v[18:19], v[32:33] op_sel_hi:[1,0] neg_lo:[0,1] neg_hi:[0,1]
    v_pk_fma_f32 v[4:5], v[12:13], v[12:13], v[4:5]
    v_pk_fma_f32 v[6:7], v[14:15], v[14:15], v[6:7]
    v_pk_fma_f32 v[4:5], v[16:17], v[16:17], v[4:5]
    v_pk_fma_f32 v[6:7], v[18:19], v[18:19], v[6:7]
    s_sub_u32 s28, s28, 1
    s_cmp_lg_u32 s28, 0
    s_cbranch_scc1 L_fb2_1
    v_add_f32 v4, v4, v5
    v_add_f32 v6, v6, v7
    v_add_f32 v26, v4, v6
    s_nop 1
    v_add_f32_dpp v5, v26, v26 row_ror:8 row_mask:0xf bank_mask:0xf
    s_nop 1
    v_add_f32_dpp v26, v5, v5 row_ror:4 row_mask:0xf bank_mask:0xf
    s_nop 1
    v_add_f32_dpp v5, v26, v26 row_ror:2 row_mask:0xf bank_mask:0xf
    s_nop 1
    v_add_f32_dpp v26, v5, v5 row_ror:1 row_mask:0xf bank_mask:0xf
    v_mov_b32 v5, v26
    s_nop 1
    v_permlane16_swap_b32 v26, v5
    v_add_f32 v26, v26, v5
    v_mov_b32 v5, v26
    s_nop 1
    v_permlane32_swap_b32 v26, v5
    v_add_f32 v26, v26, v5
    v_mov_b32 v24, v34
L_ready1:
    s_cmp_lg_u32 s3, 0
    s_cbranch_scc1 L_nobump1
    v_mov_b32 v16, s26
    v_mov_b32 v18, s24
    v_mov_b32 v19, s25
    s_mov_b64 exec, 1
    global_store_dwordx2 v16, v[18:19], s[70:71] sc0 sc1
    s_mov_b64 exec, -1
L_nobump1:
    v_add_f32 v12, v24, v28
    v_mul_f32 v12, 0x37800000, v12
    v_mul_f32 v13, 0x38800000, v24
    v_mul_f32 v14, 0x37aaaaab, v28
    v_sub_f32 v13, v13, v12
    v_sub_f32 v14, v14, v12
    v_mul_f32 v13, v13, v13
    v_mul_f32 v14, v14, v14
    v_mov_b32 v15, 0x46800000
    v_fma_f32 v13, v13, v15, v26
    v_mov_b32 v15, 0x47400000
    v_fma_f32 v14, v14, v15, v29
    v_add_f32 v13, v13, v14
    v_cvt_pk_bf16_f32 v32, v12, v12
    v_lshlrev_b32 v32, 16, v32
    v_sub_f32 v12, v12, v32
    v_mul_f32 v12, v12, v12
    v_mov_b32 v15, 0x37800000
    v_fma_f32 v4, v13, v15, v12
    v_cvt_pk_bf16_f32 v4, v4, v4
    v_lshlrev_b32 v4, 16, v4
    v_add_f32 v4, 0x3727c5ac, v4
    v_cvt_pk_bf16_f32 v4, v4, v4
    v_lshlrev_b32 v4, 16, v4
    v_sqrt_f32 v4, v4
    s_nop 0
    v_cvt_pk_bf16_f32 v4, v4, v4
    v_lshlrev_b32 v4, 16, v4
    v_rcp_f32 v34, v4
    s_lshl_b32 s32, s68, 16
    s_and_b32 s33, s68, 0xffff0000
    s_lshl_b32 s34, s69, 16
    s_and_b32 s35, s69, 0xffff0000
    s_bitcmp1_b32 s59, 0
    s_cselect_b32 s32, s33, s32
    s_cselect_b32 s34, s35, s34
    v_mul_f32 v34, s32, v34
    v_mov_b32 v35, s34
    s_add_u32 s14, s49, 32768
    s_add_u32 s14, s10, s14
    s_addc_u32 s15, s11, 0
    v_lshlrev_b32 v12, 16, v36
    v_and_b32 v13, s22, v36
    v_lshlrev_b32 v14, 16, v37
    v_and_b32 v15, s22, v37
    v_lshlrev_b32 v16, 16, v38
    v_and_b32 v17, s22, v38
    v_lshlrev_b32 v18, 16, v39
    v_and_b32 v19, s22, v39
    v_pk_add_f32 v[12:13], v[12:13], v[32:33] op_sel_hi:[1,0] neg_lo:[0,1] neg_hi:[0,1]
    v_pk_add_f32 v[14:15], v[14:15], v[32:33] op_sel_hi:[1,0] neg_lo:[0,1] neg_hi:[0,1]
    v_pk_add_f32 v[16:17], v[16:17], v[32:33] op_sel_hi:[1,0] neg_lo:[0,1] neg_hi:[0,1]
    v_pk_add_f32 v[18:19], v[18:19], v[32:33] op_sel_hi:[1,0] neg_lo:[0,1] neg_hi:[0,1]
    v_cvt_pk_bf16_f32 v36, v12, v13
    v_cvt_pk_bf16_f32 v37, v14, v15
    v_cvt_pk_bf16_f32 v38, v16, v17
    v_cvt_pk_bf16_f32 v39, v18, v19
    v_lshlrev_b32 v12, 16, v36
    v_and_b32 v13, s22, v36
    v_lshlrev_b32 v14, 16, v37
    v_and_b32 v15, s22, v37
    v_lshlrev_b32 v16, 16, v38
    v_and_b32 v17, s22, v38
    v_lshlrev_b32 v18, 16, v39
    v_and_b32 v19, s22, v39
    v_pk_fma_f32 v[12:13], v[12:13], v[34:35], v[34:35] op_sel:[0,0,1] op_sel_hi:[1,0,1]
    v_pk_fma_f32 v[14:15], v[14:15], v[34:35], v[34:35] op_sel:[0,0,1] op_sel_hi:[1,0,1]
    v_pk_fma_f32 v[16:17], v[16:17], v[34:35], v[34:35] op_sel:[0,0,1] op_sel_hi:[1,0,1]
    v_pk_fma_f32 v[18:19], v[18:19], v[34:35], v[34:35] op_sel:[0,0,1] op_sel_hi:[1,0,1]
    v_cvt_pk_bf16_f32 v36, v12, v13
    v_cvt_pk_bf16_f32 v37, v14, v15
    v_cvt_pk_bf16_f32 v38, v16, v17
    v_cvt_pk_bf16_f32 v39, v18, v19
    global_store_dwordx4 v1, v[36:39], s[14:15] sc1
    s_add_u32 s14, s14, 8192
    s_addc_u32 s15, s15, 0
    v_lshlrev_b32 v12, 16, v40
    v_and_b32 v13, s22, v40
    v_lshlrev_b32 v14, 16, v41
    v_and_b32 v15, s22, v41
    v_lshlrev_b32 v16, 16, v42
    v_and_b32 v17, s22, v42
    v_lshlrev_b32 v18, 16, v43
    v_and_b32 v19, s22, v43
    v_pk_add_f32 v[12:13], v[12:13], v[32:33] op_sel_hi:[1,0] neg_lo:[0,1] neg_hi:[0,1]
    v_pk_add_f32 v[14:15], v[14:15], v[32:33] op_sel_hi:[1,0] neg_lo:[0,1] neg_hi:[0,1]
    v_pk_add_f32 v[16:17], v[16:17], v[32:33] op_sel_hi:[1,0] neg_lo:[0,1] neg_hi:[0,1]
    v_pk_add_f32 v[18:19], v[18:19], v[32:33] op_sel_hi:[1,0] neg_lo:[0,1] neg_hi:[0,1]
    v_cvt_pk_bf16_f32 v40, v12, v13
    v_cvt_pk_bf16_f32 v41, v14, v15
    v_cvt_pk_bf16_f32 v42, v16, v17
    v_cvt_pk_bf16_f32 v43, v18, v19
    v_lshlrev_b32 v12, 16, v40
    v_and_b32 v13, s22, v40
    v_lshlrev_b32 v14, 16, v41
    v_and_b32 v15, s22, v41
    v_lshlrev_b32 v16, 16, v42
    v_and_b32 v17, s22, v42
    v_lshlrev_b32 v18, 16, v43
    v_and_b32 v19, s22, v43
    v_pk_fma_f32 v[12:13], v[12:13], v[34:35], v[34:35] op_sel:[0,0,1] op_sel_hi:[1,0,1]
    v_pk_fma_f32 v[14:15], v[14:15], v[34:35], v[34:35] op_sel:[0,0,1] op_sel_hi:[1,0,1]
    v_pk_fma_f32 v[16:17], v[16:17], v[34:35], v[34:35] op_sel:[0,0,1] op_sel_hi:[1,0,1]
    v_pk_fma_f32 v[18:19], v[18:19], v[34:35], v[34:35] op_sel:[0,0,1] op_sel_hi:[1,0,1]
    v_cvt_pk_bf16_f32 v40, v12, v13
    v_cvt_pk_bf16_f32 v41, v14, v15
    v_cvt_pk_bf16_f32 v42, v16, v17
    v_cvt_pk_bf16_f32 v43, v18, v19
    global_store_dwordx4 v1, v[40:43], s[14:15] sc1
    s_add_u32 s14, s14, 8192
    s_addc_u32 s15, s15, 0
    v_lshlrev_b32 v12, 16, v44
    v_and_b32 v13, s22, v44
    v_lshlrev_b32 v14, 16, v45
    v_and_b32 v15, s22, v45
    v_lshlrev_b32 v16, 16, v46
    v_and_b32 v17, s22, v46
    v_lshlrev_b32 v18, 16, v47
    v_and_b32 v19, s22, v47
    v_pk_add_f32 v[12:13], v[12:13], v[32:33] op_sel_hi:[1,0] neg_lo:[0,1] neg_hi:[0,1]
    v_pk_add_f32 v[14:15], v[14:15], v[32:33] op_sel_hi:[1,0] neg_lo:[0,1] neg_hi:[0,1]
    v_pk_add_f32 v[16:17], v[16:17], v[32:33] op_sel_hi:[1,0] neg_lo:[0,1] neg_hi:[0,1]
    v_pk_add_f32 v[18:19], v[18:19], v[32:33] op_sel_hi:[1,0] neg_lo:[0,1] neg_hi:[0,1]
    v_cvt_pk_bf16_f32 v44, v12, v13
    v_cvt_pk_bf16_f32 v45, v14, v15
    v_cvt_pk_bf16_f32 v46, v16, v17
    v_cvt_pk_bf16_f32 v47, v18, v19
    v_lshlrev_b32 v12, 16, v44
    v_and_b32 v13, s22, v44
    v_lshlrev_b32 v14, 16, v45
    v_and_b32 v15, s22, v45
    v_lshlrev_b32 v16, 16, v46
    v_and_b32 v17, s22, v46
    v_lshlrev_b32 v18, 16, v47
    v_and_b32 v19, s22, v47
    v_pk_fma_f32 v[12:13], v[12:13], v[34:35], v[34:35] op_sel:[0,0,1] op_sel_hi:[1,0,1]
    v_pk_fma_f32 v[14:15], v[14:15], v[34:35], v[34:35] op_sel:[0,0,1] op_sel_hi:[1,0,1]
    v_pk_fma_f32 v[16:17], v[16:17], v[34:35], v[34:35] op_sel:[0,0,1] op_sel_hi:[1,0,1]
    v_pk_fma_f32 v[18:19], v[18:19], v[34:35], v[34:35] op_sel:[0,0,1] op_sel_hi:[1,0,1]
    v_cvt_pk_bf16_f32 v44, v12, v13
    v_cvt_pk_bf16_f32 v45, v14, v15
    v_cvt_pk_bf16_f32 v46, v16, v17
    v_cvt_pk_bf16_f32 v47, v18, v19
    global_store_dwordx4 v1, v[44:47], s[14:15] sc1
    s_add_u32 s14, s14, 8192
    s_addc_u32 s15, s15, 0
    v_lshlrev_b32 v12, 16, v48
    v_and_b32 v13, s22, v48
    v_lshlrev_b32 v14, 16, v49
    v_and_b32 v15, s22, v49
    v_lshlrev_b32 v16, 16, v50
    v_and_b32 v17, s22, v50
    v_lshlrev_b32 v18, 16, v51
    v_and_b32 v19, s22, v51
    v_pk_add_f32 v[12:13], v[12:13], v[32:33] op_sel_hi:[1,0] neg_lo:[0,1] neg_hi:[0,1]
    v_pk_add_f32 v[14:15], v[14:15], v[32:33] op_sel_hi:[1,0] neg_lo:[0,1] neg_hi:[0,1]
    v_pk_add_f32 v[16:17], v[16:17], v[32:33] op_sel_hi:[1,0] neg_lo:[0,1] neg_hi:[0,1]
    v_pk_add_f32 v[18:19], v[18:19], v[32:33] op_sel_hi:[1,0] neg_lo:[0,1] neg_hi:[0,1]
    v_cvt_pk_bf16_f32 v48, v12, v13
    v_cvt_pk_bf16_f32 v49, v14, v15
    v_cvt_pk_bf16_f32 v50, v16, v17
    v_cvt_pk_bf16_f32 v51, v18, v19
    v_lshlrev_b32 v12, 16, v48
    v_and_b32 v13, s22, v48
    v_lshlrev_b32 v14, 16, v49
    v_and_b32 v15, s22, v49
    v_lshlrev_b32 v16, 16, v50
    v_and_b32 v17, s22, v50
    v_lshlrev_b32 v18, 16, v51
    v_and_b32 v19, s22, v51
    v_pk_fma_f32 v[12:13], v[12:13], v[34:35], v[34:35] op_sel:[0,0,1] op_sel_hi:[1,0,1]
    v_pk_fma_f32 v[14:15], v[14:15], v[34:35], v[34:35] op_sel:[0,0,1] op_sel_hi:[1,0,1]
    v_pk_fma_f32 v[16:17], v[16:17], v[34:35], v[34:35] op_sel:[0,0,1] op_sel_hi:[1,0,1]
    v_pk_fma_f32 v[18:19], v[18:19], v[34:35], v[34:35] op_sel:[0,0,1] op_sel_hi:[1,0,1]
    v_cvt_pk_bf16_f32 v48, v12, v13
    v_cvt_pk_bf16_f32 v49, v14, v15
    v_cvt_pk_bf16_f32 v50, v16, v17
    v_cvt_pk_bf16_f32 v51, v18, v19
    global_store_dwordx4 v1, v[48:51], s[14:15] sc1
    s_add_u32 s14, s14, 8192
    s_addc_u32 s15, s15, 0
    v_lshlrev_b32 v12, 16, v52
    v_and_b32 v13, s22, v52
    v_lshlrev_b32 v14, 16, v53
    v_and_b32 v15, s22, v53
    v_lshlrev_b32 v16, 16, v54
    v_and_b32 v17, s22, v54
    v_lshlrev_b32 v18, 16, v55
    v_and_b32 v19, s22, v55
    v_pk_add_f32 v[12:13], v[12:13], v[32:33] op_sel_hi:[1,0] neg_lo:[0,1] neg_hi:[0,1]
    v_pk_add_f32 v[14:15], v[14:15], v[32:33] op_sel_hi:[1,0] neg_lo:[0,1] neg_hi:[0,1]
    v_pk_add_f32 v[16:17], v[16:17], v[32:33] op_sel_hi:[1,0] neg_lo:[0,1] neg_hi:[0,1]
    v_pk_add_f32 v[18:19], v[18:19], v[32:33] op_sel_hi:[1,0] neg_lo:[0,1] neg_hi:[0,1]
    v_cvt_pk_bf16_f32 v52, v12, v13
    v_cvt_pk_bf16_f32 v53, v14, v15
    v_cvt_pk_bf16_f32 v54, v16, v17
    v_cvt_pk_bf16_f32 v55, v18, v19
    v_lshlrev_b32 v12, 16, v52
    v_and_b32 v13, s22, v52
    v_lshlrev_b32 v14, 16, v53
    v_and_b32 v15, s22, v53
    v_lshlrev_b32 v16, 16, v54
    v_and_b32 v17, s22, v54
    v_lshlrev_b32 v18, 16, v55
    v_and_b32 v19, s22, v55
    v_pk_fma_f32 v[12:13], v[12:13], v[34:35], v[34:35] op_sel:[0,0,1] op_sel_hi:[1,0,1]
    v_pk_fma_f32 v[14:15], v[14:15], v[34:35], v[34:35] op_sel:[0,0,1] op_sel_hi:[1,0,1]
    v_pk_fma_f32 v[16:17], v[16:17], v[34:35], v[34:35] op_sel:[0,0,1] op_sel_hi:[1,0,1]
    v_pk_fma_f32 v[18:19], v[18:19], v[34:35], v[34:35] op_sel:[0,0,1] op_sel_hi:[1,0,1]
    v_cvt_pk_bf16_f32 v52, v12, v13
    v_cvt_pk_bf16_f32 v53, v14, v15
    v_cvt_pk_bf16_f32 v54, v16, v17
    v_cvt_pk_bf16_f32 v55, v18, v19
    global_store_dwordx4 v1, v[52:55], s[14:15] sc1
    s_add_u32 s14, s14, 8192
    s_addc_u32 s15, s15, 0
    v_lshlrev_b32 v12, 16, v56
    v_and_b32 v13, s22, v56
    v_lshlrev_b32 v14, 16, v57
    v_and_b32 v15, s22, v57
    v_lshlrev_b32 v16, 16, v58
    v_and_b32 v17, s22, v58
    v_lshlrev_b32 v18, 16, v59
    v_and_b32 v19, s22, v59
    v_pk_add_f32 v[12:13], v[12:13], v[32:33] op_sel_hi:[1,0] neg_lo:[0,1] neg_hi:[0,1]
    v_pk_add_f32 v[14:15], v[14:15], v[32:33] op_sel_hi:[1,0] neg_lo:[0,1] neg_hi:[0,1]
    v_pk_add_f32 v[16:17], v[16:17], v[32:33] op_sel_hi:[1,0] neg_lo:[0,1] neg_hi:[0,1]
    v_pk_add_f32 v[18:19], v[18:19], v[32:33] op_sel_hi:[1,0] neg_lo:[0,1] neg_hi:[0,1]
    v_cvt_pk_bf16_f32 v56, v12, v13
    v_cvt_pk_bf16_f32 v57, v14, v15
    v_cvt_pk_bf16_f32 v58, v16, v17
    v_cvt_pk_bf16_f32 v59, v18, v19
    v_lshlrev_b32 v12, 16, v56
    v_and_b32 v13, s22, v56
    v_lshlrev_b32 v14, 16, v57
    v_and_b32 v15, s22, v57
    v_lshlrev_b32 v16, 16, v58
    v_and_b32 v17, s22, v58
    v_lshlrev_b32 v18, 16, v59
    v_and_b32 v19, s22, v59
    v_pk_fma_f32 v[12:13], v[12:13], v[34:35], v[34:35] op_sel:[0,0,1] op_sel_hi:[1,0,1]
    v_pk_fma_f32 v[14:15], v[14:15], v[34:35], v[34:35] op_sel:[0,0,1] op_sel_hi:[1,0,1]
    v_pk_fma_f32 v[16:17], v[16:17], v[34:35], v[34:35] op_sel:[0,0,1] op_sel_hi:[1,0,1]
    v_pk_fma_f32 v[18:19], v[18:19], v[34:35], v[34:35] op_sel:[0,0,1] op_sel_hi:[1,0,1]
    v_cvt_pk_bf16_f32 v56, v12, v13
    v_cvt_pk_bf16_f32 v57, v14, v15
    v_cvt_pk_bf16_f32 v58, v16, v17
    v_cvt_pk_bf16_f32 v59, v18, v19
    global_store_dwordx4 v1, v[56:59], s[14:15] sc1
    s_add_u32 s14, s14, 8192
    s_addc_u32 s15, s15, 0
    v_lshlrev_b32 v12, 16, v60
    v_and_b32 v13, s22, v60
    v_lshlrev_b32 v14, 16, v61
    v_and_b32 v15, s22, v61
    v_lshlrev_b32 v16, 16, v62
    v_and_b32 v17, s22, v62
    v_lshlrev_b32 v18, 16, v63
    v_and_b32 v19, s22, v63
    v_pk_add_f32 v[12:13], v[12:13], v[32:33] op_sel_hi:[1,0] neg_lo:[0,1] neg_hi:[0,1]
    v_pk_add_f32 v[14:15], v[14:15], v[32:33] op_sel_hi:[1,0] neg_lo:[0,1] neg_hi:[0,1]
    v_pk_add_f32 v[16:17], v[16:17], v[32:33] op_sel_hi:[1,0] neg_lo:[0,1] neg_hi:[0,1]
    v_pk_add_f32 v[18:19], v[18:19], v[32:33] op_sel_hi:[1,0] neg_lo:[0,1] neg_hi:[0,1]
    v_cvt_pk_bf16_f32 v60, v12, v13
    v_cvt_pk_bf16_f32 v61, v14, v15
    v_cvt_pk_bf16_f32 v62, v16, v17
    v_cvt_pk_bf16_f32 v63, v18, v19
    v_lshlrev_b32 v12, 16, v60
    v_and_b32 v13, s22, v60
    v_lshlrev_b32 v14, 16, v61
    v_and_b32 v15, s22, v61
    v_lshlrev_b32 v16, 16, v62
    v_and_b32 v17, s22, v62
    v_lshlrev_b32 v18, 16, v63
    v_and_b32 v19, s22, v63
    v_pk_fma_f32 v[12:13], v[12:13], v[34:35], v[34:35] op_sel:[0,0,1] op_sel_hi:[1,0,1]
    v_pk_fma_f32 v[14:15], v[14:15], v[34:35], v[34:35] op_sel:[0,0,1] op_sel_hi:[1,0,1]
    v_pk_fma_f32 v[16:17], v[16:17], v[34:35], v[34:35] op_sel:[0,0,1] op_sel_hi:[1,0,1]
    v_pk_fma_f32 v[18:19], v[18:19], v[34:35], v[34:35] op_sel:[0,0,1] op_sel_hi:[1,0,1]
    v_cvt_pk_bf16_f32 v60, v12, v13
    v_cvt_pk_bf16_f32 v61, v14, v15
    v_cvt_pk_bf16_f32 v62, v16, v17
    v_cvt_pk_bf16_f32 v63, v18, v19
    global_store_dwordx4 v1, v[60:63], s[14:15] sc1
    s_add_u32 s14, s14, 8192
    s_addc_u32 s15, s15, 0
    v_lshlrev_b32 v12, 16, v64
    v_and_b32 v13, s22, v64
    v_lshlrev_b32 v14, 16, v65
    v_and_b32 v15, s22, v65
    v_lshlrev_b32 v16, 16, v66
    v_and_b32 v17, s22, v66
    v_lshlrev_b32 v18, 16, v67
    v_and_b32 v19, s22, v67
    v_pk_add_f32 v[12:13], v[12:13], v[32:33] op_sel_hi:[1,0] neg_lo:[0,1] neg_hi:[0,1]
    v_pk_add_f32 v[14:15], v[14:15], v[32:33] op_sel_hi:[1,0] neg_lo:[0,1] neg_hi:[0,1]
    v_pk_add_f32 v[16:17], v[16:17], v[32:33] op_sel_hi:[1,0] neg_lo:[0,1] neg_hi:[0,1]
    v_pk_add_f32 v[18:19], v[18:19], v[32:33] op_sel_hi:[1,0] neg_lo:[0,1] neg_hi:[0,1]
    v_cvt_pk_bf16_f32 v64, v12, v13
    v_cvt_pk_bf16_f32 v65, v14, v15
    v_cvt_pk_bf16_f32 v66, v16, v17
    v_cvt_pk_bf16_f32 v67, v18, v19
    v_lshlrev_b32 v12, 16, v64
    v_and_b32 v13, s22, v64
    v_lshlrev_b32 v14, 16, v65
    v_and_b32 v15, s22, v65
    v_lshlrev_b32 v16, 16, v66
    v_and_b32 v17, s22, v66
    v_lshlrev_b32 v18, 16, v67
    v_and_b32 v19, s22, v67
    v_pk_fma_f32 v[12:13], v[12:13], v[34:35], v[34:35] op_sel:[0,0,1] op_sel_hi:[1,0,1]
    v_pk_fma_f32 v[14:15], v[14:15], v[34:35], v[34:35] op_sel:[0,0,1] op_sel_hi:[1,0,1]
    v_pk_fma_f32 v[16:17], v[16:17], v[34:35], v[34:35] op_sel:[0,0,1] op_sel_hi:[1,0,1]
    v_pk_fma_f32 v[18:19], v[18:19], v[34:35], v[34:35] op_sel:[0,0,1] op_sel_hi:[1,0,1]
    v_cvt_pk_bf16_f32 v64, v12, v13
    v_cvt_pk_bf16_f32 v65, v14, v15
    v_cvt_pk_bf16_f32 v66, v16, v17
    v_cvt_pk_bf16_f32 v67, v18, v19
    global_store_dwordx4 v1, v[64:67], s[14:15] sc1
    s_add_u32 s14, s14, 8192
    s_addc_u32 s15, s15, 0
    v_lshlrev_b32 v12, 16, v68
    v_and_b32 v13, s22, v68
    v_lshlrev_b32 v14, 16, v69
    v_and_b32 v15, s22, v69
    v_lshlrev_b32 v16, 16, v70
    v_and_b32 v17, s22, v70
    v_lshlrev_b32 v18, 16, v71
    v_and_b32 v19, s22, v71
    v_pk_add_f32 v[12:13], v[12:13], v[32:33] op_sel_hi:[1,0] neg_lo:[0,1] neg_hi:[0,1]
    v_pk_add_f32 v[14:15], v[14:15], v[32:33] op_sel_hi:[1,0] neg_lo:[0,1] neg_hi:[0,1]
    v_pk_add_f32 v[16:17], v[16:17], v[32:33] op_sel_hi:[1,0] neg_lo:[0,1] neg_hi:[0,1]
    v_pk_add_f32 v[18:19], v[18:19], v[32:33] op_sel_hi:[1,0] neg_lo:[0,1] neg_hi:[0,1]
    v_cvt_pk_bf16_f32 v68, v12, v13
    v_cvt_pk_bf16_f32 v69, v14, v15
    v_cvt_pk_bf16_f32 v70, v16, v17
    v_cvt_pk_bf16_f32 v71, v18, v19
    v_lshlrev_b32 v12, 16, v68
    v_and_b32 v13, s22, v68
    v_lshlrev_b32 v14, 16, v69
    v_and_b32 v15, s22, v69
    v_lshlrev_b32 v16, 16, v70
    v_and_b32 v17, s22, v70
    v_lshlrev_b32 v18, 16, v71
    v_and_b32 v19, s22, v71
    v_pk_fma_f32 v[12:13], v[12:13], v[34:35], v[34:35] op_sel:[0,0,1] op_sel_hi:[1,0,1]
    v_pk_fma_f32 v[14:15], v[14:15], v[34:35], v[34:35] op_sel:[0,0,1] op_sel_hi:[1,0,1]
    v_pk_fma_f32 v[16:17], v[16:17], v[34:35], v[34:35] op_sel:[0,0,1] op_sel_hi:[1,0,1]
    v_pk_fma_f32 v[18:19], v[18:19], v[34:35], v[34:35] op_sel:[0,0,1] op_sel_hi:[1,0,1]
    v_cvt_pk_bf16_f32 v68, v12, v13
    v_cvt_pk_bf16_f32 v69, v14, v15
    v_cvt_pk_bf16_f32 v70, v16, v17
    v_cvt_pk_bf16_f32 v71, v18, v19
    global_store_dwordx4 v1, v[68:71], s[14:15] sc1
    s_add_u32 s14, s14, 8192
    s_addc_u32 s15, s15, 0
    v_lshlrev_b32 v12, 16, v72
    v_and_b32 v13, s22, v72
    v_lshlrev_b32 v14, 16, v73
    v_and_b32 v15, s22, v73
    v_lshlrev_b32 v16, 16, v74
    v_and_b32 v17, s22, v74
    v_lshlrev_b32 v18, 16, v75
    v_and_b32 v19, s22, v75
    v_pk_add_f32 v[12:13], v[12:13], v[32:33] op_sel_hi:[1,0] neg_lo:[0,1] neg_hi:[0,1]
    v_pk_add_f32 v[14:15], v[14:15], v[32:33] op_sel_hi:[1,0] neg_lo:[0,1] neg_hi:[0,1]
    v_pk_add_f32 v[16:17], v[16:17], v[32:33] op_sel_hi:[1,0] neg_lo:[0,1] neg_hi:[0,1]
    v_pk_add_f32 v[18:19], v[18:19], v[32:33] op_sel_hi:[1,0] neg_lo:[0,1] neg_hi:[0,1]
    v_cvt_pk_bf16_f32 v72, v12, v13
    v_cvt_pk_bf16_f32 v73, v14, v15
    v_cvt_pk_bf16_f32 v74, v16, v17
    v_cvt_pk_bf16_f32 v75, v18, v19
    v_lshlrev_b32 v12, 16, v72
    v_and_b32 v13, s22, v72
    v_lshlrev_b32 v14, 16, v73
    v_and_b32 v15, s22, v73
    v_lshlrev_b32 v16, 16, v74
    v_and_b32 v17, s22, v74
    v_lshlrev_b32 v18, 16, v75
    v_and_b32 v19, s22, v75
    v_pk_fma_f32 v[12:13], v[12:13], v[34:35], v[34:35] op_sel:[0,0,1] op_sel_hi:[1,0,1]
    v_pk_fma_f32 v[14:15], v[14:15], v[34:35], v[34:35] op_sel:[0,0,1] op_sel_hi:[1,0,1]
    v_pk_fma_f32 v[16:17], v[16:17], v[34:35], v[34:35] op_sel:[0,0,1] op_sel_hi:[1,0,1]
    v_pk_fma_f32 v[18:19], v[18:19], v[34:35], v[34:35] op_sel:[0,0,1] op_sel_hi:[1,0,1]
    v_cvt_pk_bf16_f32 v72, v12, v13
    v_cvt_pk_bf16_f32 v73, v14, v15
    v_cvt_pk_bf16_f32 v74, v16, v17
    v_cvt_pk_bf16_f32 v75, v18, v19
    global_store_dwordx4 v1, v[72:75], s[14:15] sc1
    s_add_u32 s14, s14, 8192
    s_addc_u32 s15, s15, 0
    v_lshlrev_b32 v12, 16, v76
    v_and_b32 v13, s22, v76
    v_lshlrev_b32 v14, 16, v77
    v_and_b32 v15, s22, v77
    v_lshlrev_b32 v16, 16, v78
    v_and_b32 v17, s22, v78
    v_lshlrev_b32 v18, 16, v79
    v_and_b32 v19, s22, v79
    v_pk_add_f32 v[12:13], v[12:13], v[32:33] op_sel_hi:[1,0] neg_lo:[0,1] neg_hi:[0,1]
    v_pk_add_f32 v[14:15], v[14:15], v[32:33] op_sel_hi:[1,0] neg_lo:[0,1] neg_hi:[0,1]
    v_pk_add_f32 v[16:17], v[16:17], v[32:33] op_sel_hi:[1,0] neg_lo:[0,1] neg_hi:[0,1]
    v_pk_add_f32 v[18:19], v[18:19], v[32:33] op_sel_hi:[1,0] neg_lo:[0,1] neg_hi:[0,1]
    v_cvt_pk_bf16_f32 v76, v12, v13
    v_cvt_pk_bf16_f32 v77, v14, v15
    v_cvt_pk_bf16_f32 v78, v16, v17
    v_cvt_pk_bf16_f32 v79, v18, v19
    v_lshlrev_b32 v12, 16, v76
    v_and_b32 v13, s22, v76
    v_lshlrev_b32 v14, 16, v77
    v_and_b32 v15, s22, v77
    v_lshlrev_b32 v16, 16, v78
    v_and_b32 v17, s22, v78
    v_lshlrev_b32 v18, 16, v79
    v_and_b32 v19, s22, v79
    v_pk_fma_f32 v[12:13], v[12:13], v[34:35], v[34:35] op_sel:[0,0,1] op_sel_hi:[1,0,1]
    v_pk_fma_f32 v[14:15], v[14:15], v[34:35], v[34:35] op_sel:[0,0,1] op_sel_hi:[1,0,1]
    v_pk_fma_f32 v[16:17], v[16:17], v[34:35], v[34:35] op_sel:[0,0,1] op_sel_hi:[1,0,1]
    v_pk_fma_f32 v[18:19], v[18:19], v[34:35], v[34:35] op_sel:[0,0,1] op_sel_hi:[1,0,1]
    v_cvt_pk_bf16_f32 v76, v12, v13
    v_cvt_pk_bf16_f32 v77, v14, v15
    v_cvt_pk_bf16_f32 v78, v16, v17
    v_cvt_pk_bf16_f32 v79, v18, v19
    global_store_dwordx4 v1, v[76:79], s[14:15] sc1
    s_add_u32 s14, s14, 8192
    s_addc_u32 s15, s15, 0
    v_lshlrev_b32 v12, 16, v80
    v_and_b32 v13, s22, v80
    v_lshlrev_b32 v14, 16, v81
    v_and_b32 v15, s22, v81
    v_lshlrev_b32 v16, 16, v82
    v_and_b32 v17, s22, v82
    v_lshlrev_b32 v18, 16, v83
    v_and_b32 v19, s22, v83
    v_pk_add_f32 v[12:13], v[12:13], v[32:33] op_sel_hi:[1,0] neg_lo:[0,1] neg_hi:[0,1]
    v_pk_add_f32 v[14:15], v[14:15], v[32:33] op_sel_hi:[1,0] neg_lo:[0,1] neg_hi:[0,1]
    v_pk_add_f32 v[16:17], v[16:17], v[32:33] op_sel_hi:[1,0] neg_lo:[0,1] neg_hi:[0,1]
    v_pk_add_f32 v[18:19], v[18:19], v[32:33] op_sel_hi:[1,0] neg_lo:[0,1] neg_hi:[0,1]
    v_cvt_pk_bf16_f32 v80, v12, v13
    v_cvt_pk_bf16_f32 v81, v14, v15
    v_cvt_pk_bf16_f32 v82, v16, v17
    v_cvt_pk_bf16_f32 v83, v18, v19
    v_lshlrev_b32 v12, 16, v80
    v_and_b32 v13, s22, v80
    v_lshlrev_b32 v14, 16, v81
    v_and_b32 v15, s22, v81
    v_lshlrev_b32 v16, 16, v82
    v_and_b32 v17, s22, v82
    v_lshlrev_b32 v18, 16, v83
    v_and_b32 v19, s22, v83
    v_pk_fma_f32 v[12:13], v[12:13], v[34:35], v[34:35] op_sel:[0,0,1] op_sel_hi:[1,0,1]
    v_pk_fma_f32 v[14:15], v[14:15], v[34:35], v[34:35] op_sel:[0,0,1] op_sel_hi:[1,0,1]
    v_pk_fma_f32 v[16:17], v[16:17], v[34:35], v[34:35] op_sel:[0,0,1] op_sel_hi:[1,0,1]
    v_pk_fma_f32 v[18:19], v[18:19], v[34:35], v[34:35] op_sel:[0,0,1] op_sel_hi:[1,0,1]
    v_cvt_pk_bf16_f32 v80, v12, v13
    v_cvt_pk_bf16_f32 v81, v14, v15
    v_cvt_pk_bf16_f32 v82, v16, v17
    v_cvt_pk_bf16_f32 v83, v18, v19
    global_store_dwordx4 v1, v[80:83], s[14:15] sc1
    s_add_u32 s14, s14, 8192
    s_addc_u32 s15, s15, 0
    s_add_u32 s14, s10, s47
    s_addc_u32 s15, s11, 0
    v_lshlrev_b32 v12, 16, v212
    v_and_b32 v13, s22, v212
    v_lshlrev_b32 v14, 16, v213
    v_and_b32 v15, s22, v213
    v_lshlrev_b32 v16, 16, v214
    v_and_b32 v17, s22, v214
    v_lshlrev_b32 v18, 16, v215
    v_and_b32 v19, s22, v215
    v_pk_fma_f32 v[12:13], v[12:13], v[8:9], v[8:9] op_sel:[0,0,1] op_sel_hi:[1,0,1]
    v_pk_fma_f32 v[14:15], v[14:15], v[8:9], v[8:9] op_sel:[0,0,1] op_sel_hi:[1,0,1]
    v_pk_fma_f32 v[16:17], v[16:17], v[8:9], v[8:9] op_sel:[0,0,1] op_sel_hi:[1,0,1]
    v_pk_fma_f32 v[18:19], v[18:19], v[8:9], v[8:9] op_sel:[0,0,1] op_sel_hi:[1,0,1]
    v_cvt_pk_bf16_f32 v212, v12, v13
    v_cvt_pk_bf16_f32 v213, v14, v15
    v_cvt_pk_bf16_f32 v214, v16, v17
    v_cvt_pk_bf16_f32 v215, v18, v19
    global_store_dwordx4 v1, v[212:215], s[14:15] sc1
    s_add_u32 s14, s14, 8192
    s_addc_u32 s15, s15, 0
    v_lshlrev_b32 v12, 16, v216
    v_and_b32 v13, s22, v216
    v_lshlrev_b32 v14, 16, v217
    v_and_b32 v15, s22, v217
    v_lshlrev_b32 v16, 16, v218
    v_and_b32 v17, s22, v218
    v_lshlrev_b32 v18, 16, v219
    v_and_b32 v19, s22, v219
    v_pk_fma_f32 v[12:13], v[12:13], v[8:9], v[8:9] op_sel:[0,0,1] op_sel_hi:[1,0,1]
    v_pk_fma_f32 v[14:15], v[14:15], v[8:9], v[8:9] op_sel:[0,0,1] op_sel_hi:[1,0,1]
    v_pk_fma_f32 v[16:17], v[16:17], v[8:9], v[8:9] op_sel:[0,0,1] op_sel_hi:[1,0,1]
    v_pk_fma_f32 v[18:19], v[18:19], v[8:9], v[8:9] op_sel:[0,0,1] op_sel_hi:[1,0,1]
    v_cvt_pk_bf16_f32 v216, v12, v13
    v_cvt_pk_bf16_f32 v217, v14, v15
    v_cvt_pk_bf16_f32 v218, v16, v17
    v_cvt_pk_bf16_f32 v219, v18, v19
    global_store_dwordx4 v1, v[216:219], s[14:15] sc1
    s_add_u32 s14, s14, 8192
    s_addc_u32 s15, s15, 0
    v_lshlrev_b32 v12, 16, v220
    v_and_b32 v13, s22, v220
    v_lshlrev_b32 v14, 16, v221
    v_and_b32 v15, s22, v221
    v_lshlrev_b32 v16, 16, v222
    v_and_b32 v17, s22, v222
    v_lshlrev_b32 v18, 16, v223
    v_and_b32 v19, s22, v223
    v_pk_fma_f32 v[12:13], v[12:13], v[8:9], v[8:9] op_sel:[0,0,1] op_sel_hi:[1,0,1]
    v_pk_fma_f32 v[14:15], v[14:15], v[8:9], v[8:9] op_sel:[0,0,1] op_sel_hi:[1,0,1]
    v_pk_fma_f32 v[16:17], v[16:17], v[8:9], v[8:9] op_sel:[0,0,1] op_sel_hi:[1,0,1]
    v_pk_fma_f32 v[18:19], v[18:19], v[8:9], v[8:9] op_sel:[0,0,1] op_sel_hi:[1,0,1]
    v_cvt_pk_bf16_f32 v220, v12, v13
    v_cvt_pk_bf16_f32 v221, v14, v15
    v_cvt_pk_bf16_f32 v222, v16, v17
    v_cvt_pk_bf16_f32 v223, v18, v19
    global_store_dwordx4 v1, v[220:223], s[14:15] sc1
    s_add_u32 s14, s14, 8192
    s_addc_u32 s15, s15, 0
    v_mov_b32 v4, 0
    v_mov_b32 v5, 0
    v_mov_b32 v6, 0
    v_mov_b32 v7, 0
    s_waitcnt vmcnt(57)
    v_dot2c_f32_bf16 v4, s21, v104
    v_dot2c_f32_bf16 v5, s21, v105
    v_dot2c_f32_bf16 v6, s21, v106
    v_dot2c_f32_bf16 v7, s21, v107
    s_waitcnt vmcnt(55)
    v_dot2c_f32_bf16 v4, s21, v108
    v_dot2c_f32_bf16 v5, s21, v109
    v_dot2c_f32_bf16 v6, s21, v110
    v_dot2c_f32_bf16 v7, s21, v111
    s_waitcnt vmcnt(53)
    v_dot2c_f32_bf16 v4, s21, v112
    v_dot2c_f32_bf16 v5, s21, v113
    v_dot2c_f32_bf16 v6, s21, v114
    v_dot2c_f32_bf16 v7, s21, v115
    s_waitcnt vmcnt(51)
    v_dot2c_f32_bf16 v4, s21, v116
    v_dot2c_f32_bf16 v5, s21, v117
    v_dot2c_f32_bf16 v6, s21, v118
    v_dot2c_f32_bf16 v7, s21, v119
    s_waitcnt vmcnt(49)
    v_dot2c_f32_bf16 v4, s21, v120
    v_dot2c_f32_bf16 v5, s21, v121
    v_dot2c_f32_bf16 v6, s21, v122
    v_dot2c_f32_bf16 v7, s21, v123
    s_waitcnt vmcnt(47)
    v_dot2c_f32_bf16 v4, s21, v124
    v_dot2c_f32_bf16 v5, s21, v125
    v_dot2c_f32_bf16 v6, s21, v126
    v_dot2c_f32_bf16 v7, s21, v127
    s_waitcnt vmcnt(45)
    v_dot2c_f32_bf16 v4, s21, v128
    v_dot2c_f32_bf16 v5, s21, v129
    v_dot2c_f32_bf16 v6, s21, v130
    v_dot2c_f32_bf16 v7, s21, v131
    s_waitcnt vmcnt(43)
    v_dot2c_f32_bf16 v4, s21, v132
    v_dot2c_f32_bf16 v5, s21, v133
    v_dot2c_f32_bf16 v6, s21, v134
    v_dot2c_f32_bf16 v7, s21, v135
    s_waitcnt vmcnt(41)
    v_dot2c_f32_bf16 v4, s21, v136
    v_dot2c_f32_bf16 v5, s21, v137
    v_dot2c_f32_bf16 v6, s21, v138
    v_dot2c_f32_bf16 v7, s21, v139
    s_waitcnt vmcnt(39)
    v_dot2c_f32_bf16 v4, s21, v140
    v_dot2c_f32_bf16 v5, s21, v141
    v_dot2c_f32_bf16 v6, s21, v142
    v_dot2c_f32_bf16 v7, s21, v143
    s_waitcnt vmcnt(37)
    v_dot2c_f32_bf16 v4, s21, v144
    v_dot2c_f32_bf16 v5, s21, v145
    v_dot2c_f32_bf16 v6, s21, v146
    v_dot2c_f32_bf16 v7, s21, v147
    s_waitcnt vmcnt(34)
    v_dot2c_f32_bf16 v4, s21, v148
    v_dot2c_f32_bf16 v5, s21, v149
    v_dot2c_f32_bf16 v6, s21, v150
    v_dot2c_f32_bf16 v7, s21, v151
    s_waitcnt vmcnt(32)
    v_dot2c_f32_bf16 v4, s21, v152
    v_dot2c_f32_bf16 v5, s21, v153
    v_dot2c_f32_bf16 v6, s21, v154
    v_dot2c_f32_bf16 v7, s21, v155
    s_waitcnt vmcnt(30)
    v_dot2c_f32_bf16 v4, s21, v156
    v_dot2c_f32_bf16 v5, s21, v157
    v_dot2c_f32_bf16 v6, s21, v158
    v_dot2c_f32_bf16 v7, s21, v159
    s_waitcnt vmcnt(28)
    v_dot2c_f32_bf16 v4, s21, v160
    v_dot2c_f32_bf16 v5, s21, v161
    v_dot2c_f32_bf16 v6, s21, v162
    v_dot2c_f32_bf16 v7, s21, v163
    s_waitcnt vmcnt(26)
    v_dot2c_f32_bf16 v4, s21, v164
    v_dot2c_f32_bf16 v5, s21, v165
    v_dot2c_f32_bf16 v6, s21, v166
    v_dot2c_f32_bf16 v7, s21, v167
    s_nop 2
    v_add_f32 v4, v4, v5
    v_add_f32 v6, v6, v7
    v_add_f32 v4, v4, v6
    s_nop 1
    v_add_f32_dpp v5, v4, v4 row_ror:8 row_mask:0xf bank_mask:0xf
    s_nop 1
    v_add_f32_dpp v4, v5, v5 row_ror:4 row_mask:0xf bank_mask:0xf
    s_nop 1
    v_add_f32_dpp v5, v4, v4 row_ror:2 row_mask:0xf bank_mask:0xf
    s_nop 1
    v_add_f32_dpp v4, v5, v5 row_ror:1 row_mask:0xf bank_mask:0xf
    ds_write_b32 v2, v4 offset:0
    v_lshlrev_b32 v12, 16, v224
    v_and_b32 v13, s22, v224
    v_lshlrev_b32 v14, 16, v225
    v_and_b32 v15, s22, v225
    v_lshlrev_b32 v16, 16, v226
    v_and_b32 v17, s22, v226
    v_lshlrev_b32 v18, 16, v227
    v_and_b32 v19, s22, v227
    v_pk_fma_f32 v[12:13], v[12:13], v[8:9], v[8:9] op_sel:[0,0,1] op_sel_hi:[1,0,1]
    v_pk_fma_f32 v[14:15], v[14:15], v[8:9], v[8:9] op_sel:[0,0,1] op_sel_hi:[1,0,1]
    v_pk_fma_f32 v[16:17], v[16:17], v[8:9], v[8:9] op_sel:[0,0,1] op_sel_hi:[1,0,1]
    v_pk_fma_f32 v[18:19], v[18:19], v[8:9], v[8:9] op_sel:[0,0,1] op_sel_hi:[1,0,1]
    v_cvt_pk_bf16_f32 v224, v12, v13
    v_cvt_pk_bf16_f32 v225, v14, v15
    v_cvt_pk_bf16_f32 v226, v16, v17
    v_cvt_pk_bf16_f32 v227, v18, v19
    global_store_dwordx4 v1, v[224:227], s[14:15] sc1
    s_add_u32 s14, s14, 8192
    s_addc_u32 s15, s15, 0
    v_lshlrev_b32 v12, 16, v228
    v_and_b32 v13, s22, v228
    v_lshlrev_b32 v14, 16, v229
    v_and_b32 v15, s22, v229
    v_lshlrev_b32 v16, 16, v230
    v_and_b32 v17, s22, v230
    v_lshlrev_b32 v18, 16, v231
    v_and_b32 v19, s22, v231
    v_pk_fma_f32 v[12:13], v[12:13], v[8:9], v[8:9] op_sel:[0,0,1] op_sel_hi:[1,0,1]
    v_pk_fma_f32 v[14:15], v[14:15], v[8:9], v[8:9] op_sel:[0,0,1] op_sel_hi:[1,0,1]
    v_pk_fma_f32 v[16:17], v[16:17], v[8:9], v[8:9] op_sel:[0,0,1] op_sel_hi:[1,0,1]
    v_pk_fma_f32 v[18:19], v[18:19], v[8:9], v[8:9] op_sel:[0,0,1] op_sel_hi:[1,0,1]
    v_cvt_pk_bf16_f32 v228, v12, v13
    v_cvt_pk_bf16_f32 v229, v14, v15
    v_cvt_pk_bf16_f32 v230, v16, v17
    v_cvt_pk_bf16_f32 v231, v18, v19
    global_store_dwordx4 v1, v[228:231], s[14:15] sc1
    s_add_u32 s14, s14, 8192
    s_addc_u32 s15, s15, 0
    s_waitcnt lgkmcnt(0)
    s_barrier
    ds_read_b64 v[4:5], v3 offset:0
    s_waitcnt lgkmcnt(0)
    v_add_f32 v4, v4, v5
    s_nop 1
    v_add_f32_dpp v5, v4, v4 row_ror:8 row_mask:0xf bank_mask:0xf
    s_nop 1
    v_add_f32_dpp v4, v5, v5 row_ror:4 row_mask:0xf bank_mask:0xf
    s_nop 1
    v_add_f32_dpp v5, v4, v4 row_ror:2 row_mask:0xf bank_mask:0xf
    s_nop 1
    v_add_f32_dpp v4, v5, v5 row_ror:1 row_mask:0xf bank_mask:0xf
    v_mul_f32 v4, 0x37800000, v4
    v_cvt_pk_bf16_f32 v4, v4, v4
    v_lshlrev_b32 v20, 16, v4
    v_mov_b32 v4, 0
    v_mov_b32 v5, 0
    v_mov_b32 v6, 0
    v_mov_b32 v7, 0
    v_lshlrev_b32 v12, 16, v232
    v_and_b32 v13, s22, v232
    v_lshlrev_b32 v14, 16, v233
    v_and_b32 v15, s22, v233
    v_lshlrev_b32 v16, 16, v234
    v_and_b32 v17, s22, v234
    v_lshlrev_b32 v18, 16, v235
    v_and_b32 v19, s22, v235
    v_pk_fma_f32 v[12:13], v[12:13], v[8:9], v[8:9] op_sel:[0,0,1] op_sel_hi:[1,0,1]
    v_pk_fma_f32 v[14:15], v[14:15], v[8:9], v[8:9] op_sel:[0,0,1] op_sel_hi:[1,0,1]
    v_pk_fma_f32 v[16:17], v[16:17], v[8:9], v[8:9] op_sel:[0,0,1] op_sel_hi:[1,0,1]
    v_pk_fma_f32 v[18:19], v[18:19], v[8:9], v[8:9] op_sel:[0,0,1] op_sel_hi:[1,0,1]
    v_cvt_pk_bf16_f32 v232, v12, v13
    v_cvt_pk_bf16_f32 v233, v14, v15
    v_cvt_pk_bf16_f32 v234, v16, v17
    v_cvt_pk_bf16_f32 v235, v18, v19
    global_store_dwordx4 v1, v[232:235], s[14:15] sc1
    s_add_u32 s14, s14, 8192
    s_addc_u32 s15, s15, 0
    v_lshlrev_b32 v12, 16, v236
    v_and_b32 v13, s22, v236
    v_lshlrev_b32 v14, 16, v237
    v_and_b32 v15, s22, v237
    v_lshlrev_b32 v16, 16, v238
    v_and_b32 v17, s22, v238
    v_lshlrev_b32 v18, 16, v239
    v_and_b32 v19, s22, v239
    v_pk_fma_f32 v[12:13], v[12:13], v[8:9], v[8:9] op_sel:[0,0,1] op_sel_hi:[1,0,1]
    v_pk_fma_f32 v[14:15], v[14:15], v[8:9], v[8:9] op_sel:[0,0,1] op_sel_hi:[1,0,1]
    v_pk_fma_f32 v[16:17], v[16:17], v[8:9], v[8:9] op_sel:[0,0,1] op_sel_hi:[1,0,1]
    v_pk_fma_f32 v[18:19], v[18:19], v[8:9], v[8:9] op_sel:[0,0,1] op_sel_hi:[1,0,1]
    v_cvt_pk_bf16_f32 v236, v12, v13
    v_cvt_pk_bf16_f32 v237, v14, v15
    v_cvt_pk_bf16_f32 v238, v16, v17
    v_cvt_pk_bf16_f32 v239, v18, v19
    global_store_dwordx4 v1, v[236:239], s[14:15] sc1
    s_add_u32 s14, s14, 8192
    s_addc_u32 s15, s15, 0
    v_lshlrev_b32 v12, 16, v104
    v_and_b32 v13, s22, v104
    v_lshlrev_b32 v14, 16, v105
    v_and_b32 v15, s22, v105
    v_lshlrev_b32 v16, 16, v106
    v_and_b32 v17, s22, v106
    v_lshlrev_b32 v18, 16, v107
    v_and_b32 v19, s22, v107
    v_pk_add_f32 v[12:13], v[12:13], v[20:21] op_sel_hi:[1,0] neg_lo:[0,1] neg_hi:[0,1]
    v_pk_add_f32 v[14:15], v[14:15], v[20:21] op_sel_hi:[1,0] neg_lo:[0,1] neg_hi:[0,1]
    v_pk_add_f32 v[16:17], v[16:17], v[20:21] op_sel_hi:[1,0] neg_lo:[0,1] neg_hi:[0,1]
    v_pk_add_f32 v[18:19], v[18:19], v[20:21] op_sel_hi:[1,0] neg_lo:[0,1] neg_hi:[0,1]
    v_cvt_pk_bf16_f32 v104, v12, v13
    v_cvt_pk_bf16_f32 v105, v14, v15
    v_cvt_pk_bf16_f32 v106, v16, v17
    v_cvt_pk_bf16_f32 v107, v18, v19
    v_dot2c_f32_bf16 v4, v104, v104
    v_dot2c_f32_bf16 v5, v105, v105
    v_dot2c_f32_bf16 v6, v106, v106
    v_dot2c_f32_bf16 v7, v107, v107
    v_lshlrev_b32 v12, 16, v108
    v_and_b32 v13, s22, v108
    v_lshlrev_b32 v14, 16, v109
    v_and_b32 v15, s22, v109
    v_lshlrev_b32 v16, 16, v110
    v_and_b32 v17, s22, v110
    v_lshlrev_b32 v18, 16, v111
    v_and_b32 v19, s22, v111
    v_pk_add_f32 v[12:13], v[12:13], v[20:21] op_sel_hi:[1,0] neg_lo:[0,1] neg_hi:[0,1]
    v_pk_add_f32 v[14:15], v[14:15], v[20:21] op_sel_hi:[1,0] neg_lo:[0,1] neg_hi:[0,1]
    v_pk_add_f32 v[16:17], v[16:17], v[20:21] op_sel_hi:[1,0] neg_lo:[0,1] neg_hi:[0,1]
    v_pk_add_f32 v[18:19], v[18:19], v[20:21] op_sel_hi:[1,0] neg_lo:[0,1] neg_hi:[0,1]
    v_cvt_pk_bf16_f32 v108, v12, v13
    v_cvt_pk_bf16_f32 v109, v14, v15
    v_cvt_pk_bf16_f32 v110, v16, v17
    v_cvt_pk_bf16_f32 v111, v18, v19
    v_dot2c_f32_bf16 v4, v108, v108
    v_dot2c_f32_bf16 v5, v109, v109
    v_dot2c_f32_bf16 v6, v110, v110
    v_dot2c_f32_bf16 v7, v111, v111
    v_lshlrev_b32 v12, 16, v112
    v_and_b32 v13, s22, v112
    v_lshlrev_b32 v14, 16, v113
    v_and_b32 v15, s22, v113
    v_lshlrev_b32 v16, 16, v114
    v_and_b32 v17, s22, v114
    v_lshlrev_b32 v18, 16, v115
    v_and_b32 v19, s22, v115
    v_pk_add_f32 v[12:13], v[12:13], v[20:21] op_sel_hi:[1,0] neg_lo:[0,1] neg_hi:[0,1]
    v_pk_add_f32 v[14:15], v[14:15], v[20:21] op_sel_hi:[1,0] neg_lo:[0,1] neg_hi:[0,1]
    v_pk_add_f32 v[16:17], v[16:17], v[20:21] op_sel_hi:[1,0] neg_lo:[0,1] neg_hi:[0,1]
    v_pk_add_f32 v[18:19], v[18:19], v[20:21] op_sel_hi:[1,0] neg_lo:[0,1] neg_hi:[0,1]
    v_cvt_pk_bf16_f32 v112, v12, v13
    v_cvt_pk_bf16_f32 v113, v14, v15
    v_cvt_pk_bf16_f32 v114, v16, v17
    v_cvt_pk_bf16_f32 v115, v18, v19
    v_dot2c_f32_bf16 v4, v112, v112
    v_dot2c_f32_bf16 v5, v113, v113
    v_dot2c_f32_bf16 v6, v114, v114
    v_dot2c_f32_bf16 v7, v115, v115
    v_lshlrev_b32 v12, 16, v116
    v_and_b32 v13, s22, v116
    v_lshlrev_b32 v14, 16, v117
    v_and_b32 v15, s22, v117
    v_lshlrev_b32 v16, 16, v118
    v_and_b32 v17, s22, v118
    v_lshlrev_b32 v18, 16, v119
    v_and_b32 v19, s22, v119
    v_pk_add_f32 v[12:13], v[12:13], v[20:21] op_sel_hi:[1,0] neg_lo:[0,1] neg_hi:[0,1]
    v_pk_add_f32 v[14:15], v[14:15], v[20:21] op_sel_hi:[1,0] neg_lo:[0,1] neg_hi:[0,1]
    v_pk_add_f32 v[16:17], v[16:17], v[20:21] op_sel_hi:[1,0] neg_lo:[0,1] neg_hi:[0,1]
    v_pk_add_f32 v[18:19], v[18:19], v[20:21] op_sel_hi:[1,0] neg_lo:[0,1] neg_hi:[0,1]
    v_cvt_pk_bf16_f32 v116, v12, v13
    v_cvt_pk_bf16_f32 v117, v14, v15
    v_cvt_pk_bf16_f32 v118, v16, v17
    v_cvt_pk_bf16_f32 v119, v18, v19
    v_dot2c_f32_bf16 v4, v116, v116
    v_dot2c_f32_bf16 v5, v117, v117
    v_dot2c_f32_bf16 v6, v118, v118
    v_dot2c_f32_bf16 v7, v119, v119
    v_lshlrev_b32 v12, 16, v240
    v_and_b32 v13, s22, v240
    v_lshlrev_b32 v14, 16, v241
    v_and_b32 v15, s22, v241
    v_lshlrev_b32 v16, 16, v242
    v_and_b32 v17, s22, v242
    v_lshlrev_b32 v18, 16, v243
    v_and_b32 v19, s22, v243
    v_pk_fma_f32 v[12:13], v[12:13], v[8:9], v[8:9] op_sel:[0,0,1] op_sel_hi:[1,0,1]
    v_pk_fma_f32 v[14:15], v[14:15], v[8:9], v[8:9] op_sel:[0,0,1] op_sel_hi:[1,0,1]
    v_pk_fma_f32 v[16:17], v[16:17], v[8:9], v[8:9] op_sel:[0,0,1] op_sel_hi:[1,0,1]
    v_pk_fma_f32 v[18:19], v[18:19], v[8:9], v[8:9] op_sel:[0,0,1] op_sel_hi:[1,0,1]
    v_cvt_pk_bf16_f32 v240, v12, v13
    v_cvt_pk_bf16_f32 v241, v14, v15
    v_cvt_pk_bf16_f32 v242, v16, v17
    v_cvt_pk_bf16_f32 v243, v18, v19
    global_store_dwordx4 v1, v[240:243], s[14:15] sc1
    s_add_u32 s14, s14, 8192
    s_addc_u32 s15, s15, 0
    v_lshlrev_b32 v12, 16, v244
    v_and_b32 v13, s22, v244
    v_lshlrev_b32 v14, 16, v245
    v_and_b32 v15, s22, v245
    v_lshlrev_b32 v16, 16, v246
    v_and_b32 v17, s22, v246
    v_lshlrev_b32 v18, 16, v247
    v_and_b32 v19, s22, v247
    v_pk_fma_f32 v[12:13], v[12:13], v[8:9], v[8:9] op_sel:[0,0,1] op_sel_hi:[1,0,1]
    v_pk_fma_f32 v[14:15], v[14:15], v[8:9], v[8:9] op_sel:[0,0,1] op_sel_hi:[1,0,1]
    v_pk_fma_f32 v[16:17], v[16:17], v[8:9], v[8:9] op_sel:[0,0,1] op_sel_hi:[1,0,1]
    v_pk_fma_f32 v[18:19], v[18:19], v[8:9], v[8:9] op_sel:[0,0,1] op_sel_hi:[1,0,1]
    v_cvt_pk_bf16_f32 v244, v12, v13
    v_cvt_pk_bf16_f32 v245, v14, v15
    v_cvt_pk_bf16_f32 v246, v16, v17
    v_cvt_pk_bf16_f32 v247, v18, v19
    global_store_dwordx4 v1, v[244:247], s[14:15] sc1
    s_add_u32 s14, s14, 8192
    s_addc_u32 s15, s15, 0
    v_lshlrev_b32 v12, 16, v120
    v_and_b32 v13, s22, v120
    v_lshlrev_b32 v14, 16, v121
    v_and_b32 v15, s22, v121
    v_lshlrev_b32 v16, 16, v122
    v_and_b32 v17, s22, v122
    v_lshlrev_b32 v18, 16, v123
    v_and_b32 v19, s22, v123
    v_pk_add_f32 v[12:13], v[12:13], v[20:21] op_sel_hi:[1,0] neg_lo:[0,1] neg_hi:[0,1]
    v_pk_add_f32 v[14:15], v[14:15], v[20:21] op_sel_hi:[1,0] neg_lo:[0,1] neg_hi:[0,1]
    v_pk_add_f32 v[16:17], v[16:17], v[20:21] op_sel_hi:[1,0] neg_lo:[0,1] neg_hi:[0,1]
    v_pk_add_f32 v[18:19], v[18:19], v[20:21] op_sel_hi:[1,0] neg_lo:[0,1] neg_hi:[0,1]
    v_cvt_pk_bf16_f32 v120, v12, v13
    v_cvt_pk_bf16_f32 v121, v14, v15
    v_cvt_pk_bf16_f32 v122, v16, v17
    v_cvt_pk_bf16_f32 v123, v18, v19
    v_dot2c_f32_bf16 v4, v120, v120
    v_dot2c_f32_bf16 v5, v121, v121
    v_dot2c_f32_bf16 v6, v122, v122
    v_dot2c_f32_bf16 v7, v123, v123
    v_lshlrev_b32 v12, 16, v124
    v_and_b32 v13, s22, v124
    v_lshlrev_b32 v14, 16, v125
    v_and_b32 v15, s22, v125
    v_lshlrev_b32 v16, 16, v126
    v_and_b32 v17, s22, v126
    v_lshlrev_b32 v18, 16, v127
    v_and_b32 v19, s22, v127
    v_pk_add_f32 v[12:13], v[12:13], v[20:21] op_sel_hi:[1,0] neg_lo:[0,1] neg_hi:[0,1]
    v_pk_add_f32 v[14:15], v[14:15], v[20:21] op_sel_hi:[1,0] neg_lo:[0,1] neg_hi:[0,1]
    v_pk_add_f32 v[16:17], v[16:17], v[20:21] op_sel_hi:[1,0] neg_lo:[0,1] neg_hi:[0,1]
    v_pk_add_f32 v[18:19], v[18:19], v[20:21] op_sel_hi:[1,0] neg_lo:[0,1] neg_hi:[0,1]
    v_cvt_pk_bf16_f32 v124, v12, v13
    v_cvt_pk_bf16_f32 v125, v14, v15
    v_cvt_pk_bf16_f32 v126, v16, v17
    v_cvt_pk_bf16_f32 v127, v18, v19
    v_dot2c_f32_bf16 v4, v124, v124
    v_dot2c_f32_bf16 v5, v125, v125
    v_dot2c_f32_bf16 v6, v126, v126
    v_dot2c_f32_bf16 v7, v127, v127
    v_lshlrev_b32 v12, 16, v128
    v_and_b32 v13, s22, v128
    v_lshlrev_b32 v14, 16, v129
    v_and_b32 v15, s22, v129
    v_lshlrev_b32 v16, 16, v130
    v_and_b32 v17, s22, v130
    v_lshlrev_b32 v18, 16, v131
    v_and_b32 v19, s22, v131
    v_pk_add_f32 v[12:13], v[12:13], v[20:21] op_sel_hi:[1,0] neg_lo:[0,1] neg_hi:[0,1]
    v_pk_add_f32 v[14:15], v[14:15], v[20:21] op_sel_hi:[1,0] neg_lo:[0,1] neg_hi:[0,1]
    v_pk_add_f32 v[16:17], v[16:17], v[20:21] op_sel_hi:[1,0] neg_lo:[0,1] neg_hi:[0,1]
    v_pk_add_f32 v[18:19], v[18:19], v[20:21] op_sel_hi:[1,0] neg_lo:[0,1] neg_hi:[0,1]
    v_cvt_pk_bf16_f32 v128, v12, v13
    v_cvt_pk_bf16_f32 v129, v14, v15
    v_cvt_pk_bf16_f32 v130, v16, v17
    v_cvt_pk_bf16_f32 v131, v18, v19
    v_dot2c_f32_bf16 v4, v128, v128
    v_dot2c_f32_bf16 v5, v129, v129
    v_dot2c_f32_bf16 v6, v130, v130
    v_dot2c_f32_bf16 v7, v131, v131
    v_lshlrev_b32 v12, 16, v132
    v_and_b32 v13, s22, v132
    v_lshlrev_b32 v14, 16, v133
    v_and_b32 v15, s22, v133
    v_lshlrev_b32 v16, 16, v134
    v_and_b32 v17, s22, v134
    v_lshlrev_b32 v18, 16, v135
    v_and_b32 v19, s22, v135
    v_pk_add_f32 v[12:13], v[12:13], v[20:21] op_sel_hi:[1,0] neg_lo:[0,1] neg_hi:[0,1]
    v_pk_add_f32 v[14:15], v[14:15], v[20:21] op_sel_hi:[1,0] neg_lo:[0,1] neg_hi:[0,1]
    v_pk_add_f32 v[16:17], v[16:17], v[20:21] op_sel_hi:[1,0] neg_lo:[0,1] neg_hi:[0,1]
    v_pk_add_f32 v[18:19], v[18:19], v[20:21] op_sel_hi:[1,0] neg_lo:[0,1] neg_hi:[0,1]
    v_cvt_pk_bf16_f32 v132, v12, v13
    v_cvt_pk_bf16_f32 v133, v14, v15
    v_cvt_pk_bf16_f32 v134, v16, v17
    v_cvt_pk_bf16_f32 v135, v18, v19
    v_dot2c_f32_bf16 v4, v132, v132
    v_dot2c_f32_bf16 v5, v133, v133
    v_dot2c_f32_bf16 v6, v134, v134
    v_dot2c_f32_bf16 v7, v135, v135
    v_lshlrev_b32 v12, 16, v248
    v_and_b32 v13, s22, v248
    v_lshlrev_b32 v14, 16, v249
    v_and_b32 v15, s22, v249
    v_lshlrev_b32 v16, 16, v250
    v_and_b32 v17, s22, v250
    v_lshlrev_b32 v18, 16, v251
    v_and_b32 v19, s22, v251
    v_pk_fma_f32 v[12:13], v[12:13], v[8:9], v[8:9] op_sel:[0,0,1] op_sel_hi:[1,0,1]
    v_pk_fma_f32 v[14:15], v[14:15], v[8:9], v[8:9] op_sel:[0,0,1] op_sel_hi:[1,0,1]
    v_pk_fma_f32 v[16:17], v[16:17], v[8:9], v[8:9] op_sel:[0,0,1] op_sel_hi:[1,0,1]
    v_pk_fma_f32 v[18:19], v[18:19], v[8:9], v[8:9] op_sel:[0,0,1] op_sel_hi:[1,0,1]
    v_cvt_pk_bf16_f32 v248, v12, v13
    v_cvt_pk_bf16_f32 v249, v14, v15
    v_cvt_pk_bf16_f32 v250, v16, v17
    v_cvt_pk_bf16_f32 v251, v18, v19
    global_store_dwordx4 v1, v[248:251], s[14:15] sc1
    s_add_u32 s14, s14, 8192
    s_addc_u32 s15, s15, 0
    v_lshlrev_b32 v12, 16, v252
    v_and_b32 v13, s22, v252
    v_lshlrev_b32 v14, 16, v253
    v_and_b32 v15, s22, v253
    v_lshlrev_b32 v16, 16, v254
    v_and_b32 v17, s22, v254
    v_lshlrev_b32 v18, 16, v255
    v_and_b32 v19, s22, v255
    v_pk_fma_f32 v[12:13], v[12:13], v[8:9], v[8:9] op_sel:[0,0,1] op_sel_hi:[1,0,1]
    v_pk_fma_f32 v[14:15], v[14:15], v[8:9], v[8:9] op_sel:[0,0,1] op_sel_hi:[1,0,1]
    v_pk_fma_f32 v[16:17], v[16:17], v[8:9], v[8:9] op_sel:[0,0,1] op_sel_hi:[1,0,1]
    v_pk_fma_f32 v[18:19], v[18:19], v[8:9], v[8:9] op_sel:[0,0,1] op_sel_hi:[1,0,1]
    v_cvt_pk_bf16_f32 v252, v12, v13
    v_cvt_pk_bf16_f32 v253, v14, v15
    v_cvt_pk_bf16_f32 v254, v16, v17
    v_cvt_pk_bf16_f32 v255, v18, v19
    global_store_dwordx4 v1, v[252:255], s[14:15] sc1
    s_add_u32 s14, s14, 8192
    s_addc_u32 s15, s15, 0
    v_lshlrev_b32 v12, 16, v136
    v_and_b32 v13, s22, v136
    v_lshlrev_b32 v14, 16, v137
    v_and_b32 v15, s22, v137
    v_lshlrev_b32 v16, 16, v138
    v_and_b32 v17, s22, v138
    v_lshlrev_b32 v18, 16, v139
    v_and_b32 v19, s22, v139
    v_pk_add_f32 v[12:13], v[12:13], v[20:21] op_sel_hi:[1,0] neg_lo:[0,1] neg_hi:[0,1]
    v_pk_add_f32 v[14:15], v[14:15], v[20:21] op_sel_hi:[1,0] neg_lo:[0,1] neg_hi:[0,1]
    v_pk_add_f32 v[16:17], v[16:17], v[20:21] op_sel_hi:[1,0] neg_lo:[0,1] neg_hi:[0,1]
    v_pk_add_f32 v[18:19], v[18:19], v[20:21] op_sel_hi:[1,0] neg_lo:[0,1] neg_hi:[0,1]
    v_cvt_pk_bf16_f32 v136, v12, v13
    v_cvt_pk_bf16_f32 v137, v14, v15
    v_cvt_pk_bf16_f32 v138, v16, v17
    v_cvt_pk_bf16_f32 v139, v18, v19
    v_dot2c_f32_bf16 v4, v136, v136
    v_dot2c_f32_bf16 v5, v137, v137
    v_dot2c_f32_bf16 v6, v138, v138
    v_dot2c_f32_bf16 v7, v139, v139
    v_lshlrev_b32 v12, 16, v140
    v_and_b32 v13, s22, v140
    v_lshlrev_b32 v14, 16, v141
    v_and_b32 v15, s22, v141
    v_lshlrev_b32 v16, 16, v142
    v_and_b32 v17, s22, v142
    v_lshlrev_b32 v18, 16, v143
    v_and_b32 v19, s22, v143
    v_pk_add_f32 v[12:13], v[12:13], v[20:21] op_sel_hi:[1,0] neg_lo:[0,1] neg_hi:[0,1]
    v_pk_add_f32 v[14:15], v[14:15], v[20:21] op_sel_hi:[1,0] neg_lo:[0,1] neg_hi:[0,1]
    v_pk_add_f32 v[16:17], v[16:17], v[20:21] op_sel_hi:[1,0] neg_lo:[0,1] neg_hi:[0,1]
    v_pk_add_f32 v[18:19], v[18:19], v[20:21] op_sel_hi:[1,0] neg_lo:[0,1] neg_hi:[0,1]
    v_cvt_pk_bf16_f32 v140, v12, v13
    v_cvt_pk_bf16_f32 v141, v14, v15
    v_cvt_pk_bf16_f32 v142, v16, v17
    v_cvt_pk_bf16_f32 v143, v18, v19
    v_dot2c_f32_bf16 v4, v140, v140
    v_dot2c_f32_bf16 v5, v141, v141
    v_dot2c_f32_bf16 v6, v142, v142
    v_dot2c_f32_bf16 v7, v143, v143
    v_lshlrev_b32 v12, 16, v144
    v_and_b32 v13, s22, v144
    v_lshlrev_b32 v14, 16, v145
    v_and_b32 v15, s22, v145
    v_lshlrev_b32 v16, 16, v146
    v_and_b32 v17, s22, v146
    v_lshlrev_b32 v18, 16, v147
    v_and_b32 v19, s22, v147
    v_pk_add_f32 v[12:13], v[12:13], v[20:21] op_sel_hi:[1,0] neg_lo:[0,1] neg_hi:[0,1]
    v_pk_add_f32 v[14:15], v[14:15], v[20:21] op_sel_hi:[1,0] neg_lo:[0,1] neg_hi:[0,1]
    v_pk_add_f32 v[16:17], v[16:17], v[20:21] op_sel_hi:[1,0] neg_lo:[0,1] neg_hi:[0,1]
    v_pk_add_f32 v[18:19], v[18:19], v[20:21] op_sel_hi:[1,0] neg_lo:[0,1] neg_hi:[0,1]
    v_cvt_pk_bf16_f32 v144, v12, v13
    v_cvt_pk_bf16_f32 v145, v14, v15
    v_cvt_pk_bf16_f32 v146, v16, v17
    v_cvt_pk_bf16_f32 v147, v18, v19
    v_dot2c_f32_bf16 v4, v144, v144
    v_dot2c_f32_bf16 v5, v145, v145
    v_dot2c_f32_bf16 v6, v146, v146
    v_dot2c_f32_bf16 v7, v147, v147
    v_lshlrev_b32 v12, 16, v148
    v_and_b32 v13, s22, v148
    v_lshlrev_b32 v14, 16, v149
    v_and_b32 v15, s22, v149
    v_lshlrev_b32 v16, 16, v150
    v_and_b32 v17, s22, v150
    v_lshlrev_b32 v18, 16, v151
    v_and_b32 v19, s22, v151
    v_pk_add_f32 v[12:13], v[12:13], v[20:21] op_sel_hi:[1,0] neg_lo:[0,1] neg_hi:[0,1]
    v_pk_add_f32 v[14:15], v[14:15], v[20:21] op_sel_hi:[1,0] neg_lo:[0,1] neg_hi:[0,1]
    v_pk_add_f32 v[16:17], v[16:17], v[20:21] op_sel_hi:[1,0] neg_lo:[0,1] neg_hi:[0,1]
    v_pk_add_f32 v[18:19], v[18:19], v[20:21] op_sel_hi:[1,0] neg_lo:[0,1] neg_hi:[0,1]
    v_cvt_pk_bf16_f32 v148, v12, v13
    v_cvt_pk_bf16_f32 v149, v14, v15
    v_cvt_pk_bf16_f32 v150, v16, v17
    v_cvt_pk_bf16_f32 v151, v18, v19
    v_dot2c_f32_bf16 v4, v148, v148
    v_dot2c_f32_bf16 v5, v149, v149
    v_dot2c_f32_bf16 v6, v150, v150
    v_dot2c_f32_bf16 v7, v151, v151
    v_lshlrev_b32 v12, 16, v84
    v_and_b32 v13, s22, v84
    v_lshlrev_b32 v14, 16, v85
    v_and_b32 v15, s22, v85
    v_lshlrev_b32 v16, 16, v86
    v_and_b32 v17, s22, v86
    v_lshlrev_b32 v18, 16, v87
    v_and_b32 v19, s22, v87
    v_pk_fma_f32 v[12:13], v[12:13], v[8:9], v[8:9] op_sel:[0,0,1] op_sel_hi:[1,0,1]
    v_pk_fma_f32 v[14:15], v[14:15], v[8:9], v[8:9] op_sel:[0,0,1] op_sel_hi:[1,0,1]
    v_pk_fma_f32 v[16:17], v[16:17], v[8:9], v[8:9] op_sel:[0,0,1] op_sel_hi:[1,0,1]
    v_pk_fma_f32 v[18:19], v[18:19], v[8:9], v[8:9] op_sel:[0,0,1] op_sel_hi:[1,0,1]
    v_cvt_pk_bf16_f32 v84, v12, v13
    v_cvt_pk_bf16_f32 v85, v14, v15
    v_cvt_pk_bf16_f32 v86, v16, v17
    v_cvt_pk_bf16_f32 v87, v18, v19
    global_store_dwordx4 v1, v[84:87], s[14:15] sc1
    s_add_u32 s14, s14, 8192
    s_addc_u32 s15, s15, 0
    v_lshlrev_b32 v12, 16, v88
    v_and_b32 v13, s22, v88
    v_lshlrev_b32 v14, 16, v89
    v_and_b32 v15, s22, v89
    v_lshlrev_b32 v16, 16, v90
    v_and_b32 v17, s22, v90
    v_lshlrev_b32 v18, 16, v91
    v_and_b32 v19, s22, v91
    v_pk_fma_f32 v[12:13], v[12:13], v[8:9], v[8:9] op_sel:[0,0,1] op_sel_hi:[1,0,1]
    v_pk_fma_f32 v[14:15], v[14:15], v[8:9], v[8:9] op_sel:[0,0,1] op_sel_hi:[1,0,1]
    v_pk_fma_f32 v[16:17], v[16:17], v[8:9], v[8:9] op_sel:[0,0,1] op_sel_hi:[1,0,1]
    v_pk_fma_f32 v[18:19], v[18:19], v[8:9], v[8:9] op_sel:[0,0,1] op_sel_hi:[1,0,1]
    v_cvt_pk_bf16_f32 v88, v12, v13
    v_cvt_pk_bf16_f32 v89, v14, v15
    v_cvt_pk_bf16_f32 v90, v16, v17
    v_cvt_pk_bf16_f32 v91, v18, v19
    global_store_dwordx4 v1, v[88:91], s[14:15] sc1
    s_add_u32 s14, s14, 8192
    s_addc_u32 s15, s15, 0
    v_lshlrev_b32 v12, 16, v152
    v_and_b32 v13, s22, v152
    v_lshlrev_b32 v14, 16, v153
    v_and_b32 v15, s22, v153
    v_lshlrev_b32 v16, 16, v154
    v_and_b32 v17, s22, v154
    v_lshlrev_b32 v18, 16, v155
    v_and_b32 v19, s22, v155
    v_pk_add_f32 v[12:13], v[12:13], v[20:21] op_sel_hi:[1,0] neg_lo:[0,1] neg_hi:[0,1]
    v_pk_add_f32 v[14:15], v[14:15], v[20:21] op_sel_hi:[1,0] neg_lo:[0,1] neg_hi:[0,1]
    v_pk_add_f32 v[16:17], v[16:17], v[20:21] op_sel_hi:[1,0] neg_lo:[0,1] neg_hi:[0,1]
    v_pk_add_f32 v[18:19], v[18:19], v[20:21] op_sel_hi:[1,0] neg_lo:[0,1] neg_hi:[0,1]
    v_cvt_pk_bf16_f32 v152, v12, v13
    v_cvt_pk_bf16_f32 v153, v14, v15
    v_cvt_pk_bf16_f32 v154, v16, v17
    v_cvt_pk_bf16_f32 v155, v18, v19
    v_dot2c_f32_bf16 v4, v152, v152
    v_dot2c_f32_bf16 v5, v153, v153
    v_dot2c_f32_bf16 v6, v154, v154
    v_dot2c_f32_bf16 v7, v155, v155
    v_lshlrev_b32 v12, 16, v156
    v_and_b32 v13, s22, v156
    v_lshlrev_b32 v14, 16, v157
    v_and_b32 v15, s22, v157
    v_lshlrev_b32 v16, 16, v158
    v_and_b32 v17, s22, v158
    v_lshlrev_b32 v18, 16, v159
    v_and_b32 v19, s22, v159
    v_pk_add_f32 v[12:13], v[12:13], v[20:21] op_sel_hi:[1,0] neg_lo:[0,1] neg_hi:[0,1]
    v_pk_add_f32 v[14:15], v[14:15], v[20:21] op_sel_hi:[1,0] neg_lo:[0,1] neg_hi:[0,1]
    v_pk_add_f32 v[16:17], v[16:17], v[20:21] op_sel_hi:[1,0] neg_lo:[0,1] neg_hi:[0,1]
    v_pk_add_f32 v[18:19], v[18:19], v[20:21] op_sel_hi:[1,0] neg_lo:[0,1] neg_hi:[0,1]
    v_cvt_pk_bf16_f32 v156, v12, v13
    v_cvt_pk_bf16_f32 v157, v14, v15
    v_cvt_pk_bf16_f32 v158, v16, v17
    v_cvt_pk_bf16_f32 v159, v18, v19
    v_dot2c_f32_bf16 v4, v156, v156
    v_dot2c_f32_bf16 v5, v157, v157
    v_dot2c_f32_bf16 v6, v158, v158
    v_dot2c_f32_bf16 v7, v159, v159
    v_lshlrev_b32 v12, 16, v160
    v_and_b32 v13, s22, v160
    v_lshlrev_b32 v14, 16, v161
    v_and_b32 v15, s22, v161
    v_lshlrev_b32 v16, 16, v162
    v_and_b32 v17, s22, v162
    v_lshlrev_b32 v18, 16, v163
    v_and_b32 v19, s22, v163
    v_pk_add_f32 v[12:13], v[12:13], v[20:21] op_sel_hi:[1,0] neg_lo:[0,1] neg_hi:[0,1]
    v_pk_add_f32 v[14:15], v[14:15], v[20:21] op_sel_hi:[1,0] neg_lo:[0,1] neg_hi:[0,1]
    v_pk_add_f32 v[16:17], v[16:17], v[20:21] op_sel_hi:[1,0] neg_lo:[0,1] neg_hi:[0,1]
    v_pk_add_f32 v[18:19], v[18:19], v[20:21] op_sel_hi:[1,0] neg_lo:[0,1] neg_hi:[0,1]
    v_cvt_pk_bf16_f32 v160, v12, v13
    v_cvt_pk_bf16_f32 v161, v14, v15
    v_cvt_pk_bf16_f32 v162, v16, v17
    v_cvt_pk_bf16_f32 v163, v18, v19
    v_dot2c_f32_bf16 v4, v160, v160
    v_dot2c_f32_bf16 v5, v161, v161
    v_dot2c_f32_bf16 v6, v162, v162
    v_dot2c_f32_bf16 v7, v163, v163
    v_lshlrev_b32 v12, 16, v164
    v_and_b32 v13, s22, v164
    v_lshlrev_b32 v14, 16, v165
    v_and_b32 v15, s22, v165
    v_lshlrev_b32 v16, 16, v166
    v_and_b32 v17, s22, v166
    v_lshlrev_b32 v18, 16, v167
    v_and_b32 v19, s22, v167
    v_pk_add_f32 v[12:13], v[12:13], v[20:21] op_sel_hi:[1,0] neg_lo:[0,1] neg_hi:[0,1]
    v_pk_add_f32 v[14:15], v[14:15], v[20:21] op_sel_hi:[1,0] neg_lo:[0,1] neg_hi:[0,1]
    v_pk_add_f32 v[16:17], v[16:17], v[20:21] op_sel_hi:[1,0] neg_lo:[0,1] neg_hi:[0,1]
    v_pk_add_f32 v[18:19], v[18:19], v[20:21] op_sel_hi:[1,0] neg_lo:[0,1] neg_hi:[0,1]
    v_cvt_pk_bf16_f32 v164, v12, v13
    v_cvt_pk_bf16_f32 v165, v14, v15
    v_cvt_pk_bf16_f32 v166, v16, v17
    v_cvt_pk_bf16_f32 v167, v18, v19
    v_dot2c_f32_bf16 v4, v164, v164
    v_dot2c_f32_bf16 v5, v165, v165
    v_dot2c_f32_bf16 v6, v166, v166
    v_dot2c_f32_bf16 v7, v167, v167
    s_nop 2
    v_add_f32 v4, v4, v5
    v_add_f32 v6, v6, v7
    v_add_f32 v4, v4, v6
    s_nop 1
    v_add_f32_dpp v5, v4, v4 row_ror:8 row_mask:0xf bank_mask:0xf
    s_nop 1
    v_add_f32_dpp v4, v5, v5 row_ror:4 row_mask:0xf bank_mask:0xf
    s_nop 1
    v_add_f32_dpp v5, v4, v4 row_ror:2 row_mask:0xf bank_mask:0xf
    s_nop 1
    v_add_f32_dpp v4, v5, v5 row_ror:1 row_mask:0xf bank_mask:0xf
    ds_write_b32 v2, v4 offset:512
    v_lshlrev_b32 v12, 16, v92
    v_and_b32 v13, s22, v92
    v_lshlrev_b32 v14, 16, v93
    v_and_b32 v15, s22, v93
    v_lshlrev_b32 v16, 16, v94
    v_and_b32 v17, s22, v94
    v_lshlrev_b32 v18, 16, v95
    v_and_b32 v19, s22, v95
    v_pk_fma_f32 v[12:13], v[12:13], v[8:9], v[8:9] op_sel:[0,0,1] op_sel_hi:[1,0,1]
    v_pk_fma_f32 v[14:15], v[14:15], v[8:9], v[8:9] op_sel:[0,0,1] op_sel_hi:[1,0,1]
    v_pk_fma_f32 v[16:17], v[16:17], v[8:9], v[8:9] op_sel:[0,0,1] op_sel_hi:[1,0,1]
    v_pk_fma_f32 v[18:19], v[18:19], v[8:9], v[8:9] op_sel:[0,0,1] op_sel_hi:[1,0,1]
    v_cvt_pk_bf16_f32 v92, v12, v13
    v_cvt_pk_bf16_f32 v93, v14, v15
    v_cvt_pk_bf16_f32 v94, v16, v17
    v_cvt_pk_bf16_f32 v95, v18, v19
    global_store_dwordx4 v1, v[92:95], s[14:15] sc1
    s_add_u32 s14, s14, 8192
    s_addc_u32 s15, s15, 0
    v_lshlrev_b32 v12, 16, v96
    v_and_b32 v13, s22, v96
    v_lshlrev_b32 v14, 16, v97
    v_and_b32 v15, s22, v97
    v_lshlrev_b32 v16, 16, v98
    v_and_b32 v17, s22, v98
    v_lshlrev_b32 v18, 16, v99
    v_and_b32 v19, s22, v99
    v_pk_fma_f32 v[12:13], v[12:13], v[8:9], v[8:9] op_sel:[0,0,1] op_sel_hi:[1,0,1]
    v_pk_fma_f32 v[14:15], v[14:15], v[8:9], v[8:9] op_sel:[0,0,1] op_sel_hi:[1,0,1]
    v_pk_fma_f32 v[16:17], v[16:17], v[8:9], v[8:9] op_sel:[0,0,1] op_sel_hi:[1,0,1]
    v_pk_fma_f32 v[18:19], v[18:19], v[8:9], v[8:9] op_sel:[0,0,1] op_sel_hi:[1,0,1]
    v_cvt_pk_bf16_f32 v96, v12, v13
    v_cvt_pk_bf16_f32 v97, v14, v15
    v_cvt_pk_bf16_f32 v98, v16, v17
    v_cvt_pk_bf16_f32 v99, v18, v19
    global_store_dwordx4 v1, v[96:99], s[14:15] sc1
    s_add_u32 s14, s14, 8192
    s_addc_u32 s15, s15, 0
    s_waitcnt lgkmcnt(0)
    s_barrier
    ds_read_b64 v[4:5], v3 offset:512
    s_waitcnt lgkmcnt(0)
    v_add_f32 v4, v4, v5
    s_nop 1
    v_add_f32_dpp v5, v4, v4 row_ror:8 row_mask:0xf bank_mask:0xf
    s_nop 1
    v_add_f32_dpp v4, v5, v5 row_ror:4 row_mask:0xf bank_mask:0xf
    s_nop 1
    v_add_f32_dpp v5, v4, v4 row_ror:2 row_mask:0xf bank_mask:0xf
    s_nop 1
    v_add_f32_dpp v4, v5, v5 row_ror:1 row_mask:0xf bank_mask:0xf
    v_mul_f32 v4, 0x37800000, v4
    v_cvt_pk_bf16_f32 v4, v4, v4
    v_lshlrev_b32 v4, 16, v4
    v_add_f32 v4, 0x3727c5ac, v4
    v_cvt_pk_bf16_f32 v4, v4, v4
    v_lshlrev_b32 v4, 16, v4
    v_sqrt_f32 v4, v4
    s_nop 0
    v_cvt_pk_bf16_f32 v4, v4, v4
    v_lshlrev_b32 v4, 16, v4
    v_rcp_f32 v10, v4
    s_lshl_b32 s32, s66, 16
    s_and_b32 s33, s66, 0xffff0000
    s_lshl_b32 s34, s67, 16
    s_and_b32 s35, s67, 0xffff0000
    s_bitcmp1_b32 s58, 0
    s_cselect_b32 s32, s33, s32
    s_cselect_b32 s34, s35, s34
    v_mul_f32 v10, s32, v10
    v_mov_b32 v11, s34
    v_lshlrev_b32 v12, 16, v100
    v_and_b32 v13, s22, v100
    v_lshlrev_b32 v14, 16, v101
    v_and_b32 v15, s22, v101
    v_lshlrev_b32 v16, 16, v102
    v_and_b32 v17, s22, v102
    v_lshlrev_b32 v18, 16, v103
    v_and_b32 v19, s22, v103
    v_pk_fma_f32 v[12:13], v[12:13], v[8:9], v[8:9] op_sel:[0,0,1] op_sel_hi:[1,0,1]
    v_pk_fma_f32 v[14:15], v[14:15], v[8:9], v[8:9] op_sel:[0,0,1] op_sel_hi:[1,0,1]
    v_pk_fma_f32 v[16:17], v[16:17], v[8:9], v[8:9] op_sel:[0,0,1] op_sel_hi:[1,0,1]
    v_pk_fma_f32 v[18:19], v[18:19], v[8:9], v[8:9] op_sel:[0,0,1] op_sel_hi:[1,0,1]
    v_cvt_pk_bf16_f32 v100, v12, v13
    v_cvt_pk_bf16_f32 v101, v14, v15
    v_cvt_pk_bf16_f32 v102, v16, v17
    v_cvt_pk_bf16_f32 v103, v18, v19
    global_store_dwordx4 v1, v[100:103], s[14:15] sc1
    s_add_u32 s14, s14, 8192
    s_addc_u32 s15, s15, 0
    s_add_u32 s14, s10, s48
    s_addc_u32 s15, s11, 0
    v_lshlrev_b32 v12, 16, v104
    v_and_b32 v13, s22, v104
    v_lshlrev_b32 v14, 16, v105
    v_and_b32 v15, s22, v105
    v_lshlrev_b32 v16, 16, v106
    v_and_b32 v17, s22, v106
    v_lshlrev_b32 v18, 16, v107
    v_and_b32 v19, s22, v107
    v_pk_fma_f32 v[12:13], v[12:13], v[10:11], v[10:11] op_sel:[0,0,1] op_sel_hi:[1,0,1]
    v_pk_fma_f32 v[14:15], v[14:15], v[10:11], v[10:11] op_sel:[0,0,1] op_sel_hi:[1,0,1]
    v_pk_fma_f32 v[16:17], v[16:17], v[10:11], v[10:11] op_sel:[0,0,1] op_sel_hi:[1,0,1]
    v_pk_fma_f32 v[18:19], v[18:19], v[10:11], v[10:11] op_sel:[0,0,1] op_sel_hi:[1,0,1]
    v_cvt_pk_bf16_f32 v104, v12, v13
    v_cvt_pk_bf16_f32 v105, v14, v15
    v_cvt_pk_bf16_f32 v106, v16, v17
    v_cvt_pk_bf16_f32 v107, v18, v19
    global_store_dwordx4 v1, v[104:107], s[14:15] sc1
    s_add_u32 s14, s14, 8192
    s_addc_u32 s15, s15, 0
    v_lshlrev_b32 v12, 16, v108
    v_and_b32 v13, s22, v108
    v_lshlrev_b32 v14, 16, v109
    v_and_b32 v15, s22, v109
    v_lshlrev_b32 v16, 16, v110
    v_and_b32 v17, s22, v110
    v_lshlrev_b32 v18, 16, v111
    v_and_b32 v19, s22, v111
    v_pk_fma_f32 v[12:13], v[12:13], v[10:11], v[10:11] op_sel:[0,0,1] op_sel_hi:[1,0,1]
    v_pk_fma_f32 v[14:15], v[14:15], v[10:11], v[10:11] op_sel:[0,0,1] op_sel_hi:[1,0,1]
    v_pk_fma_f32 v[16:17], v[16:17], v[10:11], v[10:11] op_sel:[0,0,1] op_sel_hi:[1,0,1]
    v_pk_fma_f32 v[18:19], v[18:19], v[10:11], v[10:11] op_sel:[0,0,1] op_sel_hi:[1,0,1]
    v_cvt_pk_bf16_f32 v108, v12, v13
    v_cvt_pk_bf16_f32 v109, v14, v15
    v_cvt_pk_bf16_f32 v110, v16, v17
    v_cvt_pk_bf16_f32 v111, v18, v19
    global_store_dwordx4 v1, v[108:111], s[14:15] sc1
    s_add_u32 s14, s14, 8192
    s_addc_u32 s15, s15, 0
    v_lshlrev_b32 v12, 16, v112
    v_and_b32 v13, s22, v112
    v_lshlrev_b32 v14, 16, v113
    v_and_b32 v15, s22, v113
    v_lshlrev_b32 v16, 16, v114
    v_and_b32 v17, s22, v114
    v_lshlrev_b32 v18, 16, v115
    v_and_b32 v19, s22, v115
    v_pk_fma_f32 v[12:13], v[12:13], v[10:11], v[10:11] op_sel:[0,0,1] op_sel_hi:[1,0,1]
    v_pk_fma_f32 v[14:15], v[14:15], v[10:11], v[10:11] op_sel:[0,0,1] op_sel_hi:[1,0,1]
    v_pk_fma_f32 v[16:17], v[16:17], v[10:11], v[10:11] op_sel:[0,0,1] op_sel_hi:[1,0,1]
    v_pk_fma_f32 v[18:19], v[18:19], v[10:11], v[10:11] op_sel:[0,0,1] op_sel_hi:[1,0,1]
    v_cvt_pk_bf16_f32 v112, v12, v13
    v_cvt_pk_bf16_f32 v113, v14, v15
    v_cvt_pk_bf16_f32 v114, v16, v17
    v_cvt_pk_bf16_f32 v115, v18, v19
    global_store_dwordx4 v1, v[112:115], s[14:15] sc1
    s_add_u32 s14, s14, 8192
    s_addc_u32 s15, s15, 0
    v_lshlrev_b32 v12, 16, v116
    v_and_b32 v13, s22, v116
    v_lshlrev_b32 v14, 16, v117
    v_and_b32 v15, s22, v117
    v_lshlrev_b32 v16, 16, v118
    v_and_b32 v17, s22, v118
    v_lshlrev_b32 v18, 16, v119
    v_and_b32 v19, s22, v119
    v_pk_fma_f32 v[12:13], v[12:13], v[10:11], v[10:11] op_sel:[0,0,1] op_sel_hi:[1,0,1]
    v_pk_fma_f32 v[14:15], v[14:15], v[10:11], v[10:11] op_sel:[0,0,1] op_sel_hi:[1,0,1]
    v_pk_fma_f32 v[16:17], v[16:17], v[10:11], v[10:11] op_sel:[0,0,1] op_sel_hi:[1,0,1]
    v_pk_fma_f32 v[18:19], v[18:19], v[10:11], v[10:11] op_sel:[0,0,1] op_sel_hi:[1,0,1]
    v_cvt_pk_bf16_f32 v116, v12, v13
    v_cvt_pk_bf16_f32 v117, v14, v15
    v_cvt_pk_bf16_f32 v118, v16, v17
    v_cvt_pk_bf16_f32 v119, v18, v19
    global_store_dwordx4 v1, v[116:119], s[14:15] sc1
    s_add_u32 s14, s14, 8192
    s_addc_u32 s15, s15, 0
    v_lshlrev_b32 v12, 16, v120
    v_and_b32 v13, s22, v120
    v_lshlrev_b32 v14, 16, v121
    v_and_b32 v15, s22, v121
    v_lshlrev_b32 v16, 16, v122
    v_and_b32 v17, s22, v122
    v_lshlrev_b32 v18, 16, v123
    v_and_b32 v19, s22, v123
    v_pk_fma_f32 v[12:13], v[12:13], v[10:11], v[10:11] op_sel:[0,0,1] op_sel_hi:[1,0,1]
    v_pk_fma_f32 v[14:15], v[14:15], v[10:11], v[10:11] op_sel:[0,0,1] op_sel_hi:[1,0,1]
    v_pk_fma_f32 v[16:17], v[16:17], v[10:11], v[10:11] op_sel:[0,0,1] op_sel_hi:[1,0,1]
    v_pk_fma_f32 v[18:19], v[18:19], v[10:11], v[10:11] op_sel:[0,0,1] op_sel_hi:[1,0,1]
    v_cvt_pk_bf16_f32 v120, v12, v13
    v_cvt_pk_bf16_f32 v121, v14, v15
    v_cvt_pk_bf16_f32 v122, v16, v17
    v_cvt_pk_bf16_f32 v123, v18, v19
    global_store_dwordx4 v1, v[120:123], s[14:15] sc1
    s_add_u32 s14, s14, 8192
    s_addc_u32 s15, s15, 0
    v_lshlrev_b32 v12, 16, v124
    v_and_b32 v13, s22, v124
    v_lshlrev_b32 v14, 16, v125
    v_and_b32 v15, s22, v125
    v_lshlrev_b32 v16, 16, v126
    v_and_b32 v17, s22, v126
    v_lshlrev_b32 v18, 16, v127
    v_and_b32 v19, s22, v127
    v_pk_fma_f32 v[12:13], v[12:13], v[10:11], v[10:11] op_sel:[0,0,1] op_sel_hi:[1,0,1]
    v_pk_fma_f32 v[14:15], v[14:15], v[10:11], v[10:11] op_sel:[0,0,1] op_sel_hi:[1,0,1]
    v_pk_fma_f32 v[16:17], v[16:17], v[10:11], v[10:11] op_sel:[0,0,1] op_sel_hi:[1,0,1]
    v_pk_fma_f32 v[18:19], v[18:19], v[10:11], v[10:11] op_sel:[0,0,1] op_sel_hi:[1,0,1]
    v_cvt_pk_bf16_f32 v124, v12, v13
    v_cvt_pk_bf16_f32 v125, v14, v15
    v_cvt_pk_bf16_f32 v126, v16, v17
    v_cvt_pk_bf16_f32 v127, v18, v19
    global_store_dwordx4 v1, v[124:127], s[14:15] sc1
    s_add_u32 s14, s14, 8192
    s_addc_u32 s15, s15, 0
    v_lshlrev_b32 v12, 16, v128
    v_and_b32 v13, s22, v128
    v_lshlrev_b32 v14, 16, v129
    v_and_b32 v15, s22, v129
    v_lshlrev_b32 v16, 16, v130
    v_and_b32 v17, s22, v130
    v_lshlrev_b32 v18, 16, v131
    v_and_b32 v19, s22, v131
    v_pk_fma_f32 v[12:13], v[12:13], v[10:11], v[10:11] op_sel:[0,0,1] op_sel_hi:[1,0,1]
    v_pk_fma_f32 v[14:15], v[14:15], v[10:11], v[10:11] op_sel:[0,0,1] op_sel_hi:[1,0,1]
    v_pk_fma_f32 v[16:17], v[16:17], v[10:11], v[10:11] op_sel:[0,0,1] op_sel_hi:[1,0,1]
    v_pk_fma_f32 v[18:19], v[18:19], v[10:11], v[10:11] op_sel:[0,0,1] op_sel_hi:[1,0,1]
    v_cvt_pk_bf16_f32 v128, v12, v13
    v_cvt_pk_bf16_f32 v129, v14, v15
    v_cvt_pk_bf16_f32 v130, v16, v17
    v_cvt_pk_bf16_f32 v131, v18, v19
    global_store_dwordx4 v1, v[128:131], s[14:15] sc1
    s_add_u32 s14, s14, 8192
    s_addc_u32 s15, s15, 0
    v_lshlrev_b32 v12, 16, v132
    v_and_b32 v13, s22, v132
    v_lshlrev_b32 v14, 16, v133
    v_and_b32 v15, s22, v133
    v_lshlrev_b32 v16, 16, v134
    v_and_b32 v17, s22, v134
    v_lshlrev_b32 v18, 16, v135
    v_and_b32 v19, s22, v135
    v_pk_fma_f32 v[12:13], v[12:13], v[10:11], v[10:11] op_sel:[0,0,1] op_sel_hi:[1,0,1]
    v_pk_fma_f32 v[14:15], v[14:15], v[10:11], v[10:11] op_sel:[0,0,1] op_sel_hi:[1,0,1]
    v_pk_fma_f32 v[16:17], v[16:17], v[10:11], v[10:11] op_sel:[0,0,1] op_sel_hi:[1,0,1]
    v_pk_fma_f32 v[18:19], v[18:19], v[10:11], v[10:11] op_sel:[0,0,1] op_sel_hi:[1,0,1]
    v_cvt_pk_bf16_f32 v132, v12, v13
    v_cvt_pk_bf16_f32 v133, v14, v15
    v_cvt_pk_bf16_f32 v134, v16, v17
    v_cvt_pk_bf16_f32 v135, v18, v19
    global_store_dwordx4 v1, v[132:135], s[14:15] sc1
    s_add_u32 s14, s14, 8192
    s_addc_u32 s15, s15, 0
    v_lshlrev_b32 v12, 16, v136
    v_and_b32 v13, s22, v136
    v_lshlrev_b32 v14, 16, v137
    v_and_b32 v15, s22, v137
    v_lshlrev_b32 v16, 16, v138
    v_and_b32 v17, s22, v138
    v_lshlrev_b32 v18, 16, v139
    v_and_b32 v19, s22, v139
    v_pk_fma_f32 v[12:13], v[12:13], v[10:11], v[10:11] op_sel:[0,0,1] op_sel_hi:[1,0,1]
    v_pk_fma_f32 v[14:15], v[14:15], v[10:11], v[10:11] op_sel:[0,0,1] op_sel_hi:[1,0,1]
    v_pk_fma_f32 v[16:17], v[16:17], v[10:11], v[10:11] op_sel:[0,0,1] op_sel_hi:[1,0,1]
    v_pk_fma_f32 v[18:19], v[18:19], v[10:11], v[10:11] op_sel:[0,0,1] op_sel_hi:[1,0,1]
    v_cvt_pk_bf16_f32 v136, v12, v13
    v_cvt_pk_bf16_f32 v137, v14, v15
    v_cvt_pk_bf16_f32 v138, v16, v17
    v_cvt_pk_bf16_f32 v139, v18, v19
    global_store_dwordx4 v1, v[136:139], s[14:15] sc1
    s_add_u32 s14, s14, 8192
    s_addc_u32 s15, s15, 0
    v_lshlrev_b32 v12, 16, v140
    v_and_b32 v13, s22, v140
    v_lshlrev_b32 v14, 16, v141
    v_and_b32 v15, s22, v141
    v_lshlrev_b32 v16, 16, v142
    v_and_b32 v17, s22, v142
    v_lshlrev_b32 v18, 16, v143
    v_and_b32 v19, s22, v143
    v_pk_fma_f32 v[12:13], v[12:13], v[10:11], v[10:11] op_sel:[0,0,1] op_sel_hi:[1,0,1]
    v_pk_fma_f32 v[14:15], v[14:15], v[10:11], v[10:11] op_sel:[0,0,1] op_sel_hi:[1,0,1]
    v_pk_fma_f32 v[16:17], v[16:17], v[10:11], v[10:11] op_sel:[0,0,1] op_sel_hi:[1,0,1]
    v_pk_fma_f32 v[18:19], v[18:19], v[10:11], v[10:11] op_sel:[0,0,1] op_sel_hi:[1,0,1]
    v_cvt_pk_bf16_f32 v140, v12, v13
    v_cvt_pk_bf16_f32 v141, v14, v15
    v_cvt_pk_bf16_f32 v142, v16, v17
    v_cvt_pk_bf16_f32 v143, v18, v19
    global_store_dwordx4 v1, v[140:143], s[14:15] sc1
    s_add_u32 s14, s14, 8192
    s_addc_u32 s15, s15, 0
    v_lshlrev_b32 v12, 16, v144
    v_and_b32 v13, s22, v144
    v_lshlrev_b32 v14, 16, v145
    v_and_b32 v15, s22, v145
    v_lshlrev_b32 v16, 16, v146
    v_and_b32 v17, s22, v146
    v_lshlrev_b32 v18, 16, v147
    v_and_b32 v19, s22, v147
    v_pk_fma_f32 v[12:13], v[12:13], v[10:11], v[10:11] op_sel:[0,0,1] op_sel_hi:[1,0,1]
    v_pk_fma_f32 v[14:15], v[14:15], v[10:11], v[10:11] op_sel:[0,0,1] op_sel_hi:[1,0,1]
    v_pk_fma_f32 v[16:17], v[16:17], v[10:11], v[10:11] op_sel:[0,0,1] op_sel_hi:[1,0,1]
    v_pk_fma_f32 v[18:19], v[18:19], v[10:11], v[10:11] op_sel:[0,0,1] op_sel_hi:[1,0,1]
    v_cvt_pk_bf16_f32 v144, v12, v13
    v_cvt_pk_bf16_f32 v145, v14, v15
    v_cvt_pk_bf16_f32 v146, v16, v17
    v_cvt_pk_bf16_f32 v147, v18, v19
    global_store_dwordx4 v1, v[144:147], s[14:15] sc1
    s_add_u32 s14, s14, 8192
    s_addc_u32 s15, s15, 0
    v_lshlrev_b32 v12, 16, v148
    v_and_b32 v13, s22, v148
    v_lshlrev_b32 v14, 16, v149
    v_and_b32 v15, s22, v149
    v_lshlrev_b32 v16, 16, v150
    v_and_b32 v17, s22, v150
    v_lshlrev_b32 v18, 16, v151
    v_and_b32 v19, s22, v151
    v_pk_fma_f32 v[12:13], v[12:13], v[10:11], v[10:11] op_sel:[0,0,1] op_sel_hi:[1,0,1]
    v_pk_fma_f32 v[14:15], v[14:15], v[10:11], v[10:11] op_sel:[0,0,1] op_sel_hi:[1,0,1]
    v_pk_fma_f32 v[16:17], v[16:17], v[10:11], v[10:11] op_sel:[0,0,1] op_sel_hi:[1,0,1]
    v_pk_fma_f32 v[18:19], v[18:19], v[10:11], v[10:11] op_sel:[0,0,1] op_sel_hi:[1,0,1]
    v_cvt_pk_bf16_f32 v148, v12, v13
    v_cvt_pk_bf16_f32 v149, v14, v15
    v_cvt_pk_bf16_f32 v150, v16, v17
    v_cvt_pk_bf16_f32 v151, v18, v19
    global_store_dwordx4 v1, v[148:151], s[14:15] sc1
    s_add_u32 s14, s14, 8192
    s_addc_u32 s15, s15, 0
    v_lshlrev_b32 v12, 16, v152
    v_and_b32 v13, s22, v152
    v_lshlrev_b32 v14, 16, v153
    v_and_b32 v15, s22, v153
    v_lshlrev_b32 v16, 16, v154
    v_and_b32 v17, s22, v154
    v_lshlrev_b32 v18, 16, v155
    v_and_b32 v19, s22, v155
    v_pk_fma_f32 v[12:13], v[12:13], v[10:11], v[10:11] op_sel:[0,0,1] op_sel_hi:[1,0,1]
    v_pk_fma_f32 v[14:15], v[14:15], v[10:11], v[10:11] op_sel:[0,0,1] op_sel_hi:[1,0,1]
    v_pk_fma_f32 v[16:17], v[16:17], v[10:11], v[10:11] op_sel:[0,0,1] op_sel_hi:[1,0,1]
    v_pk_fma_f32 v[18:19], v[18:19], v[10:11], v[10:11] op_sel:[0,0,1] op_sel_hi:[1,0,1]
    v_cvt_pk_bf16_f32 v152, v12, v13
    v_cvt_pk_bf16_f32 v153, v14, v15
    v_cvt_pk_bf16_f32 v154, v16, v17
    v_cvt_pk_bf16_f32 v155, v18, v19
    global_store_dwordx4 v1, v[152:155], s[14:15] sc1
    s_add_u32 s14, s14, 8192
    s_addc_u32 s15, s15, 0
    v_lshlrev_b32 v12, 16, v156
    v_and_b32 v13, s22, v156
    v_lshlrev_b32 v14, 16, v157
    v_and_b32 v15, s22, v157
    v_lshlrev_b32 v16, 16, v158
    v_and_b32 v17, s22, v158
    v_lshlrev_b32 v18, 16, v159
    v_and_b32 v19, s22, v159
    v_pk_fma_f32 v[12:13], v[12:13], v[10:11], v[10:11] op_sel:[0,0,1] op_sel_hi:[1,0,1]
    v_pk_fma_f32 v[14:15], v[14:15], v[10:11], v[10:11] op_sel:[0,0,1] op_sel_hi:[1,0,1]
    v_pk_fma_f32 v[16:17], v[16:17], v[10:11], v[10:11] op_sel:[0,0,1] op_sel_hi:[1,0,1]
    v_pk_fma_f32 v[18:19], v[18:19], v[10:11], v[10:11] op_sel:[0,0,1] op_sel_hi:[1,0,1]
    v_cvt_pk_bf16_f32 v156, v12, v13
    v_cvt_pk_bf16_f32 v157, v14, v15
    v_cvt_pk_bf16_f32 v158, v16, v17
    v_cvt_pk_bf16_f32 v159, v18, v19
    global_store_dwordx4 v1, v[156:159], s[14:15] sc1
    s_add_u32 s14, s14, 8192
    s_addc_u32 s15, s15, 0
    v_lshlrev_b32 v12, 16, v160
    v_and_b32 v13, s22, v160
    v_lshlrev_b32 v14, 16, v161
    v_and_b32 v15, s22, v161
    v_lshlrev_b32 v16, 16, v162
    v_and_b32 v17, s22, v162
    v_lshlrev_b32 v18, 16, v163
    v_and_b32 v19, s22, v163
    v_pk_fma_f32 v[12:13], v[12:13], v[10:11], v[10:11] op_sel:[0,0,1] op_sel_hi:[1,0,1]
    v_pk_fma_f32 v[14:15], v[14:15], v[10:11], v[10:11] op_sel:[0,0,1] op_sel_hi:[1,0,1]
    v_pk_fma_f32 v[16:17], v[16:17], v[10:11], v[10:11] op_sel:[0,0,1] op_sel_hi:[1,0,1]
    v_pk_fma_f32 v[18:19], v[18:19], v[10:11], v[10:11] op_sel:[0,0,1] op_sel_hi:[1,0,1]
    v_cvt_pk_bf16_f32 v160, v12, v13
    v_cvt_pk_bf16_f32 v161, v14, v15
    v_cvt_pk_bf16_f32 v162, v16, v17
    v_cvt_pk_bf16_f32 v163, v18, v19
    global_store_dwordx4 v1, v[160:163], s[14:15] sc1
    s_add_u32 s14, s14, 8192
    s_addc_u32 s15, s15, 0
    v_lshlrev_b32 v12, 16, v164
    v_and_b32 v13, s22, v164
    v_lshlrev_b32 v14, 16, v165
    v_and_b32 v15, s22, v165
    v_lshlrev_b32 v16, 16, v166
    v_and_b32 v17, s22, v166
    v_lshlrev_b32 v18, 16, v167
    v_and_b32 v19, s22, v167
    v_pk_fma_f32 v[12:13], v[12:13], v[10:11], v[10:11] op_sel:[0,0,1] op_sel_hi:[1,0,1]
    v_pk_fma_f32 v[14:15], v[14:15], v[10:11], v[10:11] op_sel:[0,0,1] op_sel_hi:[1,0,1]
    v_pk_fma_f32 v[16:17], v[16:17], v[10:11], v[10:11] op_sel:[0,0,1] op_sel_hi:[1,0,1]
    v_pk_fma_f32 v[18:19], v[18:19], v[10:11], v[10:11] op_sel:[0,0,1] op_sel_hi:[1,0,1]
    v_cvt_pk_bf16_f32 v164, v12, v13
    v_cvt_pk_bf16_f32 v165, v14, v15
    v_cvt_pk_bf16_f32 v166, v16, v17
    v_cvt_pk_bf16_f32 v167, v18, v19
    global_store_dwordx4 v1, v[164:167], s[14:15] sc1
    s_add_u32 s14, s14, 8192
    s_addc_u32 s15, s15, 0
L_done:
L_end:
    s_endpgm
    .fill (32768 - (. - L_side1)) / 4, 4, 0xbf800000
.section .rodata,"a"
.p2align 6
.amdhsa_kernel standalone__instancenorm__prompt_kernel
  .amdhsa_next_free_vgpr 256
  .amdhsa_next_free_sgpr 96
  .amdhsa_accum_offset 256
  .amdhsa_group_segment_fixed_size 0
  .amdhsa_kernarg_size 48
  .amdhsa_user_sgpr_count 2
  .amdhsa_user_sgpr_kernarg_segment_ptr 1
  .amdhsa_system_sgpr_workgroup_id_x 1
  .amdhsa_float_denorm_mode_32 3
  .amdhsa_float_denorm_mode_16_64 3
.end_amdhsa_kernel
```
